```python
import torch

def _softmax(x, axis=-1):
    return torch.softmax(x, dim=axis)
def _gelu(x):
    return torch.nn.functional.gelu(x, approximate="tanh")
def _silu(x):
    return torch.nn.functional.silu(x)
def _sigmoid(x):
    return torch.sigmoid(x)
def _layernorm(x, axis=-1, eps=1e-5):
    m = x.mean(dim=axis, keepdim=True)
    v = x.var(dim=axis, keepdim=True, unbiased=False)
    return (x - m) / torch.sqrt(v + eps)
def _scatter_add(tgt, idx, src, axis=0):
    return tgt.clone().index_add_(axis, idx, src)
def _segment_sum(src, seg, n):
    out = torch.zeros((n,) + src.shape[1:], dtype=src.dtype)
    return out.index_add_(0, seg, src)
def _pad(x, pw):
    flat = tuple(v for pair in reversed(pw) for v in pair)
    return torch.nn.functional.pad(x, flat)

kernel_name = 'sequential_preLN__ssm_conv_h3__mixer_s_mlp__prompt'

def setup_inputs():

    _w = (lambda a: (lambda t: t.to(torch.bfloat16) if t.is_floating_point() else t)(torch.as_tensor(a)))
    def _A_setup():
        B, S, D = 1, 2048, 640
        ks = 4
        return {
            "q": _w((lambda *s: torch.randn(*s, dtype=torch.bfloat16) * 0.05)(B, S, D)),
            "k": _w((lambda *s: torch.randn(*s, dtype=torch.bfloat16) * 0.4)(B, S, D)),
            "v": _w((lambda *s: torch.randn(*s, dtype=torch.bfloat16) * 0.4)(B, S, D)),
            "shift_k": _w((lambda *s: torch.randn(*s, dtype=torch.bfloat16) * 0.4)(D, ks) * 0.5),
            "ssm_k": _w((lambda *s: torch.randn(*s, dtype=torch.bfloat16) * 0.4)(D, S) * (1.0 / S ** 0.5)),
            "ssm_D": _w((lambda *s: torch.randn(*s, dtype=torch.bfloat16) * 0.4)(D)),
        }
    _A_in = _A_setup()

    def _B_setup():
        B, S, D, F = 1, 2048, 640, 1728
        return {
            "x":  _w((lambda *s: torch.randn(*s, dtype=torch.bfloat16) * 0.05)(B, S, D)),
            "w1": _w((lambda *s: torch.randn(*s, dtype=torch.bfloat16) * 3.2)(D, D) * (D ** -0.5)),
            "w2": _w((lambda *s: torch.randn(*s, dtype=torch.bfloat16) * 3.2)(D, D) * (D ** -0.5)),
            "w3": _w((lambda *s: torch.randn(*s, dtype=torch.bfloat16) * 3.2)(D, F) * (D ** -0.5)),
            "w4": _w((lambda *s: torch.randn(*s, dtype=torch.bfloat16) * 3.2)(F, D) * (F ** -0.5)),
        }
    _B_in = _B_setup()

    return {
        "A_q": _A_in["q"],
        "A_k": _A_in["k"],
        "A_v": _A_in["v"],
        "A_shift_k": _A_in["shift_k"],
        "A_ssm_k": _A_in["ssm_k"],
        "A_ssm_D": _A_in["ssm_D"],
        "B_x": _B_in["x"],
        "B_w1": _B_in["w1"],
        "B_w2": _B_in["w2"],
        "B_w3": _B_in["w3"],
        "B_w4": _B_in["w4"],
    }

def reference(A_q, A_k, A_v, A_shift_k, A_ssm_k, A_ssm_D, B_x, B_w1, B_w2, B_w3, B_w4):
    def _A_ref(q, k, v, shift_k, ssm_k, ssm_D):
        B, S, D = q.shape
        ks = shift_k.shape[-1]
        k_pad = _pad(k, ((0, 0), (ks - 1, 0), (0, 0)))
        k_shift = torch.zeros_like(k)
        for t in range(ks):
            k_shift = k_shift + k_pad[:, t:t + S, :] * shift_k[:, ks - 1 - t][None, None, :]
        kv = k_shift * v
        L = 2 * S
        kv_pad = _pad(kv, ((0, 0), (0, S), (0, 0)))
        kf_pad = _pad(ssm_k, ((0, 0), (0, S)))
        kv_f = (lambda x, axes=(-2,-1): torch.fft.rfft2(x.float(), dim=axes))(kv_pad[:, None, :, :], axes=(1, 2))
        kf_f = (lambda x, axes=(-2,-1): torch.fft.rfft2(x.float(), dim=axes))(kf_pad[:, None, :], axes=(1, 2))
        kf_f = (lambda x, *d: x.permute(*d))(kf_f, 1, 2, 0)
        y_f = kv_f * kf_f[None, :, :, :]
        y = (lambda x, s, axes=(-2,-1): torch.fft.irfft2(x, s=s, dim=axes).to(torch.bfloat16))(y_f, (1, L), axes=(1, 2))[:, 0, :S, :]
        y = y + kv * ssm_D[None, None, :]
        return q * y

    def _B_ref(x, w1, w2, w3, w4):
        B, S, D = x.shape
        h = _gelu(_layernorm(x, axis=-1) @ w1)
        c = D // 4
        g0 = _pad(h[:, :, 0*c:1*c], ((0, 0), (1, 0), (0, 0)))[:, :S, :]
        g1 = _pad(h[:, :, 1*c:2*c], ((0, 0), (0, 1), (0, 0)))[:, 1:, :]
        g2 = _pad(h[:, :, 2*c:3*c], ((0, 0), (2, 0), (0, 0)))[:, :S, :]
        g3 = _pad(h[:, :, 3*c:   ], ((0, 0), (0, 2), (0, 0)))[:, 2:, :]
        hs = torch.concatenate([g0, g1, g2, g3], axis=-1) @ w2
        x1 = x + hs
        h2 = _gelu(_layernorm(x1, axis=-1) @ w3) @ w4
        return x1 + h2

    x = A_q
    h = x + _A_ref(_layernorm(x, axis=-1), A_k, A_v, A_shift_k, A_ssm_k, A_ssm_D)
    h2 = h + _B_ref(_layernorm(h, axis=-1), B_w1, B_w2, B_w3, B_w4)
    return h2
```

```asm
; @launch grid=(256,1,1) block=(256,1,1) lds=144896
.amdgcn_target "amdgcn-amd-amdhsa--gfx950"
.text
.globl sequential_preLN__ssm_conv_h3__mixer_s_mlp__prompt_kernel
.p2align 8
.type sequential_preLN__ssm_conv_h3__mixer_s_mlp__prompt_kernel,@function
sequential_preLN__ssm_conv_h3__mixer_s_mlp__prompt_kernel:
  s_cmp_ge_u32 s2, 256
  s_cbranch_scc1 sequential_preLN__ssm_conv_h3__mixer_s_mlp__prompt_kernel_end
  s_load_dwordx8 s[36:43], s[0:1], 8
  s_load_dwordx2 s[44:45], s[0:1], 40
  s_load_dwordx8 s[76:83], s[0:1], 56
  s_load_dwordx2 s[72:73], s[0:1], 96
  s_load_dwordx2 s[4:5], s[0:1], 104
  s_load_dwordx2 s[6:7], s[0:1], 88
  s_load_dwordx2 s[8:9], s[0:1], 0
  v_lshrrev_b32 v5, 6, v0
  v_and_b32 v1, 63, v0
  v_readfirstlane_b32 s10, v5
  v_and_b32 v2, 15, v1
  v_lshrrev_b32 v3, 4, v1
  v_lshlrev_b32 v4, 4, v1
  s_cmp_ge_u32 s2, 242
  s_cbranch_scc1 sequential_preLN__ssm_conv_h3__mixer_s_mlp__prompt_kernel_special
  s_sub_u32 s29, s2, 160
  s_cmp_lt_u32 s29, 78
  s_cselect_b32 s29, 2, 1
  s_add_u32 s26, s2, 0
  s_mul_hi_u32 s27, s26, 0x1999999a
  s_mul_i32 s28, s27, 10
  s_sub_u32 s28, s26, s28
  s_lshl_b32 s30, s27, 6
  s_lshl_b32 s31, s28, 6
  s_add_u32 s26, s2, 82
  s_mul_hi_u32 s27, s26, 0x1999999a
  s_mul_i32 s28, s27, 10
  s_sub_u32 s28, s26, s28
  s_lshl_b32 s32, s27, 6
  s_lshl_b32 s33, s28, 6
  v_lshrrev_b32 v5, 3, v0
  v_and_b32 v6, 7, v0
  v_lshlrev_b32 v6, 4, v6
  s_waitcnt lgkmcnt(0)
  s_mov_b32 s48, s36
  s_mov_b32 s49, s37
  s_mov_b32 s50, 2621440
  s_mov_b32 s51, 0x20000
  s_mov_b32 s52, s38
  s_mov_b32 s53, s39
  s_mov_b32 s54, 2621440
  s_mov_b32 s55, 0x20000
  s_mov_b32 s56, s40
  s_mov_b32 s57, s41
  s_mov_b32 s58, 5120
  s_mov_b32 s59, 0x20000
  s_lshl_b32 s26, s10, 10
  s_mov_b32 s27, 40960
  v_add_u32 v8, s30, v5
  v_mul_u32_u24 v8, 1280, v8
  s_lshl_b32 s28, s31, 1
  v_add3_u32 v8, v8, v6, s28
  v_subrev_u32 v10, 3840, v8
  s_add_u32 m0, s26, 0
  s_nop 0
  buffer_load_dwordx4 v10, s[48:51], 0 offen lds
  s_add_u32 m0, s26, 4096
  v_add_u32 v7, 40960, v10
  buffer_load_dwordx4 v7, s[48:51], 0 offen lds
  s_add_u32 m0, s26, 9216
  s_nop 0
  buffer_load_dwordx4 v8, s[52:55], 0 offen lds
  s_add_u32 m0, s26, 13312
  s_nop 0
  buffer_load_dwordx4 v8, s[52:55], s27 offen lds
  s_mov_b32 m0, 8192
  v_lshrrev_b32 v7, 3, v1
  v_add_u32 v7, s30, v7
  v_mul_u32_u24 v7, 1280, v7
  v_and_b32 v18, 7, v1
  v_lshlrev_b32 v18, 4, v18
  s_lshl_b32 s28, s31, 1
  v_add3_u32 v7, v7, v18, s28
  v_add_u32 v7, 78080, v7
  buffer_load_dwordx4 v7, s[48:51], 0 offen lds
  v_add_u32 v16, s31, v1
  v_lshlrev_b32 v16, 3, v16
  buffer_load_dwordx2 v[12:13], v16, s[56:59], 0 offen
  s_cmp_lt_u32 s29, 2
  s_cbranch_scc1 sequential_preLN__ssm_conv_h3__mixer_s_mlp__prompt_kernel_kv1
  v_add_u32 v9, s32, v5
  v_mul_u32_u24 v9, 1280, v9
  s_lshl_b32 s28, s33, 1
  v_add3_u32 v9, v9, v6, s28
  v_subrev_u32 v11, 3840, v9
  s_add_u32 m0, s26, 17408
  s_nop 0
  buffer_load_dwordx4 v11, s[48:51], 0 offen lds
  s_add_u32 m0, s26, 21504
  v_add_u32 v7, 40960, v11
  buffer_load_dwordx4 v7, s[48:51], 0 offen lds
  s_add_u32 m0, s26, 26624
  s_nop 0
  buffer_load_dwordx4 v9, s[52:55], 0 offen lds
  s_add_u32 m0, s26, 30720
  s_nop 0
  buffer_load_dwordx4 v9, s[52:55], s27 offen lds
  s_mov_b32 m0, 25600
  v_lshrrev_b32 v7, 3, v1
  v_add_u32 v7, s32, v7
  v_mul_u32_u24 v7, 1280, v7
  v_and_b32 v18, 7, v1
  v_lshlrev_b32 v18, 4, v18
  s_lshl_b32 s28, s33, 1
  v_add3_u32 v7, v7, v18, s28
  v_add_u32 v7, 78080, v7
  buffer_load_dwordx4 v7, s[48:51], 0 offen lds
  v_add_u32 v17, s33, v1
  v_lshlrev_b32 v17, 3, v17
  buffer_load_dwordx2 v[14:15], v17, s[56:59], 0 offen
sequential_preLN__ssm_conv_h3__mixer_s_mlp__prompt_kernel_kv1:
  s_and_b32 s24, s2, 63
  s_lshr_b32 s25, s2, 6
  s_and_b32 s26, s2, 3
  s_lshl_b32 s26, s26, 3
  s_lshr_b32 s27, s2, 3
  s_and_b32 s60, s27, 7
  s_add_u32 s60, s60, s26
  s_bfe_u32 s26, s2, 0x10002
  s_lshl_b32 s26, s26, 2
  s_lshr_b32 s61, s27, 3
  s_add_u32 s61, s61, s26
  s_and_b32 s62, s61, 1
  s_mul_i32 s69, s61, 5
  s_add_u32 s64, s69, s62
  s_add_u32 s65, s69, s62
  s_add_u32 s65, s65, 1
  s_add_u32 s66, s69, s62
  s_add_u32 s66, s66, 2
  s_add_u32 s67, s69, s62
  s_add_u32 s67, s67, 3
  s_cmp_eq_u32 s62, 0
  s_cselect_b32 s68, 4, 0
  s_add_u32 s68, s68, s69
  s_lshl_b32 s63, s60, 2
  s_add_u32 s63, s63, s10
  s_mul_i32 s26, s63, 20480
  s_lshr_b32 s70, s64, 1
  s_lshl_b32 s70, s70, 10
  s_add_u32 s70, s70, s26
  s_lshr_b32 s71, s68, 1
  s_lshl_b32 s71, s71, 10
  s_add_u32 s71, s71, s26
  s_lshl_b32 s26, s62, 3
  s_add_u32 s71, s71, s26
  s_mov_b32 s12, s4
  s_mov_b32 s13, s5
  s_mov_b32 s14, 29089792
  s_mov_b32 s15, 0x20000
  s_mov_b32 s16, s8
  s_mov_b32 s17, s9
  s_mov_b32 s18, 2621440
  s_mov_b32 s19, 0x20000
  s_mov_b32 s20, s6
  s_mov_b32 s21, s7
  s_mov_b32 s22, 2621440
  s_mov_b32 s23, 0x20000
  s_mov_b32 s74, 256
  s_mov_b32 s75, 0x20000
  s_cmp_ge_u32 s2, 160
  s_nop 1
  s_cbranch_scc1 sequential_preLN__ssm_conv_h3__mixer_s_mlp__prompt_kernel_keepw
  s_mov_b32 s76, s42
  s_mov_b32 s77, s43
  s_mov_b32 s80, s44
  s_mov_b32 s81, s45
sequential_preLN__ssm_conv_h3__mixer_s_mlp__prompt_kernel_keepw:
  s_getpc_b64 s[26:27]
sequential_preLN__ssm_conv_h3__mixer_s_mlp__prompt_kernel_pczu1:
  s_add_u32 s26, s26, sequential_preLN__ssm_conv_h3__mixer_s_mlp__prompt_kernel_code0 - sequential_preLN__ssm_conv_h3__mixer_s_mlp__prompt_kernel_pczu1
  s_addc_u32 s27, s27, 0
  s_lshr_b32 s28, s2, 3
  s_lshl_b32 s28, s28, 12
  v_lshlrev_b32 v180, 4, v0
  v_add_u32 v180, s28, v180
  v_min_u32 v180, sequential_preLN__ssm_conv_h3__mixer_s_mlp__prompt_kernel_end - sequential_preLN__ssm_conv_h3__mixer_s_mlp__prompt_kernel_code0 - 16, v180
  v_mov_b32 v181, s27
  v_add_co_u32 v180, vcc, s26, v180
  s_nop 1
  v_addc_co_u32 v181, vcc, 0, v181, vcc
  global_load_dwordx4 v[182:185], v[180:181], off
sequential_preLN__ssm_conv_h3__mixer_s_mlp__prompt_kernel_code0:
  s_cmp_lt_u32 s29, 2
  s_cbranch_scc1 sequential_preLN__ssm_conv_h3__mixer_s_mlp__prompt_kernel_kvw1
  s_waitcnt vmcnt(7)
  s_branch sequential_preLN__ssm_conv_h3__mixer_s_mlp__prompt_kernel_kvw2
sequential_preLN__ssm_conv_h3__mixer_s_mlp__prompt_kernel_kvw1:
  s_waitcnt vmcnt(1)
sequential_preLN__ssm_conv_h3__mixer_s_mlp__prompt_kernel_kvw2:
  s_barrier
  v_mov_b32 v178, 0
  buffer_load_dword v177, v178, s[72:75], 0 offen sc1
  s_cmp_ge_u32 s2, 160
  s_cbranch_scc1 sequential_preLN__ssm_conv_h3__mixer_s_mlp__prompt_kernel_noh
  s_lshl_b32 s83, s2, 2
  s_add_u32 s83, s83, s10
  s_lshl_b32 s35, s83, 12
  s_mul_i32 s82, s10, 12928
  s_add_u32 s82, s82, 92160
  v_subrev_u32 v5, 32, v4
  v_add_u32 v6, 16, v5
  s_lshl_b32 s28, s83, 1
  v_mov_b32 v19, s28
  s_add_u32 s76, s76, s35
  s_addc_u32 s77, s77, 0
  s_mov_b32 s78, 4096
  s_mov_b32 s79, 0x20000
  buffer_load_dwordx4 v[128:131], v5, s[76:79], 0 offen
  buffer_load_dword v132, v6, s[76:79], 0 offen
  v_add_u32 v5, 1024, v5
  v_add_u32 v6, 1024, v6
  buffer_load_dwordx4 v[136:139], v5, s[76:79], 0 offen
  buffer_load_dword v140, v6, s[76:79], 0 offen
  v_add_u32 v5, 1024, v5
  v_add_u32 v6, 1024, v6
  buffer_load_dwordx4 v[144:147], v5, s[76:79], 0 offen
  buffer_load_dword v148, v6, s[76:79], 0 offen
  v_add_u32 v5, 1024, v5
  v_add_u32 v6, 1024, v6
  buffer_load_dwordx4 v[152:155], v5, s[76:79], 0 offen
  buffer_load_dword v156, v6, s[76:79], 0 offen
  v_add_u32 v5, 1024, v5
  v_add_u32 v6, 1024, v6
  buffer_load_dwordx4 v[160:163], v5, s[76:79], 0 offen
  buffer_load_dword v164, v6, s[76:79], 0 offen
  v_subrev_u32 v5, 32, v4
  s_add_u32 m0, s82, 4608
  s_nop 0
  buffer_load_dwordx4 v5, s[76:79], 0 offen lds
  s_add_u32 m0, s82, 5632
  v_add_u32 v5, 1024, v5
  buffer_load_dwordx4 v5, s[76:79], 0 offen offset:0 lds
  buffer_load_dwordx4 v5, s[76:79], 0 offen offset:1024 lds
  buffer_load_dwordx4 v5, s[76:79], 0 offen offset:2048 lds
  s_add_u32 m0, s82, 8704
  v_add_u32 v5, 3072, v5
  s_mov_b64 exec, 15
  buffer_load_dwordx4 v5, s[76:79], 0 offen lds
  s_mov_b64 exec, -1
  s_mov_b32 s44, s80
  s_mov_b32 s45, s81
  s_mov_b32 s46, 1280
  s_mov_b32 s47, 0x20000
  buffer_load_ushort v176, v19, s[44:47], 0 offen
sequential_preLN__ssm_conv_h3__mixer_s_mlp__prompt_kernel_noh:
  v_and_b32 v10, 15, v1
  v_lshrrev_b32 v11, 2, v10
  s_lshl_b32 s42, s10, 4
  v_add_u32 v11, s42, v11
  v_lshlrev_b32 v11, 7, v11
  v_and_b32 v10, 3, v10
  v_lshlrev_b32 v10, 3, v10
  v_lshlrev_b32 v16, 5, v3
  v_add3_u32 v11, v11, v10, v16
  s_mov_b32 s45, 0
  s_mov_b32 s46, 0xffff0000
  s_mov_b32 s47, 34816
  .p2align 3
sequential_preLN__ssm_conv_h3__mixer_s_mlp__prompt_kernel_kvloop:
  v_mul_u32_u24 v9, 144, v1
  s_lshl_b32 s43, s10, 5
  s_sub_u32 s43, 34912, s43
  v_add_u32 v9, s43, v9
  ds_read_b64_tr_b16 v[16:17], v11 offset:0
  ds_read_b64_tr_b16 v[18:19], v11 offset:512
  ds_read_b64_tr_b16 v[20:21], v11 offset:1024
  ds_read_b64_tr_b16 v[22:23], v11 offset:1536
  ds_read_b64_tr_b16 v[24:25], v11 offset:2048
  ds_read_b64_tr_b16 v[26:27], v11 offset:9216
  ds_read_b64_tr_b16 v[28:29], v11 offset:9728
  ds_read_b64_tr_b16 v[30:31], v11 offset:10240
  ds_read_b64_tr_b16 v[32:33], v11 offset:10752
  v_lshlrev_b32 v34, 16, v12
  v_and_b32 v35, s46, v12
  v_lshlrev_b32 v36, 16, v13
  v_and_b32 v37, s46, v13
  s_waitcnt lgkmcnt(4)
  v_lshlrev_b32 v38, 16, v16
  v_and_b32 v39, s46, v16
  v_lshlrev_b32 v40, 16, v17
  v_and_b32 v41, s46, v17
  v_lshlrev_b32 v42, 16, v18
  v_and_b32 v43, s46, v18
  v_lshlrev_b32 v44, 16, v19
  v_and_b32 v45, s46, v19
  v_lshlrev_b32 v46, 16, v20
  v_and_b32 v47, s46, v20
  v_lshlrev_b32 v48, 16, v21
  v_and_b32 v49, s46, v21
  v_lshlrev_b32 v50, 16, v22
  v_and_b32 v51, s46, v22
  v_lshlrev_b32 v52, 16, v23
  v_and_b32 v53, s46, v23
  v_lshlrev_b32 v54, 16, v24
  v_and_b32 v55, s46, v24
  v_lshlrev_b32 v56, 16, v25
  v_and_b32 v57, s46, v25
  s_waitcnt lgkmcnt(0)
  v_mul_f32 v16, v34, v56
  v_fmac_f32 v16, v35, v55
  v_fmac_f32 v16, v36, v54
  v_fmac_f32 v16, v37, v53
  v_and_b32 v18, s46, v33
  v_mul_f32 v16, v16, v18
  v_mul_f32 v17, v34, v55
  v_fmac_f32 v17, v35, v54
  v_fmac_f32 v17, v36, v53
  v_fmac_f32 v17, v37, v52
  v_lshlrev_b32 v19, 16, v33
  v_mul_f32 v17, v17, v19
  v_cvt_pk_bf16_f32 v58, v16, v17
  v_mul_f32 v16, v34, v54
  v_fmac_f32 v16, v35, v53
  v_fmac_f32 v16, v36, v52
  v_fmac_f32 v16, v37, v51
  v_and_b32 v18, s46, v32
  v_mul_f32 v16, v16, v18
  v_mul_f32 v17, v34, v53
  v_fmac_f32 v17, v35, v52
  v_fmac_f32 v17, v36, v51
  v_fmac_f32 v17, v37, v50
  v_lshlrev_b32 v19, 16, v32
  v_mul_f32 v17, v17, v19
  v_cvt_pk_bf16_f32 v59, v16, v17
  v_mul_f32 v16, v34, v52
  v_fmac_f32 v16, v35, v51
  v_fmac_f32 v16, v36, v50
  v_fmac_f32 v16, v37, v49
  v_and_b32 v18, s46, v31
  v_mul_f32 v16, v16, v18
  v_mul_f32 v17, v34, v51
  v_fmac_f32 v17, v35, v50
  v_fmac_f32 v17, v36, v49
  v_fmac_f32 v17, v37, v48
  v_lshlrev_b32 v19, 16, v31
  v_mul_f32 v17, v17, v19
  v_cvt_pk_bf16_f32 v60, v16, v17
  v_mul_f32 v16, v34, v50
  v_fmac_f32 v16, v35, v49
  v_fmac_f32 v16, v36, v48
  v_fmac_f32 v16, v37, v47
  v_and_b32 v18, s46, v30
  v_mul_f32 v16, v16, v18
  v_mul_f32 v17, v34, v49
  v_fmac_f32 v17, v35, v48
  v_fmac_f32 v17, v36, v47
  v_fmac_f32 v17, v37, v46
  v_lshlrev_b32 v19, 16, v30
  v_mul_f32 v17, v17, v19
  v_cvt_pk_bf16_f32 v61, v16, v17
  ds_write_b128 v9, v[58:61] offset:0
  v_mul_f32 v16, v34, v48
  v_fmac_f32 v16, v35, v47
  v_fmac_f32 v16, v36, v46
  v_fmac_f32 v16, v37, v45
  v_and_b32 v18, s46, v29
  v_mul_f32 v16, v16, v18
  v_mul_f32 v17, v34, v47
  v_fmac_f32 v17, v35, v46
  v_fmac_f32 v17, v36, v45
  v_fmac_f32 v17, v37, v44
  v_lshlrev_b32 v19, 16, v29
  v_mul_f32 v17, v17, v19
  v_cvt_pk_bf16_f32 v20, v16, v17
  v_mul_f32 v16, v34, v46
  v_fmac_f32 v16, v35, v45
  v_fmac_f32 v16, v36, v44
  v_fmac_f32 v16, v37, v43
  v_and_b32 v18, s46, v28
  v_mul_f32 v16, v16, v18
  v_mul_f32 v17, v34, v45
  v_fmac_f32 v17, v35, v44
  v_fmac_f32 v17, v36, v43
  v_fmac_f32 v17, v37, v42
  v_lshlrev_b32 v19, 16, v28
  v_mul_f32 v17, v17, v19
  v_cvt_pk_bf16_f32 v21, v16, v17
  v_mul_f32 v16, v34, v44
  v_fmac_f32 v16, v35, v43
  v_fmac_f32 v16, v36, v42
  v_fmac_f32 v16, v37, v41
  v_and_b32 v18, s46, v27
  v_mul_f32 v16, v16, v18
  v_mul_f32 v17, v34, v43
  v_fmac_f32 v17, v35, v42
  v_fmac_f32 v17, v36, v41
  v_fmac_f32 v17, v37, v40
  v_lshlrev_b32 v19, 16, v27
  v_mul_f32 v17, v17, v19
  v_cvt_pk_bf16_f32 v22, v16, v17
  v_mul_f32 v16, v34, v42
  v_fmac_f32 v16, v35, v41
  v_fmac_f32 v16, v36, v40
  v_fmac_f32 v16, v37, v39
  v_and_b32 v18, s46, v26
  v_mul_f32 v16, v16, v18
  v_mul_f32 v17, v34, v41
  v_fmac_f32 v17, v35, v40
  v_fmac_f32 v17, v36, v39
  v_fmac_f32 v17, v37, v38
  v_lshlrev_b32 v19, 16, v26
  v_mul_f32 v17, v17, v19
  v_cvt_pk_bf16_f32 v23, v16, v17
  ds_write_b128 v9, v[20:23] offset:16
  v_lshrrev_b32 v5, 3, v1
  v_add_u32 v5, s42, v5
  v_and_b32 v6, 7, v1
  v_lshlrev_b32 v6, 4, v6
  v_mul_u32_u24 v7, 144, v5
  v_add3_u32 v7, v7, v6, s47
  v_add_u32 v5, s31, v5
  v_lshlrev_b32 v5, 12, v5
  v_add_u32 v5, v5, v6
  s_sub_u32 s43, 1984, s30
  s_lshl_b32 s43, s43, 1
  s_add_u32 s43, s43, 0
  s_add_u32 s44, s43, 32768
  s_waitcnt lgkmcnt(0)
  s_barrier
  ds_read_b128 v[16:19], v7
  ds_read_b128 v[20:23], v7 offset:1152
  s_waitcnt lgkmcnt(1)
  buffer_store_dwordx4 v[16:19], v5, s[12:15], s43 offen sc1
  s_waitcnt lgkmcnt(0)
  buffer_store_dwordx4 v[20:23], v5, s[12:15], s44 offen sc1
  s_add_u32 s45, s45, 1
  s_cmp_ge_u32 s45, s29
  s_nop 4
  s_cbranch_scc1 sequential_preLN__ssm_conv_h3__mixer_s_mlp__prompt_kernel_kvexit
  s_waitcnt vmcnt(4)
  s_barrier
  s_mov_b32 s30, s32
  s_mov_b32 s31, s33
  v_mov_b32 v12, v14
  v_mov_b32 v13, v15
  v_add_u32 v11, 17408, v11
  s_branch sequential_preLN__ssm_conv_h3__mixer_s_mlp__prompt_kernel_kvloop
sequential_preLN__ssm_conv_h3__mixer_s_mlp__prompt_kernel_kvexit:
  s_waitcnt vmcnt(0)
  v_cmp_eq_u32 vcc, 0, v177
  s_nop 4
  s_cbranch_vccz sequential_preLN__ssm_conv_h3__mixer_s_mlp__prompt_kernel_initok
  v_mov_b32 v5, 0
  s_mov_b32 s85, 0
sequential_preLN__ssm_conv_h3__mixer_s_mlp__prompt_kernel_in2_l:
  buffer_load_dword v6, v5, s[72:75], 0 offen sc1
  s_add_u32 s85, s85, 1
  s_waitcnt vmcnt(0)
  v_cmp_eq_u32 vcc, 0, v6
  s_cmp_gt_u32 s85, 200000
  s_cbranch_scc1 sequential_preLN__ssm_conv_h3__mixer_s_mlp__prompt_kernel_in2
  s_nop 2
  s_nop 2
  s_cbranch_vccnz sequential_preLN__ssm_conv_h3__mixer_s_mlp__prompt_kernel_in2_l
sequential_preLN__ssm_conv_h3__mixer_s_mlp__prompt_kernel_in2:
sequential_preLN__ssm_conv_h3__mixer_s_mlp__prompt_kernel_initok:
  s_barrier
  s_cmp_lg_u32 s10, 0
  s_cbranch_scc1 sequential_preLN__ssm_conv_h3__mixer_s_mlp__prompt_kernel_sigc0
  s_add_u32 s84, s2, 0
  s_mul_hi_u32 s85, s84, 0x1999999a
  s_mul_i32 s28, s85, 10
  s_sub_u32 s84, s84, s28
  s_lshl_b32 s84, s84, 2
  s_and_b32 s85, s85, 3
  s_add_u32 s84, s84, s85
  s_lshl_b32 s84, s84, 7
  s_add_u32 s84, s84, 29077504
  v_mov_b32 v5, 0
  v_mov_b32 v6, 1
  s_mov_b64 exec, 1
  buffer_atomic_add v6, v5, s[12:15], s84 offen sc1
  s_mov_b64 exec, -1
sequential_preLN__ssm_conv_h3__mixer_s_mlp__prompt_kernel_sigc0:
  s_cmp_lt_u32 s29, 2
  s_cbranch_scc1 sequential_preLN__ssm_conv_h3__mixer_s_mlp__prompt_kernel_sigc0b
  s_cmp_lg_u32 s10, 0
  s_cbranch_scc1 sequential_preLN__ssm_conv_h3__mixer_s_mlp__prompt_kernel_sigc0c
  s_add_u32 s84, s2, 82
  s_mul_hi_u32 s85, s84, 0x1999999a
  s_mul_i32 s28, s85, 10
  s_sub_u32 s84, s84, s28
  s_lshl_b32 s84, s84, 2
  s_and_b32 s85, s85, 3
  s_add_u32 s84, s84, s85
  s_lshl_b32 s84, s84, 7
  s_add_u32 s84, s84, 29077504
  v_mov_b32 v5, 0
  v_mov_b32 v6, 1
  s_mov_b64 exec, 1
  buffer_atomic_add v6, v5, s[12:15], s84 offen sc1
  s_mov_b64 exec, -1
sequential_preLN__ssm_conv_h3__mixer_s_mlp__prompt_kernel_sigc0c:
sequential_preLN__ssm_conv_h3__mixer_s_mlp__prompt_kernel_sigc0b:
  s_cmp_ge_u32 s2, 160
  s_cbranch_scc1 sequential_preLN__ssm_conv_h3__mixer_s_mlp__prompt_kernel_prep
  s_lshl_b32 s34, s10, 3
  v_add_u32 v8, s34, v3
  v_and_b32 v9, 15, v8
  v_xor_b32 v9, v9, v2
  s_lshl_b32 s29, s24, 5
  v_add_u32 v10, s29, v8
  v_mul_u32_u24 v10, 1280, v10
  v_xor_b32 v11, 4, v9
  v_lshl_add_u32 v212, v9, 4, v10
  v_lshl_add_u32 v213, v11, 4, v10
  v_add_u32 v213, 5120, v213
  s_mul_i32 s26, s25, 10
  s_lshl_b32 s27, s10, 1
  s_add_u32 s26, s26, s27
  s_mul_i32 s26, s26, 20480
  s_add_u32 s26, s26, 5259264
  s_mul_i32 s27, s25, 10
  s_lshr_b32 s28, s10, 1
  s_add_u32 s27, s27, s28
  s_add_u32 s27, s27, 8
  s_mul_i32 s27, s27, 20480
  s_add_u32 s27, s27, 5259264
  s_add_u32 s28, s26, 20480
  s_cmp_eq_u32 s10, 0
  s_cbranch_scc1 sequential_preLN__ssm_conv_h3__mixer_s_mlp__prompt_kernel_noq0
  s_sub_u32 s36, s10, 1
  s_mul_i32 s36, s36, 3
  s_add_u32 s37, s36, 3
  s_min_u32 s37, s37, 8
  s_lshl_b32 s38, s24, 5
sequential_preLN__ssm_conv_h3__mixer_s_mlp__prompt_kernel_qgrp:
  s_lshl_b32 s39, s36, 2
  v_add_u32 v8, s39, v3
  v_and_b32 v9, 15, v8
  v_xor_b32 v9, v9, v2
  v_add_u32 v8, s38, v8
  v_mul_u32_u24 v8, 1280, v8
  v_lshl_add_u32 v8, v9, 4, v8
  s_mul_i32 s39, s36, 5120
  s_add_u32 m0, s39, 0
  s_nop 0
  buffer_load_dwordx4 v8, s[16:19], 0 offen offset:0 lds
  s_add_u32 m0, s39, 768
  s_nop 0
  buffer_load_dwordx4 v8, s[16:19], 0 offen offset:256 lds
  s_add_u32 m0, s39, 1536
  s_nop 0
  buffer_load_dwordx4 v8, s[16:19], 0 offen offset:512 lds
  s_add_u32 m0, s39, 2304
  s_nop 0
  buffer_load_dwordx4 v8, s[16:19], 0 offen offset:768 lds
  s_add_u32 m0, s39, 3072
  s_nop 0
  buffer_load_dwordx4 v8, s[16:19], 0 offen offset:1024 lds
  s_add_u32 s36, s36, 1
  s_cmp_lt_u32 s36, s37
  s_cbranch_scc1 sequential_preLN__ssm_conv_h3__mixer_s_mlp__prompt_kernel_qgrp
sequential_preLN__ssm_conv_h3__mixer_s_mlp__prompt_kernel_noq0:
  s_add_u32 s42, s82, 8768
  v_add_u32 v5, s42, v4
  v_alignbit_b32 v168, v129, v128, 16
  v_alignbit_b32 v169, v130, v129, 16
  v_alignbit_b32 v170, v131, v130, 16
  v_alignbit_b32 v171, v132, v131, 16
  ds_write_b128 v5, v[168:171] offset:0
  v_alignbit_b32 v172, v137, v136, 16
  v_alignbit_b32 v173, v138, v137, 16
  v_alignbit_b32 v174, v139, v138, 16
  v_alignbit_b32 v175, v140, v139, 16
  ds_write_b128 v5, v[172:175] offset:1024
  v_alignbit_b32 v168, v145, v144, 16
  v_alignbit_b32 v169, v146, v145, 16
  v_alignbit_b32 v170, v147, v146, 16
  v_alignbit_b32 v171, v148, v147, 16
  ds_write_b128 v5, v[168:171] offset:2048
  v_alignbit_b32 v172, v153, v152, 16
  v_alignbit_b32 v173, v154, v153, 16
  v_alignbit_b32 v174, v155, v154, 16
  v_alignbit_b32 v175, v156, v155, 16
  ds_write_b128 v5, v[172:175] offset:3072
  s_mov_b64 exec, 15
  v_alignbit_b32 v168, v161, v160, 16
  v_alignbit_b32 v169, v162, v161, 16
  v_alignbit_b32 v170, v163, v162, 16
  v_alignbit_b32 v171, v164, v163, 16
  ds_write_b128 v5, v[168:171] offset:4096
  s_mov_b64 exec, -1
  s_cmp_lg_u32 s10, 0
  s_cbranch_scc1 sequential_preLN__ssm_conv_h3__mixer_s_mlp__prompt_kernel_wt3
  s_lshr_b32 s84, s2, 4
  s_lshl_b32 s84, s84, 9
  s_add_u32 s84, s84, 29077504
  v_and_b32 v5, 3, v1
  v_lshlrev_b32 v5, 7, v5
  v_add_u32 v5, s84, v5
  v_mov_b32 v7, 8
  s_mov_b32 s85, 0
sequential_preLN__ssm_conv_h3__mixer_s_mlp__prompt_kernel_pl4_l:
  buffer_load_dword v6, v5, s[12:15], 0 offen sc1
  s_add_u32 s85, s85, 1
  s_waitcnt vmcnt(0)
  v_cmp_gt_u32 vcc, v7, v6
  s_cmp_gt_u32 s85, 200000
  s_cbranch_scc1 sequential_preLN__ssm_conv_h3__mixer_s_mlp__prompt_kernel_pl4
  s_nop 2
  s_nop 2
  s_cbranch_vccnz sequential_preLN__ssm_conv_h3__mixer_s_mlp__prompt_kernel_pl4_l
sequential_preLN__ssm_conv_h3__mixer_s_mlp__prompt_kernel_pl4:
sequential_preLN__ssm_conv_h3__mixer_s_mlp__prompt_kernel_wt3:
  s_barrier
  s_lshl_b32 s35, s83, 12
  s_add_u32 s36, s35, 0
  s_mov_b32 m0, s82
  s_nop 0
  buffer_load_dwordx4 v4, s[12:15], s36 offen offset:0 sc1 lds
  buffer_load_dwordx4 v4, s[12:15], s36 offen offset:1024 sc1 lds
  buffer_load_dwordx4 v4, s[12:15], s36 offen offset:2048 sc1 lds
  buffer_load_dwordx4 v4, s[12:15], s36 offen offset:3072 sc1 lds
  v_mov_b32 v8, 0
  v_mov_b32 v9, 0
  v_lshlrev_b32 v7, 3, v1
  v_add_u32 v7, s82, v7
  ds_write_b64 v7, v[8:9] offset:4096
  v_add_u32 v13, 1, v2
  v_and_b32 v14, 1, v13
  v_mul_u32_u24 v12, 4160, v14
  v_sub_u32 v13, v13, v14
  v_lshlrev_b32 v13, 1, v13
  v_lshl_add_u32 v13, v3, 4, v13
  s_add_u32 s38, s82, 4608
  v_add3_u32 v12, v12, v13, s38
  v_add_u32 v104, 1024, v12
  v_add_u32 v105, 2048, v12
  v_add_u32 v106, 3072, v12
  v_lshlrev_b32 v13, 5, v2
  v_lshlrev_b32 v14, 4, v3
  v_sub_u32 v13, v14, v13
  s_add_u32 s39, s82, 480
  v_add_u32 v13, s39, v13
  v_sub_u32 v16, 15, v2
  v_lshrrev_b32 v17, 3, v16
  v_and_b32 v16, 7, v16
  v_and_b32 v18, 1, v16
  v_lshlrev_b32 v18, 4, v18
  v_lshlrev_b32 v18, v18, v176
  v_cmp_eq_u32 vcc, v17, v3
  s_nop 1
  v_cndmask_b32 v18, 0, v18, vcc
  v_lshrrev_b32 v16, 1, v16
  v_cmp_eq_u32 vcc, 0, v16
  s_nop 1
  v_cndmask_b32 v100, 0, v18, vcc
  v_cmp_eq_u32 vcc, 1, v16
  s_nop 1
  v_cndmask_b32 v101, 0, v18, vcc
  v_cmp_eq_u32 vcc, 2, v16
  s_nop 1
  v_cndmask_b32 v102, 0, v18, vcc
  v_cmp_eq_u32 vcc, 3, v16
  s_nop 1
  v_cndmask_b32 v103, 0, v18, vcc
  s_waitcnt vmcnt(0) lgkmcnt(0)
  ds_read_b128 v[144:147], v13 offset:3584
  ds_read_b128 v[148:151], v13 offset:3072
  ds_read_b128 v[152:155], v13 offset:2560
  ds_read_b128 v[156:159], v13 offset:2048
  ds_read_b128 v[160:163], v13 offset:1536
  ds_read_b128 v[164:167], v13 offset:1024
  ds_read_b128 v[168:171], v13 offset:512
  ds_read_b128 v[172:175], v13 offset:0
  ds_read2_b32 v[48:49], v12 offset0:0 offset1:1
  ds_read2_b32 v[50:51], v12 offset0:2 offset1:3
  ds_read2_b32 v[52:53], v12 offset0:128 offset1:129
  ds_read2_b32 v[54:55], v12 offset0:130 offset1:131
  ds_read2_b32 v[56:57], v104 offset0:0 offset1:1
  ds_read2_b32 v[58:59], v104 offset0:2 offset1:3
  ds_read2_b32 v[60:61], v104 offset0:128 offset1:129
  ds_read2_b32 v[62:63], v104 offset0:130 offset1:131
  ds_read2_b32 v[64:65], v105 offset0:0 offset1:1
  ds_read2_b32 v[66:67], v105 offset0:2 offset1:3
  ds_read2_b32 v[68:69], v105 offset0:128 offset1:129
  ds_read2_b32 v[70:71], v105 offset0:130 offset1:131
  ds_read2_b32 v[72:73], v106 offset0:0 offset1:1
  ds_read2_b32 v[74:75], v106 offset0:2 offset1:3
  ds_read2_b32 v[76:77], v106 offset0:128 offset1:129
  ds_read2_b32 v[78:79], v106 offset0:130 offset1:131
  s_waitcnt lgkmcnt(0)
  v_mfma_f32_16x16x32_bf16 v[16:19], v[100:103], v[144:147], 0
  v_mfma_f32_16x16x32_bf16 v[20:23], v[100:103], v[148:151], 0
  v_mfma_f32_16x16x32_bf16 v[24:27], v[100:103], v[152:155], 0
  v_mfma_f32_16x16x32_bf16 v[28:31], v[100:103], v[156:159], 0
  v_mfma_f32_16x16x32_bf16 v[32:35], v[100:103], v[160:163], 0
  v_mfma_f32_16x16x32_bf16 v[36:39], v[100:103], v[164:167], 0
  v_mfma_f32_16x16x32_bf16 v[40:43], v[100:103], v[168:171], 0
  v_mfma_f32_16x16x32_bf16 v[44:47], v[100:103], v[172:175], 0
  v_mfma_f32_16x16x32_bf16 v[16:19], v[48:51], v[144:147], v[16:19]
  ds_read_b128 v[176:179], v13 offset:3648
  v_mfma_f32_16x16x32_bf16 v[20:23], v[48:51], v[148:151], v[20:23]
  ds_read_b128 v[180:183], v13 offset:3136
  v_mfma_f32_16x16x32_bf16 v[24:27], v[48:51], v[152:155], v[24:27]
  ds_read_b128 v[184:187], v13 offset:2624
  v_mfma_f32_16x16x32_bf16 v[28:31], v[48:51], v[156:159], v[28:31]
  ds_read_b128 v[188:191], v13 offset:2112
  v_mfma_f32_16x16x32_bf16 v[32:35], v[48:51], v[160:163], v[32:35]
  ds_read_b128 v[192:195], v13 offset:1600
  v_mfma_f32_16x16x32_bf16 v[36:39], v[48:51], v[164:167], v[36:39]
  ds_read_b128 v[196:199], v13 offset:1088
  v_mfma_f32_16x16x32_bf16 v[40:43], v[48:51], v[168:171], v[40:43]
  ds_read_b128 v[200:203], v13 offset:576
  v_mfma_f32_16x16x32_bf16 v[44:47], v[48:51], v[172:175], v[44:47]
  ds_read_b128 v[204:207], v13 offset:64
  v_mfma_f32_16x16x32_bf16 v[20:23], v[52:55], v[144:147], v[20:23]
  ds_read2_b32 v[112:113], v12 offset0:16 offset1:17
  v_mfma_f32_16x16x32_bf16 v[24:27], v[52:55], v[148:151], v[24:27]
  ds_read2_b32 v[114:115], v12 offset0:18 offset1:19
  v_mfma_f32_16x16x32_bf16 v[28:31], v[52:55], v[152:155], v[28:31]
  ds_read2_b32 v[116:117], v12 offset0:144 offset1:145
  v_mfma_f32_16x16x32_bf16 v[32:35], v[52:55], v[156:159], v[32:35]
  ds_read2_b32 v[118:119], v12 offset0:146 offset1:147
  v_mfma_f32_16x16x32_bf16 v[36:39], v[52:55], v[160:163], v[36:39]
  ds_read2_b32 v[120:121], v104 offset0:16 offset1:17
  v_mfma_f32_16x16x32_bf16 v[40:43], v[52:55], v[164:167], v[40:43]
  ds_read2_b32 v[122:123], v104 offset0:18 offset1:19
  v_mfma_f32_16x16x32_bf16 v[44:47], v[52:55], v[168:171], v[44:47]
  ds_read2_b32 v[124:125], v104 offset0:144 offset1:145
  v_mfma_f32_16x16x32_bf16 v[24:27], v[56:59], v[144:147], v[24:27]
  ds_read2_b32 v[126:127], v104 offset0:146 offset1:147
  v_mfma_f32_16x16x32_bf16 v[28:31], v[56:59], v[148:151], v[28:31]
  ds_read2_b32 v[128:129], v105 offset0:16 offset1:17
  v_mfma_f32_16x16x32_bf16 v[32:35], v[56:59], v[152:155], v[32:35]
  ds_read2_b32 v[130:131], v105 offset0:18 offset1:19
  v_mfma_f32_16x16x32_bf16 v[36:39], v[56:59], v[156:159], v[36:39]
  ds_read2_b32 v[132:133], v105 offset0:144 offset1:145
  v_mfma_f32_16x16x32_bf16 v[40:43], v[56:59], v[160:163], v[40:43]
  ds_read2_b32 v[134:135], v105 offset0:146 offset1:147
  v_mfma_f32_16x16x32_bf16 v[44:47], v[56:59], v[164:167], v[44:47]
  ds_read2_b32 v[136:137], v106 offset0:16 offset1:17
  v_mfma_f32_16x16x32_bf16 v[28:31], v[60:63], v[144:147], v[28:31]
  ds_read2_b32 v[138:139], v106 offset0:18 offset1:19
  v_mfma_f32_16x16x32_bf16 v[32:35], v[60:63], v[148:151], v[32:35]
  ds_read2_b32 v[140:141], v106 offset0:144 offset1:145
  v_mfma_f32_16x16x32_bf16 v[36:39], v[60:63], v[152:155], v[36:39]
  ds_read2_b32 v[142:143], v106 offset0:146 offset1:147
  v_mfma_f32_16x16x32_bf16 v[40:43], v[60:63], v[156:159], v[40:43]
  v_mfma_f32_16x16x32_bf16 v[44:47], v[60:63], v[160:163], v[44:47]
  v_mfma_f32_16x16x32_bf16 v[32:35], v[64:67], v[144:147], v[32:35]
  v_mfma_f32_16x16x32_bf16 v[36:39], v[64:67], v[148:151], v[36:39]
  v_mfma_f32_16x16x32_bf16 v[40:43], v[64:67], v[152:155], v[40:43]
  v_mfma_f32_16x16x32_bf16 v[44:47], v[64:67], v[156:159], v[44:47]
  v_mfma_f32_16x16x32_bf16 v[36:39], v[68:71], v[144:147], v[36:39]
  v_mfma_f32_16x16x32_bf16 v[40:43], v[68:71], v[148:151], v[40:43]
  v_mfma_f32_16x16x32_bf16 v[44:47], v[68:71], v[152:155], v[44:47]
  v_mfma_f32_16x16x32_bf16 v[40:43], v[72:75], v[144:147], v[40:43]
  v_mfma_f32_16x16x32_bf16 v[44:47], v[72:75], v[148:151], v[44:47]
  v_mfma_f32_16x16x32_bf16 v[44:47], v[76:79], v[144:147], v[44:47]
  s_waitcnt lgkmcnt(0)
  v_mov_b32 v220, 29084928
  buffer_load_dword v219, v220, s[12:15], 0 offen sc1
  v_mfma_f32_16x16x32_bf16 v[16:19], v[112:115], v[176:179], v[16:19]
  ds_read_b128 v[144:147], v13 offset:3712
  v_mfma_f32_16x16x32_bf16 v[20:23], v[112:115], v[180:183], v[20:23]
  ds_read_b128 v[148:151], v13 offset:3200
  v_mfma_f32_16x16x32_bf16 v[24:27], v[112:115], v[184:187], v[24:27]
  ds_read_b128 v[152:155], v13 offset:2688
  v_mfma_f32_16x16x32_bf16 v[28:31], v[112:115], v[188:191], v[28:31]
  ds_read_b128 v[156:159], v13 offset:2176
  v_mfma_f32_16x16x32_bf16 v[32:35], v[112:115], v[192:195], v[32:35]
  ds_read_b128 v[160:163], v13 offset:1664
  v_mfma_f32_16x16x32_bf16 v[36:39], v[112:115], v[196:199], v[36:39]
  ds_read_b128 v[164:167], v13 offset:1152
  v_mfma_f32_16x16x32_bf16 v[40:43], v[112:115], v[200:203], v[40:43]
  ds_read_b128 v[168:171], v13 offset:640
  v_mfma_f32_16x16x32_bf16 v[44:47], v[112:115], v[204:207], v[44:47]
  ds_read_b128 v[172:175], v13 offset:128
  v_mfma_f32_16x16x32_bf16 v[20:23], v[116:119], v[176:179], v[20:23]
  ds_read2_b32 v[48:49], v12 offset0:32 offset1:33
  v_mfma_f32_16x16x32_bf16 v[24:27], v[116:119], v[180:183], v[24:27]
  ds_read2_b32 v[50:51], v12 offset0:34 offset1:35
  v_mfma_f32_16x16x32_bf16 v[28:31], v[116:119], v[184:187], v[28:31]
  ds_read2_b32 v[52:53], v12 offset0:160 offset1:161
  v_mfma_f32_16x16x32_bf16 v[32:35], v[116:119], v[188:191], v[32:35]
  ds_read2_b32 v[54:55], v12 offset0:162 offset1:163
  v_mfma_f32_16x16x32_bf16 v[36:39], v[116:119], v[192:195], v[36:39]
  ds_read2_b32 v[56:57], v104 offset0:32 offset1:33
  v_mfma_f32_16x16x32_bf16 v[40:43], v[116:119], v[196:199], v[40:43]
  ds_read2_b32 v[58:59], v104 offset0:34 offset1:35
  v_mfma_f32_16x16x32_bf16 v[44:47], v[116:119], v[200:203], v[44:47]
  ds_read2_b32 v[60:61], v104 offset0:160 offset1:161
  v_mfma_f32_16x16x32_bf16 v[24:27], v[120:123], v[176:179], v[24:27]
  ds_read2_b32 v[62:63], v104 offset0:162 offset1:163
  v_mfma_f32_16x16x32_bf16 v[28:31], v[120:123], v[180:183], v[28:31]
  ds_read2_b32 v[64:65], v105 offset0:32 offset1:33
  v_mfma_f32_16x16x32_bf16 v[32:35], v[120:123], v[184:187], v[32:35]
  ds_read2_b32 v[66:67], v105 offset0:34 offset1:35
  v_mfma_f32_16x16x32_bf16 v[36:39], v[120:123], v[188:191], v[36:39]
  ds_read2_b32 v[68:69], v105 offset0:160 offset1:161
  v_mfma_f32_16x16x32_bf16 v[40:43], v[120:123], v[192:195], v[40:43]
  ds_read2_b32 v[70:71], v105 offset0:162 offset1:163
  v_mfma_f32_16x16x32_bf16 v[44:47], v[120:123], v[196:199], v[44:47]
  ds_read2_b32 v[72:73], v106 offset0:32 offset1:33
  v_mfma_f32_16x16x32_bf16 v[28:31], v[124:127], v[176:179], v[28:31]
  ds_read2_b32 v[74:75], v106 offset0:34 offset1:35
  v_mfma_f32_16x16x32_bf16 v[32:35], v[124:127], v[180:183], v[32:35]
  ds_read2_b32 v[76:77], v106 offset0:160 offset1:161
  v_mfma_f32_16x16x32_bf16 v[36:39], v[124:127], v[184:187], v[36:39]
  ds_read2_b32 v[78:79], v106 offset0:162 offset1:163
  v_mfma_f32_16x16x32_bf16 v[40:43], v[124:127], v[188:191], v[40:43]
  v_mfma_f32_16x16x32_bf16 v[44:47], v[124:127], v[192:195], v[44:47]
  v_mfma_f32_16x16x32_bf16 v[32:35], v[128:131], v[176:179], v[32:35]
  v_mfma_f32_16x16x32_bf16 v[36:39], v[128:131], v[180:183], v[36:39]
  v_mfma_f32_16x16x32_bf16 v[40:43], v[128:131], v[184:187], v[40:43]
  v_mfma_f32_16x16x32_bf16 v[44:47], v[128:131], v[188:191], v[44:47]
  v_mfma_f32_16x16x32_bf16 v[36:39], v[132:135], v[176:179], v[36:39]
  v_mfma_f32_16x16x32_bf16 v[40:43], v[132:135], v[180:183], v[40:43]
  v_mfma_f32_16x16x32_bf16 v[44:47], v[132:135], v[184:187], v[44:47]
  v_mfma_f32_16x16x32_bf16 v[40:43], v[136:139], v[176:179], v[40:43]
  v_mfma_f32_16x16x32_bf16 v[44:47], v[136:139], v[180:183], v[44:47]
  v_mfma_f32_16x16x32_bf16 v[44:47], v[140:143], v[176:179], v[44:47]
  s_waitcnt lgkmcnt(0)
  s_waitcnt vmcnt(0)
  v_cmp_eq_u32 vcc, 0, v219
  s_nop 4
  s_cbranch_vccz sequential_preLN__ssm_conv_h3__mixer_s_mlp__prompt_kernel_cpaok5
  v_mov_b32 v5, 29084928
  v_mov_b32 v7, 1
  s_mov_b32 s85, 0
sequential_preLN__ssm_conv_h3__mixer_s_mlp__prompt_kernel_pl6_l:
  buffer_load_dword v6, v5, s[12:15], 0 offen sc1
  s_add_u32 s85, s85, 1
  s_waitcnt vmcnt(0)
  v_cmp_gt_u32 vcc, v7, v6
  s_cmp_gt_u32 s85, 200000
  s_cbranch_scc1 sequential_preLN__ssm_conv_h3__mixer_s_mlp__prompt_kernel_pl6
  s_nop 2
  s_nop 2
  s_cbranch_vccnz sequential_preLN__ssm_conv_h3__mixer_s_mlp__prompt_kernel_pl6_l
sequential_preLN__ssm_conv_h3__mixer_s_mlp__prompt_kernel_pl6:
sequential_preLN__ssm_conv_h3__mixer_s_mlp__prompt_kernel_cpaok5:
  v_mfma_f32_16x16x32_bf16 v[16:19], v[48:51], v[144:147], v[16:19]
  ds_read_b128 v[176:179], v13 offset:3776
  v_mfma_f32_16x16x32_bf16 v[20:23], v[48:51], v[148:151], v[20:23]
  ds_read_b128 v[180:183], v13 offset:3264
  buffer_load_dwordx4 a[0:3], v4, s[12:15], s26 offen offset:0 sc1
  v_mfma_f32_16x16x32_bf16 v[24:27], v[48:51], v[152:155], v[24:27]
  ds_read_b128 v[184:187], v13 offset:2752
  v_mfma_f32_16x16x32_bf16 v[28:31], v[48:51], v[156:159], v[28:31]
  ds_read_b128 v[188:191], v13 offset:2240
  v_mfma_f32_16x16x32_bf16 v[32:35], v[48:51], v[160:163], v[32:35]
  ds_read_b128 v[192:195], v13 offset:1728
  v_mfma_f32_16x16x32_bf16 v[36:39], v[48:51], v[164:167], v[36:39]
  ds_read_b128 v[196:199], v13 offset:1216
  v_mfma_f32_16x16x32_bf16 v[40:43], v[48:51], v[168:171], v[40:43]
  ds_read_b128 v[200:203], v13 offset:704
  v_mfma_f32_16x16x32_bf16 v[44:47], v[48:51], v[172:175], v[44:47]
  ds_read_b128 v[204:207], v13 offset:192
  buffer_load_dwordx4 a[80:83], v4, s[12:15], s28 offen offset:0 sc1
  v_mfma_f32_16x16x32_bf16 v[20:23], v[52:55], v[144:147], v[20:23]
  ds_read2_b32 v[112:113], v12 offset0:48 offset1:49
  v_mfma_f32_16x16x32_bf16 v[24:27], v[52:55], v[148:151], v[24:27]
  ds_read2_b32 v[114:115], v12 offset0:50 offset1:51
  v_mfma_f32_16x16x32_bf16 v[28:31], v[52:55], v[152:155], v[28:31]
  ds_read2_b32 v[116:117], v12 offset0:176 offset1:177
  v_mfma_f32_16x16x32_bf16 v[32:35], v[52:55], v[156:159], v[32:35]
  ds_read2_b32 v[118:119], v12 offset0:178 offset1:179
  v_mfma_f32_16x16x32_bf16 v[36:39], v[52:55], v[160:163], v[36:39]
  ds_read2_b32 v[120:121], v104 offset0:48 offset1:49
  v_mfma_f32_16x16x32_bf16 v[40:43], v[52:55], v[164:167], v[40:43]
  ds_read2_b32 v[122:123], v104 offset0:50 offset1:51
  buffer_load_dwordx4 a[160:163], v4, s[12:15], s27 offen offset:0 sc1
  v_mfma_f32_16x16x32_bf16 v[44:47], v[52:55], v[168:171], v[44:47]
  ds_read2_b32 v[124:125], v104 offset0:176 offset1:177
  v_mfma_f32_16x16x32_bf16 v[24:27], v[56:59], v[144:147], v[24:27]
  ds_read2_b32 v[126:127], v104 offset0:178 offset1:179
  v_mfma_f32_16x16x32_bf16 v[28:31], v[56:59], v[148:151], v[28:31]
  ds_read2_b32 v[128:129], v105 offset0:48 offset1:49
  v_mfma_f32_16x16x32_bf16 v[32:35], v[56:59], v[152:155], v[32:35]
  ds_read2_b32 v[130:131], v105 offset0:50 offset1:51
  v_mfma_f32_16x16x32_bf16 v[36:39], v[56:59], v[156:159], v[36:39]
  ds_read2_b32 v[132:133], v105 offset0:176 offset1:177
  v_mfma_f32_16x16x32_bf16 v[40:43], v[56:59], v[160:163], v[40:43]
  ds_read2_b32 v[134:135], v105 offset0:178 offset1:179
  buffer_load_dwordx4 a[4:7], v4, s[12:15], s26 offen offset:1024 sc1
  v_mfma_f32_16x16x32_bf16 v[44:47], v[56:59], v[164:167], v[44:47]
  ds_read2_b32 v[136:137], v106 offset0:48 offset1:49
  v_mfma_f32_16x16x32_bf16 v[28:31], v[60:63], v[144:147], v[28:31]
  ds_read2_b32 v[138:139], v106 offset0:50 offset1:51
  v_mfma_f32_16x16x32_bf16 v[32:35], v[60:63], v[148:151], v[32:35]
  ds_read2_b32 v[140:141], v106 offset0:176 offset1:177
  v_mfma_f32_16x16x32_bf16 v[36:39], v[60:63], v[152:155], v[36:39]
  ds_read2_b32 v[142:143], v106 offset0:178 offset1:179
  v_mfma_f32_16x16x32_bf16 v[40:43], v[60:63], v[156:159], v[40:43]
  v_mfma_f32_16x16x32_bf16 v[44:47], v[60:63], v[160:163], v[44:47]
  buffer_load_dwordx4 a[84:87], v4, s[12:15], s28 offen offset:1024 sc1
  v_mfma_f32_16x16x32_bf16 v[32:35], v[64:67], v[144:147], v[32:35]
  v_mfma_f32_16x16x32_bf16 v[36:39], v[64:67], v[148:151], v[36:39]
  v_mfma_f32_16x16x32_bf16 v[40:43], v[64:67], v[152:155], v[40:43]
  v_mfma_f32_16x16x32_bf16 v[44:47], v[64:67], v[156:159], v[44:47]
  v_mfma_f32_16x16x32_bf16 v[36:39], v[68:71], v[144:147], v[36:39]
  v_mfma_f32_16x16x32_bf16 v[40:43], v[68:71], v[148:151], v[40:43]
  buffer_load_dwordx4 a[164:167], v4, s[12:15], s27 offen offset:1024 sc1
  v_mfma_f32_16x16x32_bf16 v[44:47], v[68:71], v[152:155], v[44:47]
  v_mfma_f32_16x16x32_bf16 v[40:43], v[72:75], v[144:147], v[40:43]
  v_mfma_f32_16x16x32_bf16 v[44:47], v[72:75], v[148:151], v[44:47]
  v_mfma_f32_16x16x32_bf16 v[44:47], v[76:79], v[144:147], v[44:47]
  s_waitcnt lgkmcnt(0)
  v_mfma_f32_16x16x32_bf16 v[16:19], v[112:115], v[176:179], v[16:19]
  ds_read_b128 v[144:147], v13 offset:3840
  v_mfma_f32_16x16x32_bf16 v[20:23], v[112:115], v[180:183], v[20:23]
  ds_read_b128 v[148:151], v13 offset:3328
  buffer_load_dwordx4 a[8:11], v4, s[12:15], s26 offen offset:2048 sc1
  v_mfma_f32_16x16x32_bf16 v[24:27], v[112:115], v[184:187], v[24:27]
  ds_read_b128 v[152:155], v13 offset:2816
  v_mfma_f32_16x16x32_bf16 v[28:31], v[112:115], v[188:191], v[28:31]
  ds_read_b128 v[156:159], v13 offset:2304
  v_mfma_f32_16x16x32_bf16 v[32:35], v[112:115], v[192:195], v[32:35]
  ds_read_b128 v[160:163], v13 offset:1792
  v_mfma_f32_16x16x32_bf16 v[36:39], v[112:115], v[196:199], v[36:39]
  ds_read_b128 v[164:167], v13 offset:1280
  v_mfma_f32_16x16x32_bf16 v[40:43], v[112:115], v[200:203], v[40:43]
  ds_read_b128 v[168:171], v13 offset:768
  v_mfma_f32_16x16x32_bf16 v[44:47], v[112:115], v[204:207], v[44:47]
  ds_read_b128 v[172:175], v13 offset:256
  buffer_load_dwordx4 a[88:91], v4, s[12:15], s28 offen offset:2048 sc1
  v_mfma_f32_16x16x32_bf16 v[20:23], v[116:119], v[176:179], v[20:23]
  ds_read2_b32 v[48:49], v12 offset0:64 offset1:65
  v_mfma_f32_16x16x32_bf16 v[24:27], v[116:119], v[180:183], v[24:27]
  ds_read2_b32 v[50:51], v12 offset0:66 offset1:67
  v_mfma_f32_16x16x32_bf16 v[28:31], v[116:119], v[184:187], v[28:31]
  ds_read2_b32 v[52:53], v12 offset0:192 offset1:193
  v_mfma_f32_16x16x32_bf16 v[32:35], v[116:119], v[188:191], v[32:35]
  ds_read2_b32 v[54:55], v12 offset0:194 offset1:195
  v_mfma_f32_16x16x32_bf16 v[36:39], v[116:119], v[192:195], v[36:39]
  ds_read2_b32 v[56:57], v104 offset0:64 offset1:65
  v_mfma_f32_16x16x32_bf16 v[40:43], v[116:119], v[196:199], v[40:43]
  ds_read2_b32 v[58:59], v104 offset0:66 offset1:67
  buffer_load_dwordx4 a[168:171], v4, s[12:15], s27 offen offset:2048 sc1
  v_mfma_f32_16x16x32_bf16 v[44:47], v[116:119], v[200:203], v[44:47]
  ds_read2_b32 v[60:61], v104 offset0:192 offset1:193
  v_mfma_f32_16x16x32_bf16 v[24:27], v[120:123], v[176:179], v[24:27]
  ds_read2_b32 v[62:63], v104 offset0:194 offset1:195
  v_mfma_f32_16x16x32_bf16 v[28:31], v[120:123], v[180:183], v[28:31]
  ds_read2_b32 v[64:65], v105 offset0:64 offset1:65
  v_mfma_f32_16x16x32_bf16 v[32:35], v[120:123], v[184:187], v[32:35]
  ds_read2_b32 v[66:67], v105 offset0:66 offset1:67
  v_mfma_f32_16x16x32_bf16 v[36:39], v[120:123], v[188:191], v[36:39]
  ds_read2_b32 v[68:69], v105 offset0:192 offset1:193
  v_mfma_f32_16x16x32_bf16 v[40:43], v[120:123], v[192:195], v[40:43]
  ds_read2_b32 v[70:71], v105 offset0:194 offset1:195
  buffer_load_dwordx4 a[12:15], v4, s[12:15], s26 offen offset:3072 sc1
  v_mfma_f32_16x16x32_bf16 v[44:47], v[120:123], v[196:199], v[44:47]
  ds_read2_b32 v[72:73], v106 offset0:64 offset1:65
  v_mfma_f32_16x16x32_bf16 v[28:31], v[124:127], v[176:179], v[28:31]
  ds_read2_b32 v[74:75], v106 offset0:66 offset1:67
  v_mfma_f32_16x16x32_bf16 v[32:35], v[124:127], v[180:183], v[32:35]
  ds_read2_b32 v[76:77], v106 offset0:192 offset1:193
  v_mfma_f32_16x16x32_bf16 v[36:39], v[124:127], v[184:187], v[36:39]
  ds_read2_b32 v[78:79], v106 offset0:194 offset1:195
  v_mfma_f32_16x16x32_bf16 v[40:43], v[124:127], v[188:191], v[40:43]
  v_mfma_f32_16x16x32_bf16 v[44:47], v[124:127], v[192:195], v[44:47]
  buffer_load_dwordx4 a[92:95], v4, s[12:15], s28 offen offset:3072 sc1
  v_mfma_f32_16x16x32_bf16 v[32:35], v[128:131], v[176:179], v[32:35]
  v_mfma_f32_16x16x32_bf16 v[36:39], v[128:131], v[180:183], v[36:39]
  v_mfma_f32_16x16x32_bf16 v[40:43], v[128:131], v[184:187], v[40:43]
  v_mfma_f32_16x16x32_bf16 v[44:47], v[128:131], v[188:191], v[44:47]
  v_mfma_f32_16x16x32_bf16 v[36:39], v[132:135], v[176:179], v[36:39]
  v_mfma_f32_16x16x32_bf16 v[40:43], v[132:135], v[180:183], v[40:43]
  buffer_load_dwordx4 a[172:175], v4, s[12:15], s27 offen offset:3072 sc1
  v_mfma_f32_16x16x32_bf16 v[44:47], v[132:135], v[184:187], v[44:47]
  v_mfma_f32_16x16x32_bf16 v[40:43], v[136:139], v[176:179], v[40:43]
  v_mfma_f32_16x16x32_bf16 v[44:47], v[136:139], v[180:183], v[44:47]
  v_mfma_f32_16x16x32_bf16 v[44:47], v[140:143], v[176:179], v[44:47]
  s_waitcnt lgkmcnt(0)
  v_mfma_f32_16x16x32_bf16 v[16:19], v[48:51], v[144:147], v[16:19]
  ds_read_b128 v[176:179], v13 offset:3904
  v_mfma_f32_16x16x32_bf16 v[20:23], v[48:51], v[148:151], v[20:23]
  ds_read_b128 v[180:183], v13 offset:3392
  s_add_u32 s26, s26, 4096
  buffer_load_dwordx4 a[16:19], v4, s[12:15], s26 offen offset:0 sc1
  v_mfma_f32_16x16x32_bf16 v[24:27], v[48:51], v[152:155], v[24:27]
  ds_read_b128 v[184:187], v13 offset:2880
  v_mfma_f32_16x16x32_bf16 v[28:31], v[48:51], v[156:159], v[28:31]
  ds_read_b128 v[188:191], v13 offset:2368
  v_mfma_f32_16x16x32_bf16 v[32:35], v[48:51], v[160:163], v[32:35]
  ds_read_b128 v[192:195], v13 offset:1856
  v_mfma_f32_16x16x32_bf16 v[36:39], v[48:51], v[164:167], v[36:39]
  ds_read_b128 v[196:199], v13 offset:1344
  v_mfma_f32_16x16x32_bf16 v[40:43], v[48:51], v[168:171], v[40:43]
  ds_read_b128 v[200:203], v13 offset:832
  v_mfma_f32_16x16x32_bf16 v[44:47], v[48:51], v[172:175], v[44:47]
  ds_read_b128 v[204:207], v13 offset:320
  s_add_u32 s28, s28, 4096
  buffer_load_dwordx4 a[96:99], v4, s[12:15], s28 offen offset:0 sc1
  v_mfma_f32_16x16x32_bf16 v[20:23], v[52:55], v[144:147], v[20:23]
  ds_read2_b32 v[112:113], v12 offset0:80 offset1:81
  v_mfma_f32_16x16x32_bf16 v[24:27], v[52:55], v[148:151], v[24:27]
  ds_read2_b32 v[114:115], v12 offset0:82 offset1:83
  v_mfma_f32_16x16x32_bf16 v[28:31], v[52:55], v[152:155], v[28:31]
  ds_read2_b32 v[116:117], v12 offset0:208 offset1:209
  v_mfma_f32_16x16x32_bf16 v[32:35], v[52:55], v[156:159], v[32:35]
  ds_read2_b32 v[118:119], v12 offset0:210 offset1:211
  v_mfma_f32_16x16x32_bf16 v[36:39], v[52:55], v[160:163], v[36:39]
  ds_read2_b32 v[120:121], v104 offset0:80 offset1:81
  v_mfma_f32_16x16x32_bf16 v[40:43], v[52:55], v[164:167], v[40:43]
  ds_read2_b32 v[122:123], v104 offset0:82 offset1:83
  s_add_u32 s27, s27, 4096
  buffer_load_dwordx4 a[176:179], v4, s[12:15], s27 offen offset:0 sc1
  v_mfma_f32_16x16x32_bf16 v[44:47], v[52:55], v[168:171], v[44:47]
  ds_read2_b32 v[124:125], v104 offset0:208 offset1:209
  v_mfma_f32_16x16x32_bf16 v[24:27], v[56:59], v[144:147], v[24:27]
  ds_read2_b32 v[126:127], v104 offset0:210 offset1:211
  v_mfma_f32_16x16x32_bf16 v[28:31], v[56:59], v[148:151], v[28:31]
  ds_read2_b32 v[128:129], v105 offset0:80 offset1:81
  v_mfma_f32_16x16x32_bf16 v[32:35], v[56:59], v[152:155], v[32:35]
  ds_read2_b32 v[130:131], v105 offset0:82 offset1:83
  v_mfma_f32_16x16x32_bf16 v[36:39], v[56:59], v[156:159], v[36:39]
  ds_read2_b32 v[132:133], v105 offset0:208 offset1:209
  v_mfma_f32_16x16x32_bf16 v[40:43], v[56:59], v[160:163], v[40:43]
  ds_read2_b32 v[134:135], v105 offset0:210 offset1:211
  buffer_load_dwordx4 a[20:23], v4, s[12:15], s26 offen offset:1024 sc1
  v_mfma_f32_16x16x32_bf16 v[44:47], v[56:59], v[164:167], v[44:47]
  ds_read2_b32 v[136:137], v106 offset0:80 offset1:81
  v_mfma_f32_16x16x32_bf16 v[28:31], v[60:63], v[144:147], v[28:31]
  ds_read2_b32 v[138:139], v106 offset0:82 offset1:83
  v_mfma_f32_16x16x32_bf16 v[32:35], v[60:63], v[148:151], v[32:35]
  ds_read2_b32 v[140:141], v106 offset0:208 offset1:209
  v_mfma_f32_16x16x32_bf16 v[36:39], v[60:63], v[152:155], v[36:39]
  ds_read2_b32 v[142:143], v106 offset0:210 offset1:211
  v_mfma_f32_16x16x32_bf16 v[40:43], v[60:63], v[156:159], v[40:43]
  v_mfma_f32_16x16x32_bf16 v[44:47], v[60:63], v[160:163], v[44:47]
  buffer_load_dwordx4 a[100:103], v4, s[12:15], s28 offen offset:1024 sc1
  v_mfma_f32_16x16x32_bf16 v[32:35], v[64:67], v[144:147], v[32:35]
  v_mfma_f32_16x16x32_bf16 v[36:39], v[64:67], v[148:151], v[36:39]
  v_mfma_f32_16x16x32_bf16 v[40:43], v[64:67], v[152:155], v[40:43]
  v_mfma_f32_16x16x32_bf16 v[44:47], v[64:67], v[156:159], v[44:47]
  v_mfma_f32_16x16x32_bf16 v[36:39], v[68:71], v[144:147], v[36:39]
  v_mfma_f32_16x16x32_bf16 v[40:43], v[68:71], v[148:151], v[40:43]
  buffer_load_dwordx4 a[180:183], v4, s[12:15], s27 offen offset:1024 sc1
  v_mfma_f32_16x16x32_bf16 v[44:47], v[68:71], v[152:155], v[44:47]
  v_mfma_f32_16x16x32_bf16 v[40:43], v[72:75], v[144:147], v[40:43]
  v_mfma_f32_16x16x32_bf16 v[44:47], v[72:75], v[148:151], v[44:47]
  v_mfma_f32_16x16x32_bf16 v[44:47], v[76:79], v[144:147], v[44:47]
  s_waitcnt lgkmcnt(0)
  v_mfma_f32_16x16x32_bf16 v[16:19], v[112:115], v[176:179], v[16:19]
  ds_read_b128 v[144:147], v13 offset:3968
  v_mfma_f32_16x16x32_bf16 v[20:23], v[112:115], v[180:183], v[20:23]
  ds_read_b128 v[148:151], v13 offset:3456
  buffer_load_dwordx4 a[24:27], v4, s[12:15], s26 offen offset:2048 sc1
  v_mfma_f32_16x16x32_bf16 v[24:27], v[112:115], v[184:187], v[24:27]
  ds_read_b128 v[152:155], v13 offset:2944
  v_mfma_f32_16x16x32_bf16 v[28:31], v[112:115], v[188:191], v[28:31]
  ds_read_b128 v[156:159], v13 offset:2432
  v_mfma_f32_16x16x32_bf16 v[32:35], v[112:115], v[192:195], v[32:35]
  ds_read_b128 v[160:163], v13 offset:1920
  v_mfma_f32_16x16x32_bf16 v[36:39], v[112:115], v[196:199], v[36:39]
  ds_read_b128 v[164:167], v13 offset:1408
  v_mfma_f32_16x16x32_bf16 v[40:43], v[112:115], v[200:203], v[40:43]
  ds_read_b128 v[168:171], v13 offset:896
  v_mfma_f32_16x16x32_bf16 v[44:47], v[112:115], v[204:207], v[44:47]
  ds_read_b128 v[172:175], v13 offset:384
  buffer_load_dwordx4 a[104:107], v4, s[12:15], s28 offen offset:2048 sc1
  v_mfma_f32_16x16x32_bf16 v[20:23], v[116:119], v[176:179], v[20:23]
  ds_read2_b32 v[48:49], v12 offset0:96 offset1:97
  v_mfma_f32_16x16x32_bf16 v[24:27], v[116:119], v[180:183], v[24:27]
  ds_read2_b32 v[50:51], v12 offset0:98 offset1:99
  v_mfma_f32_16x16x32_bf16 v[28:31], v[116:119], v[184:187], v[28:31]
  ds_read2_b32 v[52:53], v12 offset0:224 offset1:225
  v_mfma_f32_16x16x32_bf16 v[32:35], v[116:119], v[188:191], v[32:35]
  ds_read2_b32 v[54:55], v12 offset0:226 offset1:227
  v_mfma_f32_16x16x32_bf16 v[36:39], v[116:119], v[192:195], v[36:39]
  ds_read2_b32 v[56:57], v104 offset0:96 offset1:97
  v_mfma_f32_16x16x32_bf16 v[40:43], v[116:119], v[196:199], v[40:43]
  ds_read2_b32 v[58:59], v104 offset0:98 offset1:99
  buffer_load_dwordx4 a[184:187], v4, s[12:15], s27 offen offset:2048 sc1
  v_mfma_f32_16x16x32_bf16 v[44:47], v[116:119], v[200:203], v[44:47]
  ds_read2_b32 v[60:61], v104 offset0:224 offset1:225
  v_mfma_f32_16x16x32_bf16 v[24:27], v[120:123], v[176:179], v[24:27]
  ds_read2_b32 v[62:63], v104 offset0:226 offset1:227
  v_mfma_f32_16x16x32_bf16 v[28:31], v[120:123], v[180:183], v[28:31]
  ds_read2_b32 v[64:65], v105 offset0:96 offset1:97
  v_mfma_f32_16x16x32_bf16 v[32:35], v[120:123], v[184:187], v[32:35]
  ds_read2_b32 v[66:67], v105 offset0:98 offset1:99
  v_mfma_f32_16x16x32_bf16 v[36:39], v[120:123], v[188:191], v[36:39]
  ds_read2_b32 v[68:69], v105 offset0:224 offset1:225
  v_mfma_f32_16x16x32_bf16 v[40:43], v[120:123], v[192:195], v[40:43]
  ds_read2_b32 v[70:71], v105 offset0:226 offset1:227
  buffer_load_dwordx4 a[28:31], v4, s[12:15], s26 offen offset:3072 sc1
  v_mfma_f32_16x16x32_bf16 v[44:47], v[120:123], v[196:199], v[44:47]
  ds_read2_b32 v[72:73], v106 offset0:96 offset1:97
  v_mfma_f32_16x16x32_bf16 v[28:31], v[124:127], v[176:179], v[28:31]
  ds_read2_b32 v[74:75], v106 offset0:98 offset1:99
  v_mfma_f32_16x16x32_bf16 v[32:35], v[124:127], v[180:183], v[32:35]
  ds_read2_b32 v[76:77], v106 offset0:224 offset1:225
  v_mfma_f32_16x16x32_bf16 v[36:39], v[124:127], v[184:187], v[36:39]
  ds_read2_b32 v[78:79], v106 offset0:226 offset1:227
  v_mfma_f32_16x16x32_bf16 v[40:43], v[124:127], v[188:191], v[40:43]
  v_mfma_f32_16x16x32_bf16 v[44:47], v[124:127], v[192:195], v[44:47]
  buffer_load_dwordx4 a[108:111], v4, s[12:15], s28 offen offset:3072 sc1
  v_mfma_f32_16x16x32_bf16 v[32:35], v[128:131], v[176:179], v[32:35]
  v_mfma_f32_16x16x32_bf16 v[36:39], v[128:131], v[180:183], v[36:39]
  v_mfma_f32_16x16x32_bf16 v[40:43], v[128:131], v[184:187], v[40:43]
  v_mfma_f32_16x16x32_bf16 v[44:47], v[128:131], v[188:191], v[44:47]
  v_mfma_f32_16x16x32_bf16 v[36:39], v[132:135], v[176:179], v[36:39]
  v_mfma_f32_16x16x32_bf16 v[40:43], v[132:135], v[180:183], v[40:43]
  buffer_load_dwordx4 a[188:191], v4, s[12:15], s27 offen offset:3072 sc1
  v_mfma_f32_16x16x32_bf16 v[44:47], v[132:135], v[184:187], v[44:47]
  v_mfma_f32_16x16x32_bf16 v[40:43], v[136:139], v[176:179], v[40:43]
  v_mfma_f32_16x16x32_bf16 v[44:47], v[136:139], v[180:183], v[44:47]
  v_mfma_f32_16x16x32_bf16 v[44:47], v[140:143], v[176:179], v[44:47]
  s_waitcnt lgkmcnt(0)
  v_mfma_f32_16x16x32_bf16 v[16:19], v[48:51], v[144:147], v[16:19]
  ds_read_b128 v[176:179], v13 offset:4032
  v_mfma_f32_16x16x32_bf16 v[20:23], v[48:51], v[148:151], v[20:23]
  ds_read_b128 v[180:183], v13 offset:3520
  s_add_u32 s26, s26, 4096
  buffer_load_dwordx4 a[32:35], v4, s[12:15], s26 offen offset:0 sc1
  v_mfma_f32_16x16x32_bf16 v[24:27], v[48:51], v[152:155], v[24:27]
  ds_read_b128 v[184:187], v13 offset:3008
  v_mfma_f32_16x16x32_bf16 v[28:31], v[48:51], v[156:159], v[28:31]
  ds_read_b128 v[188:191], v13 offset:2496
  v_mfma_f32_16x16x32_bf16 v[32:35], v[48:51], v[160:163], v[32:35]
  ds_read_b128 v[192:195], v13 offset:1984
  v_mfma_f32_16x16x32_bf16 v[36:39], v[48:51], v[164:167], v[36:39]
  ds_read_b128 v[196:199], v13 offset:1472
  v_mfma_f32_16x16x32_bf16 v[40:43], v[48:51], v[168:171], v[40:43]
  ds_read_b128 v[200:203], v13 offset:960
  v_mfma_f32_16x16x32_bf16 v[44:47], v[48:51], v[172:175], v[44:47]
  ds_read_b128 v[204:207], v13 offset:448
  s_add_u32 s28, s28, 4096
  buffer_load_dwordx4 a[112:115], v4, s[12:15], s28 offen offset:0 sc1
  v_mfma_f32_16x16x32_bf16 v[20:23], v[52:55], v[144:147], v[20:23]
  ds_read2_b32 v[112:113], v12 offset0:112 offset1:113
  v_mfma_f32_16x16x32_bf16 v[24:27], v[52:55], v[148:151], v[24:27]
  ds_read2_b32 v[114:115], v12 offset0:114 offset1:115
  v_mfma_f32_16x16x32_bf16 v[28:31], v[52:55], v[152:155], v[28:31]
  ds_read2_b32 v[116:117], v12 offset0:240 offset1:241
  v_mfma_f32_16x16x32_bf16 v[32:35], v[52:55], v[156:159], v[32:35]
  ds_read2_b32 v[118:119], v12 offset0:242 offset1:243
  v_mfma_f32_16x16x32_bf16 v[36:39], v[52:55], v[160:163], v[36:39]
  ds_read2_b32 v[120:121], v104 offset0:112 offset1:113
  v_mfma_f32_16x16x32_bf16 v[40:43], v[52:55], v[164:167], v[40:43]
  ds_read2_b32 v[122:123], v104 offset0:114 offset1:115
  s_add_u32 s27, s27, 4096
  buffer_load_dwordx4 a[192:195], v4, s[12:15], s27 offen offset:0 sc1
  v_mfma_f32_16x16x32_bf16 v[44:47], v[52:55], v[168:171], v[44:47]
  ds_read2_b32 v[124:125], v104 offset0:240 offset1:241
  v_mfma_f32_16x16x32_bf16 v[24:27], v[56:59], v[144:147], v[24:27]
  ds_read2_b32 v[126:127], v104 offset0:242 offset1:243
  v_mfma_f32_16x16x32_bf16 v[28:31], v[56:59], v[148:151], v[28:31]
  ds_read2_b32 v[128:129], v105 offset0:112 offset1:113
  v_mfma_f32_16x16x32_bf16 v[32:35], v[56:59], v[152:155], v[32:35]
  ds_read2_b32 v[130:131], v105 offset0:114 offset1:115
  v_mfma_f32_16x16x32_bf16 v[36:39], v[56:59], v[156:159], v[36:39]
  ds_read2_b32 v[132:133], v105 offset0:240 offset1:241
  v_mfma_f32_16x16x32_bf16 v[40:43], v[56:59], v[160:163], v[40:43]
  ds_read2_b32 v[134:135], v105 offset0:242 offset1:243
  buffer_load_dwordx4 a[36:39], v4, s[12:15], s26 offen offset:1024 sc1
  v_mfma_f32_16x16x32_bf16 v[44:47], v[56:59], v[164:167], v[44:47]
  ds_read2_b32 v[136:137], v106 offset0:112 offset1:113
  v_mfma_f32_16x16x32_bf16 v[28:31], v[60:63], v[144:147], v[28:31]
  ds_read2_b32 v[138:139], v106 offset0:114 offset1:115
  v_mfma_f32_16x16x32_bf16 v[32:35], v[60:63], v[148:151], v[32:35]
  ds_read2_b32 v[140:141], v106 offset0:240 offset1:241
  v_mfma_f32_16x16x32_bf16 v[36:39], v[60:63], v[152:155], v[36:39]
  ds_read2_b32 v[142:143], v106 offset0:242 offset1:243
  v_mfma_f32_16x16x32_bf16 v[40:43], v[60:63], v[156:159], v[40:43]
  v_mfma_f32_16x16x32_bf16 v[44:47], v[60:63], v[160:163], v[44:47]
  buffer_load_dwordx4 a[116:119], v4, s[12:15], s28 offen offset:1024 sc1
  v_mfma_f32_16x16x32_bf16 v[32:35], v[64:67], v[144:147], v[32:35]
  v_mfma_f32_16x16x32_bf16 v[36:39], v[64:67], v[148:151], v[36:39]
  v_mfma_f32_16x16x32_bf16 v[40:43], v[64:67], v[152:155], v[40:43]
  v_mfma_f32_16x16x32_bf16 v[44:47], v[64:67], v[156:159], v[44:47]
  v_mfma_f32_16x16x32_bf16 v[36:39], v[68:71], v[144:147], v[36:39]
  v_mfma_f32_16x16x32_bf16 v[40:43], v[68:71], v[148:151], v[40:43]
  buffer_load_dwordx4 a[196:199], v4, s[12:15], s27 offen offset:1024 sc1
  v_mfma_f32_16x16x32_bf16 v[44:47], v[68:71], v[152:155], v[44:47]
  v_mfma_f32_16x16x32_bf16 v[40:43], v[72:75], v[144:147], v[40:43]
  v_mfma_f32_16x16x32_bf16 v[44:47], v[72:75], v[148:151], v[44:47]
  v_mfma_f32_16x16x32_bf16 v[44:47], v[76:79], v[144:147], v[44:47]
  s_waitcnt lgkmcnt(0)
  v_mfma_f32_16x16x32_bf16 v[16:19], v[112:115], v[176:179], v[16:19]
  v_mfma_f32_16x16x32_bf16 v[20:23], v[112:115], v[180:183], v[20:23]
  buffer_load_dwordx4 a[40:43], v4, s[12:15], s26 offen offset:2048 sc1
  v_mfma_f32_16x16x32_bf16 v[24:27], v[112:115], v[184:187], v[24:27]
  v_mfma_f32_16x16x32_bf16 v[28:31], v[112:115], v[188:191], v[28:31]
  v_mfma_f32_16x16x32_bf16 v[32:35], v[112:115], v[192:195], v[32:35]
  v_mfma_f32_16x16x32_bf16 v[36:39], v[112:115], v[196:199], v[36:39]
  v_mfma_f32_16x16x32_bf16 v[40:43], v[112:115], v[200:203], v[40:43]
  v_mfma_f32_16x16x32_bf16 v[44:47], v[112:115], v[204:207], v[44:47]
  buffer_load_dwordx4 a[120:123], v4, s[12:15], s28 offen offset:2048 sc1
  v_mfma_f32_16x16x32_bf16 v[20:23], v[116:119], v[176:179], v[20:23]
  v_mfma_f32_16x16x32_bf16 v[24:27], v[116:119], v[180:183], v[24:27]
  v_mfma_f32_16x16x32_bf16 v[28:31], v[116:119], v[184:187], v[28:31]
  v_mfma_f32_16x16x32_bf16 v[32:35], v[116:119], v[188:191], v[32:35]
  v_mfma_f32_16x16x32_bf16 v[36:39], v[116:119], v[192:195], v[36:39]
  v_mfma_f32_16x16x32_bf16 v[40:43], v[116:119], v[196:199], v[40:43]
  buffer_load_dwordx4 a[200:203], v4, s[12:15], s27 offen offset:2048 sc1
  v_mfma_f32_16x16x32_bf16 v[44:47], v[116:119], v[200:203], v[44:47]
  v_mfma_f32_16x16x32_bf16 v[24:27], v[120:123], v[176:179], v[24:27]
  v_mfma_f32_16x16x32_bf16 v[28:31], v[120:123], v[180:183], v[28:31]
  v_mfma_f32_16x16x32_bf16 v[32:35], v[120:123], v[184:187], v[32:35]
  v_mfma_f32_16x16x32_bf16 v[36:39], v[120:123], v[188:191], v[36:39]
  v_mfma_f32_16x16x32_bf16 v[40:43], v[120:123], v[192:195], v[40:43]
  buffer_load_dwordx4 a[44:47], v4, s[12:15], s26 offen offset:3072 sc1
  v_mfma_f32_16x16x32_bf16 v[44:47], v[120:123], v[196:199], v[44:47]
  v_mfma_f32_16x16x32_bf16 v[28:31], v[124:127], v[176:179], v[28:31]
  v_mfma_f32_16x16x32_bf16 v[32:35], v[124:127], v[180:183], v[32:35]
  v_mfma_f32_16x16x32_bf16 v[36:39], v[124:127], v[184:187], v[36:39]
  v_mfma_f32_16x16x32_bf16 v[40:43], v[124:127], v[188:191], v[40:43]
  v_mfma_f32_16x16x32_bf16 v[44:47], v[124:127], v[192:195], v[44:47]
  buffer_load_dwordx4 a[124:127], v4, s[12:15], s28 offen offset:3072 sc1
  v_mfma_f32_16x16x32_bf16 v[32:35], v[128:131], v[176:179], v[32:35]
  v_mfma_f32_16x16x32_bf16 v[36:39], v[128:131], v[180:183], v[36:39]
  v_mfma_f32_16x16x32_bf16 v[40:43], v[128:131], v[184:187], v[40:43]
  v_mfma_f32_16x16x32_bf16 v[44:47], v[128:131], v[188:191], v[44:47]
  v_mfma_f32_16x16x32_bf16 v[36:39], v[132:135], v[176:179], v[36:39]
  v_mfma_f32_16x16x32_bf16 v[40:43], v[132:135], v[180:183], v[40:43]
  buffer_load_dwordx4 a[204:207], v4, s[12:15], s27 offen offset:3072 sc1
  v_mfma_f32_16x16x32_bf16 v[44:47], v[132:135], v[184:187], v[44:47]
  v_mfma_f32_16x16x32_bf16 v[40:43], v[136:139], v[176:179], v[40:43]
  v_mfma_f32_16x16x32_bf16 v[44:47], v[136:139], v[180:183], v[44:47]
  v_mfma_f32_16x16x32_bf16 v[44:47], v[140:143], v[176:179], v[44:47]
  s_waitcnt lgkmcnt(0)
  v_lshrrev_b32 v14, 1, v2
  v_mul_u32_u24 v14, 272, v14
  v_and_b32 v15, 1, v2
  v_lshl_add_u32 v14, v15, 5, v14
  v_lshl_add_u32 v14, v3, 3, v14
  s_lshl_b32 s36, s10, 6
  s_add_u32 s36, s36, 45056
  v_add_u32 v14, s36, v14
  v_cvt_pk_bf16_f32 v48, v16, v17
  v_cvt_pk_bf16_f32 v49, v18, v19
  ds_write_b64 v14, v[48:49] offset:0
  v_cvt_pk_bf16_f32 v50, v20, v21
  v_cvt_pk_bf16_f32 v51, v22, v23
  ds_write_b64 v14, v[50:51] offset:2176
  v_cvt_pk_bf16_f32 v52, v24, v25
  v_cvt_pk_bf16_f32 v53, v26, v27
  ds_write_b64 v14, v[52:53] offset:4352
  v_cvt_pk_bf16_f32 v54, v28, v29
  v_cvt_pk_bf16_f32 v55, v30, v31
  ds_write_b64 v14, v[54:55] offset:6528
  v_cvt_pk_bf16_f32 v56, v32, v33
  v_cvt_pk_bf16_f32 v57, v34, v35
  ds_write_b64 v14, v[56:57] offset:8704
  v_cvt_pk_bf16_f32 v58, v36, v37
  v_cvt_pk_bf16_f32 v59, v38, v39
  ds_write_b64 v14, v[58:59] offset:10880
  v_cvt_pk_bf16_f32 v60, v40, v41
  v_cvt_pk_bf16_f32 v61, v42, v43
  ds_write_b64 v14, v[60:61] offset:13056
  v_cvt_pk_bf16_f32 v62, v44, v45
  v_cvt_pk_bf16_f32 v63, v46, v47
  ds_write_b64 v14, v[62:63] offset:15232
  s_lshl_b32 s36, s10, 4
  v_add_u32 v15, s36, v3
  v_mul_u32_u24 v16, 272, v15
  v_lshl_add_u32 v16, v2, 4, v16
  v_add_u32 v16, 45056, v16
  v_mul_u32_u24 v15, 40960, v15
  v_lshl_add_u32 v15, v2, 4, v15
  s_lshl_b32 s36, s2, 8
  s_add_u32 s36, s36, 2621440
  s_waitcnt lgkmcnt(0)
  s_barrier
  ds_read_b128 v[144:147], v16 offset:0
  ds_read_b128 v[148:151], v16 offset:1088
  ds_read_b128 v[152:155], v16 offset:2176
  ds_read_b128 v[156:159], v16 offset:3264
  s_waitcnt lgkmcnt(3)
  buffer_store_dwordx4 v[144:147], v15, s[12:15], s36 offen sc1
  s_add_u32 s36, s36, 163840
  s_waitcnt lgkmcnt(2)
  buffer_store_dwordx4 v[148:151], v15, s[12:15], s36 offen sc1
  s_add_u32 s36, s36, 163840
  s_waitcnt lgkmcnt(1)
  buffer_store_dwordx4 v[152:155], v15, s[12:15], s36 offen sc1
  s_add_u32 s36, s36, 163840
  s_waitcnt lgkmcnt(0)
  buffer_store_dwordx4 v[156:159], v15, s[12:15], s36 offen sc1
  v_lshrrev_b32 v10, 2, v2
  v_mul_u32_u24 v10, 5120, v10
  v_and_b32 v11, 3, v2
  v_lshl_add_u32 v10, v11, 8, v10
  v_xor_b32 v11, v3, v2
  s_mul_i32 s36, s10, 5
  s_add_u32 s37, s36, 0
  s_and_b32 s38, s37, 3
  s_lshl_b32 s38, s38, 2
  s_lshr_b32 s37, s37, 2
  s_lshl_b32 s37, s37, 10
  v_xor_b32 v16, s38, v11
  v_lshlrev_b32 v16, 4, v16
  v_add3_u32 v16, v16, v10, s37
  s_add_u32 s37, s36, 1
  s_and_b32 s38, s37, 3
  s_lshl_b32 s38, s38, 2
  s_lshr_b32 s37, s37, 2
  s_lshl_b32 s37, s37, 10
  v_xor_b32 v17, s38, v11
  v_lshlrev_b32 v17, 4, v17
  v_add3_u32 v17, v17, v10, s37
  s_add_u32 s37, s36, 2
  s_and_b32 s38, s37, 3
  s_lshl_b32 s38, s38, 2
  s_lshr_b32 s37, s37, 2
  s_lshl_b32 s37, s37, 10
  v_xor_b32 v18, s38, v11
  v_lshlrev_b32 v18, 4, v18
  v_add3_u32 v18, v18, v10, s37
  s_add_u32 s37, s36, 3
  s_and_b32 s38, s37, 3
  s_lshl_b32 s38, s38, 2
  s_lshr_b32 s37, s37, 2
  s_lshl_b32 s37, s37, 10
  v_xor_b32 v19, s38, v11
  v_lshlrev_b32 v19, 4, v19
  v_add3_u32 v19, v19, v10, s37
  s_add_u32 s37, s36, 4
  s_and_b32 s38, s37, 3
  s_lshl_b32 s38, s38, 2
  s_lshr_b32 s37, s37, 2
  s_lshl_b32 s37, s37, 10
  v_xor_b32 v20, s38, v11
  v_lshlrev_b32 v20, 4, v20
  v_add3_u32 v20, v20, v10, s37
  s_barrier
  ds_read_b128 v[32:35], v16 offset:0
  ds_read_b128 v[36:39], v17 offset:0
  ds_read_b128 v[40:43], v18 offset:0
  ds_read_b128 v[44:47], v19 offset:0
  ds_read_b128 v[48:51], v20 offset:0
  ds_read_b128 v[52:55], v16 offset:20480
  ds_read_b128 v[56:59], v17 offset:20480
  ds_read_b128 v[60:63], v18 offset:20480
  ds_read_b128 v[64:67], v19 offset:20480
  ds_read_b128 v[68:71], v20 offset:20480
  v_mov_b32 v22, 0
  v_mov_b32 v24, 0
  v_mov_b32 v26, 0
  v_mov_b32 v28, 0
  s_mov_b32 s38, 0x3f803f80
  s_waitcnt lgkmcnt(5)
  v_dot2_f32_bf16 v22, v32, s38, v22
  v_dot2_f32_bf16 v24, v32, v32, v24
  v_dot2_f32_bf16 v22, v33, s38, v22
  v_dot2_f32_bf16 v24, v33, v33, v24
  v_dot2_f32_bf16 v22, v34, s38, v22
  v_dot2_f32_bf16 v24, v34, v34, v24
  v_dot2_f32_bf16 v22, v35, s38, v22
  v_dot2_f32_bf16 v24, v35, v35, v24
  v_dot2_f32_bf16 v22, v36, s38, v22
  v_dot2_f32_bf16 v24, v36, v36, v24
  v_dot2_f32_bf16 v22, v37, s38, v22
  v_dot2_f32_bf16 v24, v37, v37, v24
  v_dot2_f32_bf16 v22, v38, s38, v22
  v_dot2_f32_bf16 v24, v38, v38, v24
  v_dot2_f32_bf16 v22, v39, s38, v22
  v_dot2_f32_bf16 v24, v39, v39, v24
  v_dot2_f32_bf16 v22, v40, s38, v22
  v_dot2_f32_bf16 v24, v40, v40, v24
  v_dot2_f32_bf16 v22, v41, s38, v22
  v_dot2_f32_bf16 v24, v41, v41, v24
  v_dot2_f32_bf16 v22, v42, s38, v22
  v_dot2_f32_bf16 v24, v42, v42, v24
  v_dot2_f32_bf16 v22, v43, s38, v22
  v_dot2_f32_bf16 v24, v43, v43, v24
  v_dot2_f32_bf16 v22, v44, s38, v22
  v_dot2_f32_bf16 v24, v44, v44, v24
  v_dot2_f32_bf16 v22, v45, s38, v22
  v_dot2_f32_bf16 v24, v45, v45, v24
  v_dot2_f32_bf16 v22, v46, s38, v22
  v_dot2_f32_bf16 v24, v46, v46, v24
  v_dot2_f32_bf16 v22, v47, s38, v22
  v_dot2_f32_bf16 v24, v47, v47, v24
  v_dot2_f32_bf16 v22, v48, s38, v22
  v_dot2_f32_bf16 v24, v48, v48, v24
  v_dot2_f32_bf16 v22, v49, s38, v22
  v_dot2_f32_bf16 v24, v49, v49, v24
  v_dot2_f32_bf16 v22, v50, s38, v22
  v_dot2_f32_bf16 v24, v50, v50, v24
  v_dot2_f32_bf16 v22, v51, s38, v22
  v_dot2_f32_bf16 v24, v51, v51, v24
  s_waitcnt lgkmcnt(0)
  v_dot2_f32_bf16 v26, v52, s38, v26
  v_dot2_f32_bf16 v28, v52, v52, v28
  v_dot2_f32_bf16 v26, v53, s38, v26
  v_dot2_f32_bf16 v28, v53, v53, v28
  v_dot2_f32_bf16 v26, v54, s38, v26
  v_dot2_f32_bf16 v28, v54, v54, v28
  v_dot2_f32_bf16 v26, v55, s38, v26
  v_dot2_f32_bf16 v28, v55, v55, v28
  v_dot2_f32_bf16 v26, v56, s38, v26
  v_dot2_f32_bf16 v28, v56, v56, v28
  v_dot2_f32_bf16 v26, v57, s38, v26
  v_dot2_f32_bf16 v28, v57, v57, v28
  v_dot2_f32_bf16 v26, v58, s38, v26
  v_dot2_f32_bf16 v28, v58, v58, v28
  v_dot2_f32_bf16 v26, v59, s38, v26
  v_dot2_f32_bf16 v28, v59, v59, v28
  v_dot2_f32_bf16 v26, v60, s38, v26
  v_dot2_f32_bf16 v28, v60, v60, v28
  v_dot2_f32_bf16 v26, v61, s38, v26
  v_dot2_f32_bf16 v28, v61, v61, v28
  v_dot2_f32_bf16 v26, v62, s38, v26
  v_dot2_f32_bf16 v28, v62, v62, v28
  v_dot2_f32_bf16 v26, v63, s38, v26
  v_dot2_f32_bf16 v28, v63, v63, v28
  v_dot2_f32_bf16 v26, v64, s38, v26
  v_dot2_f32_bf16 v28, v64, v64, v28
  v_dot2_f32_bf16 v26, v65, s38, v26
  v_dot2_f32_bf16 v28, v65, v65, v28
  v_dot2_f32_bf16 v26, v66, s38, v26
  v_dot2_f32_bf16 v28, v66, v66, v28
  v_dot2_f32_bf16 v26, v67, s38, v26
  v_dot2_f32_bf16 v28, v67, v67, v28
  v_dot2_f32_bf16 v26, v68, s38, v26
  v_dot2_f32_bf16 v28, v68, v68, v28
  v_dot2_f32_bf16 v26, v69, s38, v26
  v_dot2_f32_bf16 v28, v69, v69, v28
  v_dot2_f32_bf16 v26, v70, s38, v26
  v_dot2_f32_bf16 v28, v70, v70, v28
  v_dot2_f32_bf16 v26, v71, s38, v26
  v_dot2_f32_bf16 v28, v71, v71, v28
  v_lshlrev_b32 v10, 4, v2
  v_lshl_add_u32 v11, v3, 2, v10
  s_lshl_b32 s37, s10, 8
  s_add_u32 s37, s37, 81920
  v_permlane32_swap_b32 v22, v26
  v_permlane32_swap_b32 v24, v28
  v_add_u32 v11, s37, v11
  v_add_u32 v10, 81920, v10
  v_add_f32 v22, v22, v26
  v_add_f32 v24, v24, v28
  s_nop 1
  v_permlane16_swap_b32 v22, v24
  v_add_f32 v22, v22, v24
  ds_write_b32 v11, v22
  s_waitcnt lgkmcnt(0)
  s_barrier
  ds_read_b128 v[192:195], v10 offset:0
  ds_read_b128 v[196:199], v10 offset:256
  ds_read_b128 v[200:203], v10 offset:512
  ds_read_b128 v[204:207], v10 offset:768
  s_waitcnt lgkmcnt(0)
  v_pk_add_f32 v[192:193], v[192:193], v[196:197]
  v_pk_add_f32 v[194:195], v[194:195], v[198:199]
  v_pk_add_f32 v[200:201], v[200:201], v[204:205]
  v_pk_add_f32 v[202:203], v[202:203], v[206:207]
  v_pk_add_f32 v[192:193], v[192:193], v[200:201]
  v_pk_add_f32 v[194:195], v[194:195], v[202:203]
  s_mov_b32 s52, 0x3acccccd
  s_mov_b32 s53, 0x3727c5ac
  v_mul_f32 v192, s52, v192
  v_mul_f32 v194, s52, v194
  v_mul_f32 v193, s52, v193
  v_mul_f32 v195, s52, v195
  v_fma_f32 v193, -v192, v192, v193
  v_fma_f32 v195, -v194, v194, v195
  v_max_f32 v193, 0, v193
  v_max_f32 v195, 0, v195
  v_add_f32 v193, s53, v193
  v_add_f32 v195, s53, v195
  v_rsq_f32 v214, v193
  v_rsq_f32 v216, v195
  v_mul_f32 v215, -v192, v214
  v_mul_f32 v217, -v194, v216
  s_waitcnt vmcnt(0)
  s_barrier
  v_cmp_eq_u32 vcc, 0, v219
  s_nop 4
  s_cbranch_vccz sequential_preLN__ssm_conv_h3__mixer_s_mlp__prompt_kernel_cpaok7
  v_mov_b32 v5, 29084928
  v_mov_b32 v7, 1
  s_mov_b32 s85, 0
sequential_preLN__ssm_conv_h3__mixer_s_mlp__prompt_kernel_pl8_l:
  buffer_load_dword v6, v5, s[12:15], 0 offen sc1
  s_add_u32 s85, s85, 1
  s_waitcnt vmcnt(0)
  v_cmp_gt_u32 vcc, v7, v6
  s_cmp_gt_u32 s85, 200000
  s_cbranch_scc1 sequential_preLN__ssm_conv_h3__mixer_s_mlp__prompt_kernel_pl8
  s_nop 2
  s_nop 2
  s_cbranch_vccnz sequential_preLN__ssm_conv_h3__mixer_s_mlp__prompt_kernel_pl8_l
sequential_preLN__ssm_conv_h3__mixer_s_mlp__prompt_kernel_pl8:
sequential_preLN__ssm_conv_h3__mixer_s_mlp__prompt_kernel_cpaok7:
  s_cmp_lg_u32 s10, 0
  s_cbranch_scc1 sequential_preLN__ssm_conv_h3__mixer_s_mlp__prompt_kernel_sigc1
  s_and_b32 s84, s2, 7
  s_lshl_b32 s84, s84, 7
  s_add_u32 s84, s84, 29082624
  v_mov_b32 v5, 0
  v_mov_b32 v6, 1
  s_mov_b64 exec, 1
  buffer_atomic_add v6, v5, s[12:15], s84 offen sc0 sc1
  s_and_b32 s84, s2, 7
  s_lshl_b32 s84, s84, 7
  s_add_u32 s84, s84, 29083904
  s_waitcnt vmcnt(0)
  v_cmp_eq_u32 vcc, 19, v6
  v_mov_b32 v6, 1
  s_nop 3
  s_and_b64 exec, exec, vcc
  s_cbranch_execz sequential_preLN__ssm_conv_h3__mixer_s_mlp__prompt_kernel_sigc1_x
  buffer_store_dword v6, v5, s[12:15], s84 offen sc1
sequential_preLN__ssm_conv_h3__mixer_s_mlp__prompt_kernel_sigc1_x:
  s_mov_b64 exec, -1
sequential_preLN__ssm_conv_h3__mixer_s_mlp__prompt_kernel_sigc1:
  s_branch sequential_preLN__ssm_conv_h3__mixer_s_mlp__prompt_kernel_wconv
sequential_preLN__ssm_conv_h3__mixer_s_mlp__prompt_kernel_special:
  s_waitcnt lgkmcnt(0)
  s_and_b32 s24, s2, 63
  s_lshr_b32 s25, s2, 6
  s_and_b32 s26, s2, 3
  s_lshl_b32 s26, s26, 3
  s_lshr_b32 s27, s2, 3
  s_and_b32 s60, s27, 7
  s_add_u32 s60, s60, s26
  s_bfe_u32 s26, s2, 0x10002
  s_lshl_b32 s26, s26, 2
  s_lshr_b32 s61, s27, 3
  s_add_u32 s61, s61, s26
  s_and_b32 s62, s61, 1
  s_mul_i32 s69, s61, 5
  s_add_u32 s64, s69, s62
  s_add_u32 s65, s69, s62
  s_add_u32 s65, s65, 1
  s_add_u32 s66, s69, s62
  s_add_u32 s66, s66, 2
  s_add_u32 s67, s69, s62
  s_add_u32 s67, s67, 3
  s_cmp_eq_u32 s62, 0
  s_cselect_b32 s68, 4, 0
  s_add_u32 s68, s68, s69
  s_lshl_b32 s63, s60, 2
  s_add_u32 s63, s63, s10
  s_mul_i32 s26, s63, 20480
  s_lshr_b32 s70, s64, 1
  s_lshl_b32 s70, s70, 10
  s_add_u32 s70, s70, s26
  s_lshr_b32 s71, s68, 1
  s_lshl_b32 s71, s71, 10
  s_add_u32 s71, s71, s26
  s_lshl_b32 s26, s62, 3
  s_add_u32 s71, s71, s26
  s_mov_b32 s12, s4
  s_mov_b32 s13, s5
  s_mov_b32 s14, 29089792
  s_mov_b32 s15, 0x20000
  s_mov_b32 s16, s8
  s_mov_b32 s17, s9
  s_mov_b32 s18, 2621440
  s_mov_b32 s19, 0x20000
  s_mov_b32 s20, s6
  s_mov_b32 s21, s7
  s_mov_b32 s22, 2621440
  s_mov_b32 s23, 0x20000
  s_mov_b32 s74, 256
  s_mov_b32 s75, 0x20000
  s_cmp_eq_u32 s2, 255
  s_cbranch_scc1 sequential_preLN__ssm_conv_h3__mixer_s_mlp__prompt_kernel_zero
sequential_preLN__ssm_conv_h3__mixer_s_mlp__prompt_kernel_w1only:
  s_sub_u32 s35, s2, 242
  s_lshl_b32 s35, s35, 2
  s_add_u32 s35, s35, s10
  s_mov_b32 s48, s76
  s_mov_b32 s49, s77
  s_mov_b32 s50, 819200
  s_mov_b32 s40, 1280
  s_mov_b32 s44, 5259264
  s_mov_b32 s45, 20
  s_mov_b32 s46, 5
  s_mul_hi_u32 s41, s35, 0x1999999a
  s_mul_i32 s42, s41, 10
  s_sub_u32 s42, s35, s42
  s_mov_b32 s43, 4
  s_lshl_b32 s41, s41, 2
  s_cmp_ge_u32 s35, 50
  s_nop 2
  s_cbranch_scc1 sequential_preLN__ssm_conv_h3__mixer_s_mlp__prompt_kernel_doneA
  s_mov_b32 s51, 0x20000
  s_lshl_b32 s34, s10, 14
  s_add_u32 s34, s34, 0
  v_lshrrev_b32 v5, 3, v1
  v_and_b32 v6, 7, v1
  v_lshlrev_b32 v6, 4, v6
  s_lshl_b32 s47, s41, 5
  v_add_u32 v5, s47, v5
  v_mul_lo_u32 v5, v5, s40
  s_lshl_b32 s47, s42, 7
  v_add3_u32 v5, v5, v6, s47
  s_lshl_b32 s52, s40, 3
  s_lshl_b32 s53, s43, 2
  s_mov_b32 s54, s34
sequential_preLN__ssm_conv_h3__mixer_s_mlp__prompt_kernel_wldA:
  s_mov_b32 m0, s54
  s_sub_u32 s53, s53, 1
  buffer_load_dwordx4 v5, s[48:51], 0 offen lds
  v_add_u32 v5, s52, v5
  s_add_u32 s54, s54, 1024
  s_cmp_lg_u32 s53, 0
  s_cbranch_scc1 sequential_preLN__ssm_conv_h3__mixer_s_mlp__prompt_kernel_wldA
  v_lshlrev_b32 v5, 10, v3
  v_bfe_u32 v6, v1, 2, 2
  v_lshl_add_u32 v5, v6, 7, v5
  v_and_b32 v6, 3, v1
  v_lshl_add_u32 v5, v6, 4, v5
  v_add_u32 v5, s34, v5
  s_lshl_b32 s47, s42, 2
  s_mul_i32 s47, s47, s45
  s_add_u32 s47, s47, s41
  s_lshl_b32 s47, s47, 10
  s_add_u32 s47, s47, s44
  s_lshl_b32 s55, s45, 10
  v_mov_b32 v24, 0
  v_mov_b32 v25, 0
  v_mov_b32 v26, 0
  v_mov_b32 v27, 0
  s_mov_b32 s52, 0x3f803f80
  s_mov_b32 s53, 0
  s_waitcnt vmcnt(0)
sequential_preLN__ssm_conv_h3__mixer_s_mlp__prompt_kernel_wtrA:
  ds_read_b64_tr_b16 v[8:9], v5 offset:0
  ds_read_b64_tr_b16 v[10:11], v5 offset:512
  ds_read_b64_tr_b16 v[12:13], v5 offset:8
  ds_read_b64_tr_b16 v[14:15], v5 offset:520
  ds_read_b64_tr_b16 v[16:17], v5 offset:64
  ds_read_b64_tr_b16 v[18:19], v5 offset:576
  ds_read_b64_tr_b16 v[20:21], v5 offset:72
  ds_read_b64_tr_b16 v[22:23], v5 offset:584
  v_add_u32 v5, 4096, v5
  s_add_u32 s53, s53, 1
  s_mov_b32 s54, s47
  s_waitcnt lgkmcnt(6)
  buffer_store_dwordx4 v[8:11], v4, s[12:15], s54 offen sc1
  s_add_u32 s54, s54, s55
  s_waitcnt lgkmcnt(4)
  buffer_store_dwordx4 v[12:15], v4, s[12:15], s54 offen sc1
  s_add_u32 s54, s54, s55
  s_waitcnt lgkmcnt(2)
  buffer_store_dwordx4 v[16:19], v4, s[12:15], s54 offen sc1
  s_add_u32 s54, s54, s55
  s_waitcnt lgkmcnt(0)
  buffer_store_dwordx4 v[20:23], v4, s[12:15], s54 offen sc1
  v_dot2_f32_bf16 v24, v8, s52, v24
  v_dot2_f32_bf16 v25, v12, s52, v25
  v_dot2_f32_bf16 v26, v16, s52, v26
  v_dot2_f32_bf16 v27, v20, s52, v27
  v_dot2_f32_bf16 v24, v9, s52, v24
  v_dot2_f32_bf16 v25, v13, s52, v25
  v_dot2_f32_bf16 v26, v17, s52, v26
  v_dot2_f32_bf16 v27, v21, s52, v27
  v_dot2_f32_bf16 v24, v10, s52, v24
  v_dot2_f32_bf16 v25, v14, s52, v25
  v_dot2_f32_bf16 v26, v18, s52, v26
  v_dot2_f32_bf16 v27, v22, s52, v27
  v_dot2_f32_bf16 v24, v11, s52, v24
  v_dot2_f32_bf16 v25, v15, s52, v25
  v_dot2_f32_bf16 v26, v19, s52, v26
  v_dot2_f32_bf16 v27, v23, s52, v27
  s_add_u32 s47, s47, 1024
  s_cmp_lt_u32 s53, s43
  s_cbranch_scc1 sequential_preLN__ssm_conv_h3__mixer_s_mlp__prompt_kernel_wtrA
  s_cmp_ge_u32 s46, 5
  s_nop 2
  s_cbranch_scc1 sequential_preLN__ssm_conv_h3__mixer_s_mlp__prompt_kernel_doneA
  v_mov_b32 v28, v24
  v_mov_b32 v29, v25
  v_mov_b32 v30, v26
  v_mov_b32 v31, v27
  v_permlane32_swap_b32 v24, v28
  v_permlane32_swap_b32 v25, v29
  v_permlane32_swap_b32 v26, v30
  v_permlane32_swap_b32 v27, v31
  v_add_f32 v24, v24, v28
  v_add_f32 v25, v25, v29
  v_add_f32 v26, v26, v30
  v_add_f32 v27, v27, v31
  v_mov_b32 v28, v24
  v_mov_b32 v29, v25
  v_mov_b32 v30, v26
  v_mov_b32 v31, v27
  v_permlane16_swap_b32 v24, v28
  v_permlane16_swap_b32 v25, v29
  v_permlane16_swap_b32 v26, v30
  v_permlane16_swap_b32 v27, v31
  v_add_f32 v24, v24, v28
  v_add_f32 v25, v25, v29
  v_add_f32 v26, v26, v30
  v_add_f32 v27, v27, v31
  s_mul_i32 s47, s46, 6912
  s_lshl_b32 s52, s42, 8
  s_add_u32 s47, s47, s52
  s_add_u32 s47, s47, 11321344
  v_lshlrev_b32 v6, 2, v2
  s_mov_b64 exec, 0xffff
  buffer_store_dword v24, v6, s[12:15], s47 offen offset:0 sc1
  buffer_store_dword v25, v6, s[12:15], s47 offen offset:64 sc1
  buffer_store_dword v26, v6, s[12:15], s47 offen offset:128 sc1
  buffer_store_dword v27, v6, s[12:15], s47 offen offset:192 sc1
  s_mov_b64 exec, -1
  s_nop 2
  s_branch sequential_preLN__ssm_conv_h3__mixer_s_mlp__prompt_kernel_doneA
sequential_preLN__ssm_conv_h3__mixer_s_mlp__prompt_kernel_doneA:
  s_waitcnt vmcnt(0)
  s_cmp_lg_u32 s10, 0
  s_nop 3
  s_cbranch_scc1 sequential_preLN__ssm_conv_h3__mixer_s_mlp__prompt_kernel_fi10
  v_mov_b32 v5, 0
  s_mov_b32 s85, 0
sequential_preLN__ssm_conv_h3__mixer_s_mlp__prompt_kernel_in11_l:
  buffer_load_dword v6, v5, s[72:75], 0 offen sc1
  s_add_u32 s85, s85, 1
  s_waitcnt vmcnt(0)
  v_cmp_eq_u32 vcc, 0, v6
  s_cmp_gt_u32 s85, 200000
  s_nop 3
  s_cbranch_scc1 sequential_preLN__ssm_conv_h3__mixer_s_mlp__prompt_kernel_in11
  s_nop 2
  s_cbranch_vccnz sequential_preLN__ssm_conv_h3__mixer_s_mlp__prompt_kernel_in11_l
sequential_preLN__ssm_conv_h3__mixer_s_mlp__prompt_kernel_in11:
sequential_preLN__ssm_conv_h3__mixer_s_mlp__prompt_kernel_fi10:
  s_barrier
  s_cmp_lg_u32 s10, 0
  s_cbranch_scc1 sequential_preLN__ssm_conv_h3__mixer_s_mlp__prompt_kernel_sig9
  s_mov_b32 s84, 29083648
  v_mov_b32 v5, 0
  v_mov_b32 v6, 1
  s_mov_b64 exec, 1
  buffer_atomic_add v6, v5, s[12:15], s84 offen sc0 sc1
  s_mov_b32 s84, 29084928
  s_waitcnt vmcnt(0)
  v_cmp_eq_u32 vcc, 12, v6
  v_mov_b32 v6, 1
  s_nop 3
  s_and_b64 exec, exec, vcc
  s_cbranch_execz sequential_preLN__ssm_conv_h3__mixer_s_mlp__prompt_kernel_sig9_x
  buffer_store_dword v6, v5, s[12:15], s84 offen sc1
sequential_preLN__ssm_conv_h3__mixer_s_mlp__prompt_kernel_sig9_x:
  s_mov_b64 exec, -1
sequential_preLN__ssm_conv_h3__mixer_s_mlp__prompt_kernel_sig9:
  s_branch sequential_preLN__ssm_conv_h3__mixer_s_mlp__prompt_kernel_prep
sequential_preLN__ssm_conv_h3__mixer_s_mlp__prompt_kernel_zero:
  v_mov_b32 v8, 0
  v_mov_b32 v9, 0
  v_mov_b32 v10, 0
  v_mov_b32 v11, 0
  v_lshlrev_b32 v5, 4, v0
  s_mov_b32 s35, 29052928
  buffer_store_dwordx4 v[8:11], v5, s[12:15], s35 offen sc1
  s_add_u32 s35, s35, 4096
  buffer_store_dwordx4 v[8:11], v5, s[12:15], s35 offen sc1
  s_add_u32 s35, s35, 4096
  buffer_store_dwordx4 v[8:11], v5, s[12:15], s35 offen sc1
  s_add_u32 s35, s35, 4096
  buffer_store_dwordx4 v[8:11], v5, s[12:15], s35 offen sc1
  s_add_u32 s35, s35, 4096
  buffer_store_dwordx4 v[8:11], v5, s[12:15], s35 offen sc1
  s_add_u32 s35, s35, 4096
  buffer_store_dwordx4 v[8:11], v5, s[12:15], s35 offen sc1
  s_add_u32 s35, s35, 4096
  buffer_store_dwordx4 v[8:11], v5, s[12:15], s35 offen sc1
  s_add_u32 s35, s35, 4096
  buffer_store_dwordx4 v[8:11], v5, s[12:15], s35 offen sc1
  s_add_u32 s35, s35, 4096
  buffer_store_dwordx4 v[8:11], v5, s[12:15], s35 offen sc1
  s_add_u32 s35, s35, 4096
  s_waitcnt vmcnt(0)
  s_barrier
  v_mov_b32 v5, 0
  v_mov_b32 v6, 1
  s_cmp_lg_u32 s10, 0
  s_cbranch_scc1 sequential_preLN__ssm_conv_h3__mixer_s_mlp__prompt_kernel_prep
  s_mov_b64 exec, 1
  buffer_store_dword v6, v5, s[72:75], 0 offen sc1
  s_mov_b64 exec, -1
sequential_preLN__ssm_conv_h3__mixer_s_mlp__prompt_kernel_prep:
sequential_preLN__ssm_conv_h3__mixer_s_mlp__prompt_kernel_noq:
sequential_preLN__ssm_conv_h3__mixer_s_mlp__prompt_kernel_roundB:
  s_lshl_b32 s34, s10, 3
  v_add_u32 v8, s34, v3
  v_and_b32 v9, 15, v8
  v_xor_b32 v9, v9, v2
  s_lshl_b32 s29, s24, 5
  v_add_u32 v10, s29, v8
  v_mul_u32_u24 v10, 1280, v10
  v_xor_b32 v11, 4, v9
  v_lshl_add_u32 v212, v9, 4, v10
  v_lshl_add_u32 v213, v11, 4, v10
  v_add_u32 v213, 5120, v213
  s_mul_i32 s26, s25, 10
  s_lshl_b32 s27, s10, 1
  s_add_u32 s26, s26, s27
  s_mul_i32 s26, s26, 20480
  s_add_u32 s26, s26, 5259264
  s_mul_i32 s27, s25, 10
  s_lshr_b32 s28, s10, 1
  s_add_u32 s27, s27, s28
  s_add_u32 s27, s27, 8
  s_mul_i32 s27, s27, 20480
  s_add_u32 s27, s27, 5259264
  s_add_u32 s28, s26, 20480
  s_sub_u32 s33, s2, 160
  s_lshl_b32 s33, s33, 2
  s_add_u32 s33, s33, s10
  s_mov_b32 s43, 0
  s_cmp_ge_u32 s33, 325
  s_cbranch_scc1 sequential_preLN__ssm_conv_h3__mixer_s_mlp__prompt_kernel_noB
  s_mov_b32 s46, 5
  s_mov_b32 s43, 4
  s_cmp_ge_u32 s33, 50
  s_cbranch_scc1 sequential_preLN__ssm_conv_h3__mixer_s_mlp__prompt_kernel_pw3
  s_mov_b32 s48, s78
  s_mov_b32 s49, s79
  s_mov_b32 s50, 819200
  s_mov_b32 s40, 1280
  s_mov_b32 s44, 6078464
  s_mov_b32 s45, 20
  s_mul_hi_u32 s41, s33, 0x1999999a
  s_mul_i32 s42, s41, 10
  s_sub_u32 s42, s33, s42
  s_lshl_b32 s41, s41, 2
  s_branch sequential_preLN__ssm_conv_h3__mixer_s_mlp__prompt_kernel_wtB
sequential_preLN__ssm_conv_h3__mixer_s_mlp__prompt_kernel_pw3:
  s_cmp_ge_u32 s33, 185
  s_cbranch_scc1 sequential_preLN__ssm_conv_h3__mixer_s_mlp__prompt_kernel_pw4
  s_sub_u32 s35, s33, 50
  s_mov_b32 s48, s80
  s_mov_b32 s49, s81
  s_mov_b32 s50, 2211840
  s_mov_b32 s40, 3456
  s_mov_b32 s44, 6897664
  s_mov_b32 s45, 20
  s_mul_hi_u32 s46, s35, 0x97b425f
  s_mul_i32 s42, s46, 27
  s_sub_u32 s42, s35, s42
  s_lshl_b32 s41, s46, 2
  s_branch sequential_preLN__ssm_conv_h3__mixer_s_mlp__prompt_kernel_wtB
sequential_preLN__ssm_conv_h3__mixer_s_mlp__prompt_kernel_pw4:
  s_sub_u32 s35, s33, 185
  s_mov_b32 s48, s82
  s_mov_b32 s49, s83
  s_mov_b32 s50, 2211840
  s_mov_b32 s40, 1280
  s_mov_b32 s44, 9109504
  s_mov_b32 s45, 54
  s_mul_hi_u32 s41, s35, 0x1999999a
  s_mul_i32 s42, s41, 10
  s_sub_u32 s42, s35, s42
  s_cmp_eq_u32 s41, 13
  s_cselect_b32 s43, 2, 4
  s_lshl_b32 s41, s41, 2
sequential_preLN__ssm_conv_h3__mixer_s_mlp__prompt_kernel_wtB:
  s_mov_b32 s51, 0x20000
  s_lshl_b32 s34, s10, 14
  s_add_u32 s34, s34, 45056
  v_lshrrev_b32 v5, 3, v1
  v_and_b32 v6, 7, v1
  v_lshlrev_b32 v6, 4, v6
  s_lshl_b32 s47, s41, 5
  v_add_u32 v5, s47, v5
  v_mul_lo_u32 v5, v5, s40
  s_lshl_b32 s47, s42, 7
  v_add3_u32 v5, v5, v6, s47
  s_lshl_b32 s52, s40, 3
  s_lshl_b32 s53, s43, 2
  s_mov_b32 s54, s34
sequential_preLN__ssm_conv_h3__mixer_s_mlp__prompt_kernel_wldB:
  s_mov_b32 m0, s54
  s_sub_u32 s53, s53, 1
  buffer_load_dwordx4 v5, s[48:51], 0 offen lds
  v_add_u32 v5, s52, v5
  s_add_u32 s54, s54, 1024
  s_cmp_lg_u32 s53, 0
  s_cbranch_scc1 sequential_preLN__ssm_conv_h3__mixer_s_mlp__prompt_kernel_wldB
sequential_preLN__ssm_conv_h3__mixer_s_mlp__prompt_kernel_noB:
  s_mul_i32 s84, s10, 10240
  s_add_u32 m0, s84, 0
  s_nop 0
  buffer_load_dwordx4 v212, s[16:19], 0 offen offset:0 lds
  s_mul_i32 s84, s10, 10240
  s_add_u32 m0, s84, 768
  s_nop 0
  buffer_load_dwordx4 v212, s[16:19], 0 offen offset:256 lds
  s_mul_i32 s84, s10, 10240
  s_add_u32 m0, s84, 1536
  s_nop 0
  buffer_load_dwordx4 v212, s[16:19], 0 offen offset:512 lds
  s_mul_i32 s84, s10, 10240
  s_add_u32 m0, s84, 2304
  s_nop 0
  buffer_load_dwordx4 v212, s[16:19], 0 offen offset:768 lds
  s_mul_i32 s84, s10, 10240
  s_add_u32 m0, s84, 3072
  s_nop 0
  buffer_load_dwordx4 v212, s[16:19], 0 offen offset:1024 lds
  s_mul_i32 s84, s10, 10240
  s_add_u32 m0, s84, 5120
  s_nop 0
  buffer_load_dwordx4 v213, s[16:19], 0 offen offset:0 lds
  s_mul_i32 s84, s10, 10240
  s_add_u32 m0, s84, 5888
  s_nop 0
  buffer_load_dwordx4 v213, s[16:19], 0 offen offset:256 lds
  s_mul_i32 s84, s10, 10240
  s_add_u32 m0, s84, 6656
  s_nop 0
  buffer_load_dwordx4 v213, s[16:19], 0 offen offset:512 lds
  s_mul_i32 s84, s10, 10240
  s_add_u32 m0, s84, 7424
  s_nop 0
  buffer_load_dwordx4 v213, s[16:19], 0 offen offset:768 lds
  s_mul_i32 s84, s10, 10240
  s_add_u32 m0, s84, 8192
  s_nop 0
  buffer_load_dwordx4 v213, s[16:19], 0 offen offset:1024 lds
  v_mov_b32 v220, 29084928
  buffer_load_dword v219, v220, s[12:15], 0 offen sc1
  s_cmp_eq_u32 s43, 0
  s_cbranch_scc1 sequential_preLN__ssm_conv_h3__mixer_s_mlp__prompt_kernel_doneB
  v_lshlrev_b32 v5, 10, v3
  v_bfe_u32 v6, v1, 2, 2
  v_lshl_add_u32 v5, v6, 7, v5
  v_and_b32 v6, 3, v1
  v_lshl_add_u32 v5, v6, 4, v5
  v_add_u32 v5, s34, v5
  s_lshl_b32 s47, s42, 2
  s_mul_i32 s47, s47, s45
  s_add_u32 s47, s47, s41
  s_lshl_b32 s47, s47, 10
  s_add_u32 s47, s47, s44
  s_lshl_b32 s55, s45, 10
  v_mov_b32 v24, 0
  v_mov_b32 v25, 0
  v_mov_b32 v26, 0
  v_mov_b32 v27, 0
  s_mov_b32 s52, 0x3f803f80
  s_mov_b32 s53, 0
  s_waitcnt vmcnt(0)
sequential_preLN__ssm_conv_h3__mixer_s_mlp__prompt_kernel_wtrB:
  ds_read_b64_tr_b16 v[8:9], v5 offset:0
  ds_read_b64_tr_b16 v[10:11], v5 offset:512
  ds_read_b64_tr_b16 v[12:13], v5 offset:8
  ds_read_b64_tr_b16 v[14:15], v5 offset:520
  ds_read_b64_tr_b16 v[16:17], v5 offset:64
  ds_read_b64_tr_b16 v[18:19], v5 offset:576
  ds_read_b64_tr_b16 v[20:21], v5 offset:72
  ds_read_b64_tr_b16 v[22:23], v5 offset:584
  v_add_u32 v5, 4096, v5
  s_add_u32 s53, s53, 1
  s_mov_b32 s54, s47
  s_waitcnt lgkmcnt(6)
  buffer_store_dwordx4 v[8:11], v4, s[12:15], s54 offen sc1
  s_add_u32 s54, s54, s55
  s_waitcnt lgkmcnt(4)
  buffer_store_dwordx4 v[12:15], v4, s[12:15], s54 offen sc1
  s_add_u32 s54, s54, s55
  s_waitcnt lgkmcnt(2)
  buffer_store_dwordx4 v[16:19], v4, s[12:15], s54 offen sc1
  s_add_u32 s54, s54, s55
  s_waitcnt lgkmcnt(0)
  buffer_store_dwordx4 v[20:23], v4, s[12:15], s54 offen sc1
  v_dot2_f32_bf16 v24, v8, s52, v24
  v_dot2_f32_bf16 v25, v12, s52, v25
  v_dot2_f32_bf16 v26, v16, s52, v26
  v_dot2_f32_bf16 v27, v20, s52, v27
  v_dot2_f32_bf16 v24, v9, s52, v24
  v_dot2_f32_bf16 v25, v13, s52, v25
  v_dot2_f32_bf16 v26, v17, s52, v26
  v_dot2_f32_bf16 v27, v21, s52, v27
  v_dot2_f32_bf16 v24, v10, s52, v24
  v_dot2_f32_bf16 v25, v14, s52, v25
  v_dot2_f32_bf16 v26, v18, s52, v26
  v_dot2_f32_bf16 v27, v22, s52, v27
  v_dot2_f32_bf16 v24, v11, s52, v24
  v_dot2_f32_bf16 v25, v15, s52, v25
  v_dot2_f32_bf16 v26, v19, s52, v26
  v_dot2_f32_bf16 v27, v23, s52, v27
  s_add_u32 s47, s47, 1024
  s_cmp_lt_u32 s53, s43
  s_cbranch_scc1 sequential_preLN__ssm_conv_h3__mixer_s_mlp__prompt_kernel_wtrB
  s_cmp_ge_u32 s46, 5
  s_cbranch_scc1 sequential_preLN__ssm_conv_h3__mixer_s_mlp__prompt_kernel_doneB
  v_mov_b32 v28, v24
  v_mov_b32 v29, v25
  v_mov_b32 v30, v26
  v_mov_b32 v31, v27
  v_permlane32_swap_b32 v24, v28
  v_permlane32_swap_b32 v25, v29
  v_permlane32_swap_b32 v26, v30
  v_permlane32_swap_b32 v27, v31
  v_add_f32 v24, v24, v28
  v_add_f32 v25, v25, v29
  v_add_f32 v26, v26, v30
  v_add_f32 v27, v27, v31
  v_mov_b32 v28, v24
  v_mov_b32 v29, v25
  v_mov_b32 v30, v26
  v_mov_b32 v31, v27
  v_permlane16_swap_b32 v24, v28
  v_permlane16_swap_b32 v25, v29
  v_permlane16_swap_b32 v26, v30
  v_permlane16_swap_b32 v27, v31
  v_add_f32 v24, v24, v28
  v_add_f32 v25, v25, v29
  v_add_f32 v26, v26, v30
  v_add_f32 v27, v27, v31
  s_mul_i32 s47, s46, 6912
  s_lshl_b32 s52, s42, 8
  s_add_u32 s47, s47, s52
  s_add_u32 s47, s47, 11321344
  v_lshlrev_b32 v6, 2, v2
  s_mov_b64 exec, 0xffff
  buffer_store_dword v24, v6, s[12:15], s47 offen offset:0 sc1
  buffer_store_dword v25, v6, s[12:15], s47 offen offset:64 sc1
  buffer_store_dword v26, v6, s[12:15], s47 offen offset:128 sc1
  buffer_store_dword v27, v6, s[12:15], s47 offen offset:192 sc1
  s_mov_b64 exec, -1
  s_branch sequential_preLN__ssm_conv_h3__mixer_s_mlp__prompt_kernel_doneB
sequential_preLN__ssm_conv_h3__mixer_s_mlp__prompt_kernel_doneB:
  s_waitcnt vmcnt(0)
  s_barrier
  s_cmp_lg_u32 s10, 0
  s_cbranch_scc1 sequential_preLN__ssm_conv_h3__mixer_s_mlp__prompt_kernel_sig12
  s_mov_b32 s84, 29083776
  v_mov_b32 v5, 0
  v_mov_b32 v6, 1
  s_mov_b64 exec, 1
  buffer_atomic_add v6, v5, s[12:15], s84 offen sc0 sc1
  s_mov_b32 s84, 29085056
  s_waitcnt vmcnt(0)
  v_cmp_eq_u32 vcc, 95, v6
  v_mov_b32 v6, 1
  s_nop 3
  s_and_b64 exec, exec, vcc
  s_cbranch_execz sequential_preLN__ssm_conv_h3__mixer_s_mlp__prompt_kernel_sig12_x
  buffer_store_dword v6, v5, s[12:15], s84 offen sc1
sequential_preLN__ssm_conv_h3__mixer_s_mlp__prompt_kernel_sig12_x:
  s_mov_b64 exec, -1
sequential_preLN__ssm_conv_h3__mixer_s_mlp__prompt_kernel_sig12:
  v_lshrrev_b32 v10, 2, v2
  v_mul_u32_u24 v10, 5120, v10
  v_and_b32 v11, 3, v2
  v_lshl_add_u32 v10, v11, 8, v10
  v_xor_b32 v11, v3, v2
  s_mul_i32 s36, s10, 5
  s_add_u32 s37, s36, 0
  s_and_b32 s38, s37, 3
  s_lshl_b32 s38, s38, 2
  s_lshr_b32 s37, s37, 2
  s_lshl_b32 s37, s37, 10
  v_xor_b32 v16, s38, v11
  v_lshlrev_b32 v16, 4, v16
  v_add3_u32 v16, v16, v10, s37
  s_add_u32 s37, s36, 1
  s_and_b32 s38, s37, 3
  s_lshl_b32 s38, s38, 2
  s_lshr_b32 s37, s37, 2
  s_lshl_b32 s37, s37, 10
  v_xor_b32 v17, s38, v11
  v_lshlrev_b32 v17, 4, v17
  v_add3_u32 v17, v17, v10, s37
  s_add_u32 s37, s36, 2
  s_and_b32 s38, s37, 3
  s_lshl_b32 s38, s38, 2
  s_lshr_b32 s37, s37, 2
  s_lshl_b32 s37, s37, 10
  v_xor_b32 v18, s38, v11
  v_lshlrev_b32 v18, 4, v18
  v_add3_u32 v18, v18, v10, s37
  s_add_u32 s37, s36, 3
  s_and_b32 s38, s37, 3
  s_lshl_b32 s38, s38, 2
  s_lshr_b32 s37, s37, 2
  s_lshl_b32 s37, s37, 10
  v_xor_b32 v19, s38, v11
  v_lshlrev_b32 v19, 4, v19
  v_add3_u32 v19, v19, v10, s37
  s_add_u32 s37, s36, 4
  s_and_b32 s38, s37, 3
  s_lshl_b32 s38, s38, 2
  s_lshr_b32 s37, s37, 2
  s_lshl_b32 s37, s37, 10
  v_xor_b32 v20, s38, v11
  v_lshlrev_b32 v20, 4, v20
  v_add3_u32 v20, v20, v10, s37
  s_barrier
  ds_read_b128 v[32:35], v16 offset:0
  ds_read_b128 v[36:39], v17 offset:0
  ds_read_b128 v[40:43], v18 offset:0
  ds_read_b128 v[44:47], v19 offset:0
  ds_read_b128 v[48:51], v20 offset:0
  ds_read_b128 v[52:55], v16 offset:20480
  ds_read_b128 v[56:59], v17 offset:20480
  ds_read_b128 v[60:63], v18 offset:20480
  ds_read_b128 v[64:67], v19 offset:20480
  ds_read_b128 v[68:71], v20 offset:20480
  v_mov_b32 v22, 0
  v_mov_b32 v24, 0
  v_mov_b32 v26, 0
  v_mov_b32 v28, 0
  s_mov_b32 s38, 0x3f803f80
  s_waitcnt lgkmcnt(5)
  v_dot2_f32_bf16 v22, v32, s38, v22
  v_dot2_f32_bf16 v24, v32, v32, v24
  v_dot2_f32_bf16 v22, v33, s38, v22
  v_dot2_f32_bf16 v24, v33, v33, v24
  v_dot2_f32_bf16 v22, v34, s38, v22
  v_dot2_f32_bf16 v24, v34, v34, v24
  v_dot2_f32_bf16 v22, v35, s38, v22
  v_dot2_f32_bf16 v24, v35, v35, v24
  v_dot2_f32_bf16 v22, v36, s38, v22
  v_dot2_f32_bf16 v24, v36, v36, v24
  v_dot2_f32_bf16 v22, v37, s38, v22
  v_dot2_f32_bf16 v24, v37, v37, v24
  v_dot2_f32_bf16 v22, v38, s38, v22
  v_dot2_f32_bf16 v24, v38, v38, v24
  v_dot2_f32_bf16 v22, v39, s38, v22
  v_dot2_f32_bf16 v24, v39, v39, v24
  v_dot2_f32_bf16 v22, v40, s38, v22
  v_dot2_f32_bf16 v24, v40, v40, v24
  v_dot2_f32_bf16 v22, v41, s38, v22
  v_dot2_f32_bf16 v24, v41, v41, v24
  v_dot2_f32_bf16 v22, v42, s38, v22
  v_dot2_f32_bf16 v24, v42, v42, v24
  v_dot2_f32_bf16 v22, v43, s38, v22
  v_dot2_f32_bf16 v24, v43, v43, v24
  v_dot2_f32_bf16 v22, v44, s38, v22
  v_dot2_f32_bf16 v24, v44, v44, v24
  v_dot2_f32_bf16 v22, v45, s38, v22
  v_dot2_f32_bf16 v24, v45, v45, v24
  v_dot2_f32_bf16 v22, v46, s38, v22
  v_dot2_f32_bf16 v24, v46, v46, v24
  v_dot2_f32_bf16 v22, v47, s38, v22
  v_dot2_f32_bf16 v24, v47, v47, v24
  v_dot2_f32_bf16 v22, v48, s38, v22
  v_dot2_f32_bf16 v24, v48, v48, v24
  v_dot2_f32_bf16 v22, v49, s38, v22
  v_dot2_f32_bf16 v24, v49, v49, v24
  v_dot2_f32_bf16 v22, v50, s38, v22
  v_dot2_f32_bf16 v24, v50, v50, v24
  v_dot2_f32_bf16 v22, v51, s38, v22
  v_dot2_f32_bf16 v24, v51, v51, v24
  s_waitcnt lgkmcnt(0)
  v_dot2_f32_bf16 v26, v52, s38, v26
  v_dot2_f32_bf16 v28, v52, v52, v28
  v_dot2_f32_bf16 v26, v53, s38, v26
  v_dot2_f32_bf16 v28, v53, v53, v28
  v_dot2_f32_bf16 v26, v54, s38, v26
  v_dot2_f32_bf16 v28, v54, v54, v28
  v_dot2_f32_bf16 v26, v55, s38, v26
  v_dot2_f32_bf16 v28, v55, v55, v28
  v_dot2_f32_bf16 v26, v56, s38, v26
  v_dot2_f32_bf16 v28, v56, v56, v28
  v_dot2_f32_bf16 v26, v57, s38, v26
  v_dot2_f32_bf16 v28, v57, v57, v28
  v_dot2_f32_bf16 v26, v58, s38, v26
  v_dot2_f32_bf16 v28, v58, v58, v28
  v_dot2_f32_bf16 v26, v59, s38, v26
  v_dot2_f32_bf16 v28, v59, v59, v28
  v_dot2_f32_bf16 v26, v60, s38, v26
  v_dot2_f32_bf16 v28, v60, v60, v28
  v_dot2_f32_bf16 v26, v61, s38, v26
  v_dot2_f32_bf16 v28, v61, v61, v28
  v_dot2_f32_bf16 v26, v62, s38, v26
  v_dot2_f32_bf16 v28, v62, v62, v28
  v_dot2_f32_bf16 v26, v63, s38, v26
  v_dot2_f32_bf16 v28, v63, v63, v28
  v_dot2_f32_bf16 v26, v64, s38, v26
  v_dot2_f32_bf16 v28, v64, v64, v28
  v_dot2_f32_bf16 v26, v65, s38, v26
  v_dot2_f32_bf16 v28, v65, v65, v28
  v_dot2_f32_bf16 v26, v66, s38, v26
  v_dot2_f32_bf16 v28, v66, v66, v28
  v_dot2_f32_bf16 v26, v67, s38, v26
  v_dot2_f32_bf16 v28, v67, v67, v28
  v_dot2_f32_bf16 v26, v68, s38, v26
  v_dot2_f32_bf16 v28, v68, v68, v28
  v_dot2_f32_bf16 v26, v69, s38, v26
  v_dot2_f32_bf16 v28, v69, v69, v28
  v_dot2_f32_bf16 v26, v70, s38, v26
  v_dot2_f32_bf16 v28, v70, v70, v28
  v_dot2_f32_bf16 v26, v71, s38, v26
  v_dot2_f32_bf16 v28, v71, v71, v28
  v_lshlrev_b32 v10, 4, v2
  v_lshl_add_u32 v11, v3, 2, v10
  s_lshl_b32 s37, s10, 8
  s_add_u32 s37, s37, 81920
  v_permlane32_swap_b32 v22, v26
  v_permlane32_swap_b32 v24, v28
  v_add_u32 v11, s37, v11
  v_add_u32 v10, 81920, v10
  v_add_f32 v22, v22, v26
  v_add_f32 v24, v24, v28
  s_nop 1
  v_permlane16_swap_b32 v22, v24
  v_add_f32 v22, v22, v24
  ds_write_b32 v11, v22
  s_waitcnt lgkmcnt(0)
  s_barrier
  ds_read_b128 v[192:195], v10 offset:0
  ds_read_b128 v[196:199], v10 offset:256
  ds_read_b128 v[200:203], v10 offset:512
  ds_read_b128 v[204:207], v10 offset:768
  s_waitcnt lgkmcnt(0)
  v_pk_add_f32 v[192:193], v[192:193], v[196:197]
  v_pk_add_f32 v[194:195], v[194:195], v[198:199]
  v_pk_add_f32 v[200:201], v[200:201], v[204:205]
  v_pk_add_f32 v[202:203], v[202:203], v[206:207]
  v_pk_add_f32 v[192:193], v[192:193], v[200:201]
  v_pk_add_f32 v[194:195], v[194:195], v[202:203]
  s_mov_b32 s52, 0x3acccccd
  s_mov_b32 s53, 0x3727c5ac
  v_mul_f32 v192, s52, v192
  v_mul_f32 v194, s52, v194
  v_mul_f32 v193, s52, v193
  v_mul_f32 v195, s52, v195
  v_fma_f32 v193, -v192, v192, v193
  v_fma_f32 v195, -v194, v194, v195
  v_max_f32 v193, 0, v193
  v_max_f32 v195, 0, v195
  v_add_f32 v193, s53, v193
  v_add_f32 v195, s53, v195
  v_rsq_f32 v214, v193
  v_rsq_f32 v216, v195
  v_mul_f32 v215, -v192, v214
  v_mul_f32 v217, -v194, v216
  v_cmp_eq_u32 vcc, 0, v219
  s_nop 4
  s_cbranch_vccz sequential_preLN__ssm_conv_h3__mixer_s_mlp__prompt_kernel_cpaok13
  v_mov_b32 v5, 29084928
  v_mov_b32 v7, 1
  s_mov_b32 s85, 0
sequential_preLN__ssm_conv_h3__mixer_s_mlp__prompt_kernel_pl14_l:
  buffer_load_dword v6, v5, s[12:15], 0 offen sc1
  s_add_u32 s85, s85, 1
  s_waitcnt vmcnt(0)
  v_cmp_gt_u32 vcc, v7, v6
  s_cmp_gt_u32 s85, 200000
  s_cbranch_scc1 sequential_preLN__ssm_conv_h3__mixer_s_mlp__prompt_kernel_pl14
  s_nop 2
  s_nop 2
  s_cbranch_vccnz sequential_preLN__ssm_conv_h3__mixer_s_mlp__prompt_kernel_pl14_l
sequential_preLN__ssm_conv_h3__mixer_s_mlp__prompt_kernel_pl14:
sequential_preLN__ssm_conv_h3__mixer_s_mlp__prompt_kernel_cpaok13:
sequential_preLN__ssm_conv_h3__mixer_s_mlp__prompt_kernel_wfirst:
  buffer_load_dwordx4 a[0:3], v4, s[12:15], s26 offen offset:0 sc1
  buffer_load_dwordx4 a[80:83], v4, s[12:15], s28 offen offset:0 sc1
  buffer_load_dwordx4 a[160:163], v4, s[12:15], s27 offen offset:0 sc1
  buffer_load_dwordx4 a[4:7], v4, s[12:15], s26 offen offset:1024 sc1
  buffer_load_dwordx4 a[84:87], v4, s[12:15], s28 offen offset:1024 sc1
  buffer_load_dwordx4 a[164:167], v4, s[12:15], s27 offen offset:1024 sc1
  buffer_load_dwordx4 a[8:11], v4, s[12:15], s26 offen offset:2048 sc1
  buffer_load_dwordx4 a[88:91], v4, s[12:15], s28 offen offset:2048 sc1
  buffer_load_dwordx4 a[168:171], v4, s[12:15], s27 offen offset:2048 sc1
  buffer_load_dwordx4 a[12:15], v4, s[12:15], s26 offen offset:3072 sc1
  buffer_load_dwordx4 a[92:95], v4, s[12:15], s28 offen offset:3072 sc1
  buffer_load_dwordx4 a[172:175], v4, s[12:15], s27 offen offset:3072 sc1
  s_add_u32 s26, s26, 4096
  buffer_load_dwordx4 a[16:19], v4, s[12:15], s26 offen offset:0 sc1
  s_add_u32 s28, s28, 4096
  buffer_load_dwordx4 a[96:99], v4, s[12:15], s28 offen offset:0 sc1
  s_add_u32 s27, s27, 4096
  buffer_load_dwordx4 a[176:179], v4, s[12:15], s27 offen offset:0 sc1
  buffer_load_dwordx4 a[20:23], v4, s[12:15], s26 offen offset:1024 sc1
  buffer_load_dwordx4 a[100:103], v4, s[12:15], s28 offen offset:1024 sc1
  buffer_load_dwordx4 a[180:183], v4, s[12:15], s27 offen offset:1024 sc1
  buffer_load_dwordx4 a[24:27], v4, s[12:15], s26 offen offset:2048 sc1
  buffer_load_dwordx4 a[104:107], v4, s[12:15], s28 offen offset:2048 sc1
  buffer_load_dwordx4 a[184:187], v4, s[12:15], s27 offen offset:2048 sc1
  buffer_load_dwordx4 a[28:31], v4, s[12:15], s26 offen offset:3072 sc1
  buffer_load_dwordx4 a[108:111], v4, s[12:15], s28 offen offset:3072 sc1
  buffer_load_dwordx4 a[188:191], v4, s[12:15], s27 offen offset:3072 sc1
  s_add_u32 s26, s26, 4096
  buffer_load_dwordx4 a[32:35], v4, s[12:15], s26 offen offset:0 sc1
  s_add_u32 s28, s28, 4096
  buffer_load_dwordx4 a[112:115], v4, s[12:15], s28 offen offset:0 sc1
  s_add_u32 s27, s27, 4096
  buffer_load_dwordx4 a[192:195], v4, s[12:15], s27 offen offset:0 sc1
  buffer_load_dwordx4 a[36:39], v4, s[12:15], s26 offen offset:1024 sc1
  buffer_load_dwordx4 a[116:119], v4, s[12:15], s28 offen offset:1024 sc1
  buffer_load_dwordx4 a[196:199], v4, s[12:15], s27 offen offset:1024 sc1
  buffer_load_dwordx4 a[40:43], v4, s[12:15], s26 offen offset:2048 sc1
  buffer_load_dwordx4 a[120:123], v4, s[12:15], s28 offen offset:2048 sc1
  buffer_load_dwordx4 a[200:203], v4, s[12:15], s27 offen offset:2048 sc1
  buffer_load_dwordx4 a[44:47], v4, s[12:15], s26 offen offset:3072 sc1
  buffer_load_dwordx4 a[124:127], v4, s[12:15], s28 offen offset:3072 sc1
  buffer_load_dwordx4 a[204:207], v4, s[12:15], s27 offen offset:3072 sc1
sequential_preLN__ssm_conv_h3__mixer_s_mlp__prompt_kernel_wconv:
  s_add_u32 s26, s26, 4096
  buffer_load_dwordx4 a[48:51], v4, s[12:15], s26 offen offset:0 sc1
  s_add_u32 s28, s28, 4096
  buffer_load_dwordx4 a[128:131], v4, s[12:15], s28 offen offset:0 sc1
  s_add_u32 s27, s27, 4096
  buffer_load_dwordx4 a[208:211], v4, s[12:15], s27 offen offset:0 sc1
  buffer_load_dwordx4 a[52:55], v4, s[12:15], s26 offen offset:1024 sc1
  buffer_load_dwordx4 a[132:135], v4, s[12:15], s28 offen offset:1024 sc1
  buffer_load_dwordx4 a[212:215], v4, s[12:15], s27 offen offset:1024 sc1
  buffer_load_dwordx4 a[56:59], v4, s[12:15], s26 offen offset:2048 sc1
  buffer_load_dwordx4 a[136:139], v4, s[12:15], s28 offen offset:2048 sc1
  buffer_load_dwordx4 a[216:219], v4, s[12:15], s27 offen offset:2048 sc1
  buffer_load_dwordx4 a[60:63], v4, s[12:15], s26 offen offset:3072 sc1
  buffer_load_dwordx4 a[140:143], v4, s[12:15], s28 offen offset:3072 sc1
  buffer_load_dwordx4 a[220:223], v4, s[12:15], s27 offen offset:3072 sc1
  s_lshl_b32 s78, s10, 10
  s_mul_i32 s72, s64, 20480
  s_add_u32 s72, s72, s78
  s_add_u32 s72, s72, 6078464
  s_mul_i32 s73, s65, 20480
  s_add_u32 s73, s73, s78
  s_add_u32 s73, s73, 6078464
  s_mul_i32 s74, s66, 20480
  s_add_u32 s74, s74, s78
  s_add_u32 s74, s74, 6078464
  s_mul_i32 s75, s67, 20480
  s_add_u32 s75, s75, s78
  s_add_u32 s75, s75, 6078464
  s_mul_i32 s76, s68, 20480
  s_add_u32 s76, s76, s78
  s_add_u32 s76, s76, 6078464
  s_mul_i32 s77, s10, 5120
  s_cmp_lg_u32 s10, 0
  s_cbranch_scc1 sequential_preLN__ssm_conv_h3__mixer_s_mlp__prompt_kernel_wt15
  v_min_u32 v5, 9, v1
  v_lshlrev_b32 v5, 7, v5
  v_add_u32 v5, 29083904, v5
  v_mov_b32 v7, 1
  s_mov_b32 s85, 0
sequential_preLN__ssm_conv_h3__mixer_s_mlp__prompt_kernel_pl16_l:
  buffer_load_dword v6, v5, s[12:15], 0 offen sc1
  s_add_u32 s85, s85, 1
  s_waitcnt vmcnt(0)
  v_cmp_gt_u32 vcc, v7, v6
  s_cmp_gt_u32 s85, 200000
  s_cbranch_scc1 sequential_preLN__ssm_conv_h3__mixer_s_mlp__prompt_kernel_pl16
  s_nop 2
  s_nop 2
  s_cbranch_vccnz sequential_preLN__ssm_conv_h3__mixer_s_mlp__prompt_kernel_pl16_l
sequential_preLN__ssm_conv_h3__mixer_s_mlp__prompt_kernel_pl16:
sequential_preLN__ssm_conv_h3__mixer_s_mlp__prompt_kernel_wt15:
  s_barrier
  s_mul_i32 s32, s10, 10240
  s_add_u32 s33, s32, 40960
  s_mul_i32 s31, s24, 40960
  s_add_u32 s31, s31, s32
  s_add_u32 s31, s31, 2621440
  s_add_u32 m0, s33, 0
  s_nop 0
  buffer_load_dwordx4 v4, s[12:15], s31 offen offset:0 sc1 lds
  buffer_load_dwordx4 v4, s[12:15], s31 offen offset:1024 sc1 lds
  buffer_load_dwordx4 v4, s[12:15], s31 offen offset:2048 sc1 lds
  buffer_load_dwordx4 v4, s[12:15], s31 offen offset:3072 sc1 lds
  s_add_u32 m0, s33, 4096
  s_add_u32 s31, s31, 4096
  buffer_load_dwordx4 v4, s[12:15], s31 offen offset:0 sc1 lds
  buffer_load_dwordx4 v4, s[12:15], s31 offen offset:1024 sc1 lds
  buffer_load_dwordx4 v4, s[12:15], s31 offen offset:2048 sc1 lds
  buffer_load_dwordx4 v4, s[12:15], s31 offen offset:3072 sc1 lds
  s_add_u32 m0, s33, 8192
  s_add_u32 s31, s31, 4096
  buffer_load_dwordx4 v4, s[12:15], s31 offen offset:0 sc1 lds
  buffer_load_dwordx4 v4, s[12:15], s31 offen offset:1024 sc1 lds
  s_lshl_b32 s29, s24, 5
  v_bfe_u32 v10, v1, 2, 2
  v_lshl_add_u32 v10, v3, 3, v10
  v_lshlrev_b32 v10, 6, v10
  v_and_b32 v11, 3, v1
  v_lshl_add_u32 v10, v11, 3, v10
  v_add_u32 v21, s33, v10
  s_and_b32 s37, s25, 1
  s_lshl_b32 s37, s37, 1
  s_sub_u32 s37, 1, s37
  s_lshr_b32 s38, s25, 1
  s_lshl_b32 s37, s37, s38
  s_add_u32 s37, s37, s29
  s_mul_i32 s39, s25, 5
  v_lshlrev_b32 v11, 8, v3
  s_add_u32 s46, s39, s10
  s_lshl_b32 s46, s46, 10
  s_add_u32 s46, s46, 16601088
  s_add_u32 s47, s39, 4
  s_lshl_b32 s47, s47, 10
  s_add_u32 s47, s47, 16601088
  s_lshr_b32 s38, s10, 1
  s_lshl_b32 s38, s38, 3
  s_add_u32 s47, s47, s38
  s_and_b32 s38, s10, 1
  s_lshl_b32 s38, s38, 4
  v_add_u32 v10, s37, v2
  v_cmp_le_u32 vcc, 0x800, v10
  s_nop 4
  s_mov_b64 s[40:41], vcc
  v_and_b32 v10, 0x7ff, v10
  v_lshrrev_b32 v22, 4, v10
  v_mul_u32_u24 v22, 20480, v22
  v_and_b32 v10, 15, v10
  v_lshl_add_u32 v10, v10, 4, v11
  v_add3_u32 v240, v10, v22, s46
  v_add_u32 v10, s37, v2
  v_add_u32 v10, 16, v10
  v_cmp_le_u32 vcc, 0x800, v10
  s_nop 4
  s_mov_b64 s[42:43], vcc
  v_and_b32 v10, 0x7ff, v10
  v_lshrrev_b32 v22, 4, v10
  v_mul_u32_u24 v22, 20480, v22
  v_and_b32 v10, 15, v10
  v_lshl_add_u32 v10, v10, 4, v11
  v_add3_u32 v241, v10, v22, s46
  v_add_u32 v10, s37, v2
  v_add_u32 v10, s38, v10
  v_cmp_le_u32 vcc, 0x800, v10
  s_nop 4
  s_mov_b64 s[44:45], vcc
  v_and_b32 v10, 0x7ff, v10
  v_lshrrev_b32 v22, 4, v10
  v_mul_u32_u24 v22, 20480, v22
  v_and_b32 v10, 15, v10
  v_lshl_add_u32 v10, v10, 4, v11
  v_add3_u32 v242, v10, v22, s47
  s_mov_b32 s50, 0xc0135761
  s_mov_b32 s51, 0xbdd2d3e8
  s_mov_b32 s52, 0x3acccccd
  s_mov_b32 s53, 0x3727c5ac
  s_mov_b32 s54, 0xffff0000
  s_waitcnt vmcnt(0)
  s_barrier
  ds_read_b64_tr_b16 v[72:73], v21 offset:0
  ds_read_b64_tr_b16 v[74:75], v21 offset:256
  ds_read_b64_tr_b16 v[76:77], v21 offset:2048
  ds_read_b64_tr_b16 v[78:79], v21 offset:2304
  ds_read_b64_tr_b16 v[80:81], v21 offset:4096
  ds_read_b64_tr_b16 v[82:83], v21 offset:4352
  ds_read_b64_tr_b16 v[84:85], v21 offset:6144
  ds_read_b64_tr_b16 v[86:87], v21 offset:6400
  v_mov_b32 v22, 0
  v_mov_b32 v23, 0
  v_mov_b32 v24, 0
  v_mov_b32 v25, 0
  v_mov_b32 v26, 0
  v_mov_b32 v27, 0
  v_mov_b32 v28, 0
  v_mov_b32 v29, 0
  s_waitcnt lgkmcnt(6)
  ds_read_b64_tr_b16 v[88:89], v21 offset:8192
  ds_read_b64_tr_b16 v[90:91], v21 offset:8448
  v_lshlrev_b32 v192, 16, v32
  v_and_b32 v193, s54, v32
  v_lshlrev_b32 v194, 16, v72
  v_and_b32 v195, s54, v72
  v_pk_fma_f32 v[112:113], v[192:193], v[214:215], v[214:215] op_sel:[0,0,1] op_sel_hi:[1,0,1]
  v_pk_fma_f32 v[112:113], v[112:113], v[194:195], v[192:193]
  v_pk_add_f32 v[22:23], v[22:23], v[112:113]
  v_pk_fma_f32 v[24:25], v[112:113], v[112:113], v[24:25]
  v_lshlrev_b32 v196, 16, v33
  v_and_b32 v197, s54, v33
  v_lshlrev_b32 v198, 16, v73
  v_and_b32 v199, s54, v73
  v_pk_fma_f32 v[114:115], v[196:197], v[214:215], v[214:215] op_sel:[0,0,1] op_sel_hi:[1,0,1]
  v_pk_fma_f32 v[114:115], v[114:115], v[198:199], v[196:197]
  v_pk_add_f32 v[22:23], v[22:23], v[114:115]
  v_pk_fma_f32 v[24:25], v[114:115], v[114:115], v[24:25]
  s_add_u32 s26, s26, 4096
  buffer_load_dwordx4 a[64:67], v4, s[12:15], s26 offen offset:0 sc1
  v_lshlrev_b32 v192, 16, v34
  v_and_b32 v193, s54, v34
  v_lshlrev_b32 v194, 16, v74
  v_and_b32 v195, s54, v74
  v_pk_fma_f32 v[116:117], v[192:193], v[214:215], v[214:215] op_sel:[0,0,1] op_sel_hi:[1,0,1]
  v_pk_fma_f32 v[116:117], v[116:117], v[194:195], v[192:193]
  v_pk_add_f32 v[22:23], v[22:23], v[116:117]
  v_pk_fma_f32 v[24:25], v[116:117], v[116:117], v[24:25]
  v_lshlrev_b32 v196, 16, v35
  v_and_b32 v197, s54, v35
  v_lshlrev_b32 v198, 16, v75
  v_and_b32 v199, s54, v75
  v_pk_fma_f32 v[118:119], v[196:197], v[214:215], v[214:215] op_sel:[0,0,1] op_sel_hi:[1,0,1]
  v_pk_fma_f32 v[118:119], v[118:119], v[198:199], v[196:197]
  v_pk_add_f32 v[22:23], v[22:23], v[118:119]
  v_pk_fma_f32 v[24:25], v[118:119], v[118:119], v[24:25]
  s_add_u32 s28, s28, 4096
  buffer_load_dwordx4 a[144:147], v4, s[12:15], s28 offen offset:0 sc1
  s_waitcnt lgkmcnt(6)
  ds_read_b64_tr_b16 v[92:93], v21 offset:32
  ds_read_b64_tr_b16 v[94:95], v21 offset:288
  v_lshlrev_b32 v192, 16, v36
  v_and_b32 v193, s54, v36
  v_lshlrev_b32 v194, 16, v76
  v_and_b32 v195, s54, v76
  v_pk_fma_f32 v[120:121], v[192:193], v[214:215], v[214:215] op_sel:[0,0,1] op_sel_hi:[1,0,1]
  v_pk_fma_f32 v[120:121], v[120:121], v[194:195], v[192:193]
  v_pk_add_f32 v[22:23], v[22:23], v[120:121]
  v_pk_fma_f32 v[24:25], v[120:121], v[120:121], v[24:25]
  v_lshlrev_b32 v196, 16, v37
  v_and_b32 v197, s54, v37
  v_lshlrev_b32 v198, 16, v77
  v_and_b32 v199, s54, v77
  v_pk_fma_f32 v[122:123], v[196:197], v[214:215], v[214:215] op_sel:[0,0,1] op_sel_hi:[1,0,1]
  v_pk_fma_f32 v[122:123], v[122:123], v[198:199], v[196:197]
  v_pk_add_f32 v[22:23], v[22:23], v[122:123]
  v_pk_fma_f32 v[24:25], v[122:123], v[122:123], v[24:25]
  s_add_u32 s27, s27, 4096
  buffer_load_dwordx4 a[224:227], v4, s[12:15], s27 offen offset:0 sc1
  v_lshlrev_b32 v192, 16, v38
  v_and_b32 v193, s54, v38
  v_lshlrev_b32 v194, 16, v78
  v_and_b32 v195, s54, v78
  v_pk_fma_f32 v[124:125], v[192:193], v[214:215], v[214:215] op_sel:[0,0,1] op_sel_hi:[1,0,1]
  v_pk_fma_f32 v[124:125], v[124:125], v[194:195], v[192:193]
  v_pk_add_f32 v[22:23], v[22:23], v[124:125]
  v_pk_fma_f32 v[24:25], v[124:125], v[124:125], v[24:25]
  v_lshlrev_b32 v196, 16, v39
  v_and_b32 v197, s54, v39
  v_lshlrev_b32 v198, 16, v79
  v_and_b32 v199, s54, v79
  v_pk_fma_f32 v[126:127], v[196:197], v[214:215], v[214:215] op_sel:[0,0,1] op_sel_hi:[1,0,1]
  v_pk_fma_f32 v[126:127], v[126:127], v[198:199], v[196:197]
  v_pk_add_f32 v[22:23], v[22:23], v[126:127]
  v_pk_fma_f32 v[24:25], v[126:127], v[126:127], v[24:25]
  buffer_load_dwordx4 a[68:71], v4, s[12:15], s26 offen offset:1024 sc1
  s_waitcnt lgkmcnt(6)
  ds_read_b64_tr_b16 v[96:97], v21 offset:2080
  ds_read_b64_tr_b16 v[98:99], v21 offset:2336
  v_lshlrev_b32 v192, 16, v40
  v_and_b32 v193, s54, v40
  v_lshlrev_b32 v194, 16, v80
  v_and_b32 v195, s54, v80
  v_pk_fma_f32 v[128:129], v[192:193], v[214:215], v[214:215] op_sel:[0,0,1] op_sel_hi:[1,0,1]
  v_pk_fma_f32 v[128:129], v[128:129], v[194:195], v[192:193]
  v_pk_add_f32 v[22:23], v[22:23], v[128:129]
  v_pk_fma_f32 v[24:25], v[128:129], v[128:129], v[24:25]
  v_lshlrev_b32 v196, 16, v41
  v_and_b32 v197, s54, v41
  v_lshlrev_b32 v198, 16, v81
  v_and_b32 v199, s54, v81
  v_pk_fma_f32 v[130:131], v[196:197], v[214:215], v[214:215] op_sel:[0,0,1] op_sel_hi:[1,0,1]
  v_pk_fma_f32 v[130:131], v[130:131], v[198:199], v[196:197]
  v_pk_add_f32 v[22:23], v[22:23], v[130:131]
  v_pk_fma_f32 v[24:25], v[130:131], v[130:131], v[24:25]
  buffer_load_dwordx4 a[148:151], v4, s[12:15], s28 offen offset:1024 sc1
  v_lshlrev_b32 v192, 16, v42
  v_and_b32 v193, s54, v42
  v_lshlrev_b32 v194, 16, v82
  v_and_b32 v195, s54, v82
  v_pk_fma_f32 v[132:133], v[192:193], v[214:215], v[214:215] op_sel:[0,0,1] op_sel_hi:[1,0,1]
  v_pk_fma_f32 v[132:133], v[132:133], v[194:195], v[192:193]
  v_pk_add_f32 v[22:23], v[22:23], v[132:133]
  v_pk_fma_f32 v[24:25], v[132:133], v[132:133], v[24:25]
  v_lshlrev_b32 v196, 16, v43
  v_and_b32 v197, s54, v43
  v_lshlrev_b32 v198, 16, v83
  v_and_b32 v199, s54, v83
  v_pk_fma_f32 v[134:135], v[196:197], v[214:215], v[214:215] op_sel:[0,0,1] op_sel_hi:[1,0,1]
  v_pk_fma_f32 v[134:135], v[134:135], v[198:199], v[196:197]
  v_pk_add_f32 v[22:23], v[22:23], v[134:135]
  v_pk_fma_f32 v[24:25], v[134:135], v[134:135], v[24:25]
  buffer_load_dwordx4 a[228:231], v4, s[12:15], s27 offen offset:1024 sc1
  s_waitcnt lgkmcnt(6)
  ds_read_b64_tr_b16 v[100:101], v21 offset:4128
  ds_read_b64_tr_b16 v[102:103], v21 offset:4384
  v_lshlrev_b32 v192, 16, v44
  v_and_b32 v193, s54, v44
  v_lshlrev_b32 v194, 16, v84
  v_and_b32 v195, s54, v84
  v_pk_fma_f32 v[136:137], v[192:193], v[214:215], v[214:215] op_sel:[0,0,1] op_sel_hi:[1,0,1]
  v_pk_fma_f32 v[136:137], v[136:137], v[194:195], v[192:193]
  v_pk_add_f32 v[22:23], v[22:23], v[136:137]
  v_pk_fma_f32 v[24:25], v[136:137], v[136:137], v[24:25]
  v_lshlrev_b32 v196, 16, v45
  v_and_b32 v197, s54, v45
  v_lshlrev_b32 v198, 16, v85
  v_and_b32 v199, s54, v85
  v_pk_fma_f32 v[138:139], v[196:197], v[214:215], v[214:215] op_sel:[0,0,1] op_sel_hi:[1,0,1]
  v_pk_fma_f32 v[138:139], v[138:139], v[198:199], v[196:197]
  v_pk_add_f32 v[22:23], v[22:23], v[138:139]
  v_pk_fma_f32 v[24:25], v[138:139], v[138:139], v[24:25]
  buffer_load_dwordx4 a[72:75], v4, s[12:15], s26 offen offset:2048 sc1
  v_lshlrev_b32 v192, 16, v46
  v_and_b32 v193, s54, v46
  v_lshlrev_b32 v194, 16, v86
  v_and_b32 v195, s54, v86
  v_pk_fma_f32 v[140:141], v[192:193], v[214:215], v[214:215] op_sel:[0,0,1] op_sel_hi:[1,0,1]
  v_pk_fma_f32 v[140:141], v[140:141], v[194:195], v[192:193]
  v_pk_add_f32 v[22:23], v[22:23], v[140:141]
  v_pk_fma_f32 v[24:25], v[140:141], v[140:141], v[24:25]
  v_lshlrev_b32 v196, 16, v47
  v_and_b32 v197, s54, v47
  v_lshlrev_b32 v198, 16, v87
  v_and_b32 v199, s54, v87
  v_pk_fma_f32 v[142:143], v[196:197], v[214:215], v[214:215] op_sel:[0,0,1] op_sel_hi:[1,0,1]
  v_pk_fma_f32 v[142:143], v[142:143], v[198:199], v[196:197]
  v_pk_add_f32 v[22:23], v[22:23], v[142:143]
  v_pk_fma_f32 v[24:25], v[142:143], v[142:143], v[24:25]
  buffer_load_dwordx4 a[152:155], v4, s[12:15], s28 offen offset:2048 sc1
  s_waitcnt lgkmcnt(6)
  ds_read_b64_tr_b16 v[104:105], v21 offset:6176
  ds_read_b64_tr_b16 v[106:107], v21 offset:6432
  v_lshlrev_b32 v192, 16, v48
  v_and_b32 v193, s54, v48
  v_lshlrev_b32 v194, 16, v88
  v_and_b32 v195, s54, v88
  v_pk_fma_f32 v[144:145], v[192:193], v[214:215], v[214:215] op_sel:[0,0,1] op_sel_hi:[1,0,1]
  v_pk_fma_f32 v[144:145], v[144:145], v[194:195], v[192:193]
  v_pk_add_f32 v[22:23], v[22:23], v[144:145]
  v_pk_fma_f32 v[24:25], v[144:145], v[144:145], v[24:25]
  v_lshlrev_b32 v196, 16, v49
  v_and_b32 v197, s54, v49
  v_lshlrev_b32 v198, 16, v89
  v_and_b32 v199, s54, v89
  v_pk_fma_f32 v[146:147], v[196:197], v[214:215], v[214:215] op_sel:[0,0,1] op_sel_hi:[1,0,1]
  v_pk_fma_f32 v[146:147], v[146:147], v[198:199], v[196:197]
  v_pk_add_f32 v[22:23], v[22:23], v[146:147]
  v_pk_fma_f32 v[24:25], v[146:147], v[146:147], v[24:25]
  buffer_load_dwordx4 a[232:235], v4, s[12:15], s27 offen offset:2048 sc1
  v_lshlrev_b32 v192, 16, v50
  v_and_b32 v193, s54, v50
  v_lshlrev_b32 v194, 16, v90
  v_and_b32 v195, s54, v90
  v_pk_fma_f32 v[148:149], v[192:193], v[214:215], v[214:215] op_sel:[0,0,1] op_sel_hi:[1,0,1]
  v_pk_fma_f32 v[148:149], v[148:149], v[194:195], v[192:193]
  v_pk_add_f32 v[22:23], v[22:23], v[148:149]
  v_pk_fma_f32 v[24:25], v[148:149], v[148:149], v[24:25]
  v_lshlrev_b32 v196, 16, v51
  v_and_b32 v197, s54, v51
  v_lshlrev_b32 v198, 16, v91
  v_and_b32 v199, s54, v91
  v_pk_fma_f32 v[150:151], v[196:197], v[214:215], v[214:215] op_sel:[0,0,1] op_sel_hi:[1,0,1]
  v_pk_fma_f32 v[150:151], v[150:151], v[198:199], v[196:197]
  v_pk_add_f32 v[22:23], v[22:23], v[150:151]
  v_pk_fma_f32 v[24:25], v[150:151], v[150:151], v[24:25]
  buffer_load_dwordx4 a[76:79], v4, s[12:15], s26 offen offset:3072 sc1
  s_waitcnt lgkmcnt(6)
  ds_read_b64_tr_b16 v[108:109], v21 offset:8224
  ds_read_b64_tr_b16 v[110:111], v21 offset:8480
  v_lshlrev_b32 v192, 16, v52
  v_and_b32 v193, s54, v52
  v_lshlrev_b32 v194, 16, v92
  v_and_b32 v195, s54, v92
  v_pk_fma_f32 v[152:153], v[192:193], v[216:217], v[216:217] op_sel:[0,0,1] op_sel_hi:[1,0,1]
  v_pk_fma_f32 v[152:153], v[152:153], v[194:195], v[192:193]
  v_pk_add_f32 v[26:27], v[26:27], v[152:153]
  v_pk_fma_f32 v[28:29], v[152:153], v[152:153], v[28:29]
  v_lshlrev_b32 v196, 16, v53
  v_and_b32 v197, s54, v53
  v_lshlrev_b32 v198, 16, v93
  v_and_b32 v199, s54, v93
  v_pk_fma_f32 v[154:155], v[196:197], v[216:217], v[216:217] op_sel:[0,0,1] op_sel_hi:[1,0,1]
  v_pk_fma_f32 v[154:155], v[154:155], v[198:199], v[196:197]
  v_pk_add_f32 v[26:27], v[26:27], v[154:155]
  v_pk_fma_f32 v[28:29], v[154:155], v[154:155], v[28:29]
  buffer_load_dwordx4 a[156:159], v4, s[12:15], s28 offen offset:3072 sc1
  v_lshlrev_b32 v192, 16, v54
  v_and_b32 v193, s54, v54
  v_lshlrev_b32 v194, 16, v94
  v_and_b32 v195, s54, v94
  v_pk_fma_f32 v[156:157], v[192:193], v[216:217], v[216:217] op_sel:[0,0,1] op_sel_hi:[1,0,1]
  v_pk_fma_f32 v[156:157], v[156:157], v[194:195], v[192:193]
  v_pk_add_f32 v[26:27], v[26:27], v[156:157]
  v_pk_fma_f32 v[28:29], v[156:157], v[156:157], v[28:29]
  v_lshlrev_b32 v196, 16, v55
  v_and_b32 v197, s54, v55
  v_lshlrev_b32 v198, 16, v95
  v_and_b32 v199, s54, v95
  v_pk_fma_f32 v[158:159], v[196:197], v[216:217], v[216:217] op_sel:[0,0,1] op_sel_hi:[1,0,1]
  v_pk_fma_f32 v[158:159], v[158:159], v[198:199], v[196:197]
  v_pk_add_f32 v[26:27], v[26:27], v[158:159]
  v_pk_fma_f32 v[28:29], v[158:159], v[158:159], v[28:29]
  buffer_load_dwordx4 a[236:239], v4, s[12:15], s27 offen offset:3072 sc1
  s_waitcnt lgkmcnt(6)
  v_lshlrev_b32 v192, 16, v56
  v_and_b32 v193, s54, v56
  v_lshlrev_b32 v194, 16, v96
  v_and_b32 v195, s54, v96
  v_pk_fma_f32 v[160:161], v[192:193], v[216:217], v[216:217] op_sel:[0,0,1] op_sel_hi:[1,0,1]
  v_pk_fma_f32 v[160:161], v[160:161], v[194:195], v[192:193]
  v_pk_add_f32 v[26:27], v[26:27], v[160:161]
  v_pk_fma_f32 v[28:29], v[160:161], v[160:161], v[28:29]
  v_lshlrev_b32 v196, 16, v57
  v_and_b32 v197, s54, v57
  v_lshlrev_b32 v198, 16, v97
  v_and_b32 v199, s54, v97
  v_pk_fma_f32 v[162:163], v[196:197], v[216:217], v[216:217] op_sel:[0,0,1] op_sel_hi:[1,0,1]
  v_pk_fma_f32 v[162:163], v[162:163], v[198:199], v[196:197]
  v_pk_add_f32 v[26:27], v[26:27], v[162:163]
  v_pk_fma_f32 v[28:29], v[162:163], v[162:163], v[28:29]
  v_lshlrev_b32 v192, 16, v58
  v_and_b32 v193, s54, v58
  v_lshlrev_b32 v194, 16, v98
  v_and_b32 v195, s54, v98
  v_pk_fma_f32 v[164:165], v[192:193], v[216:217], v[216:217] op_sel:[0,0,1] op_sel_hi:[1,0,1]
  v_pk_fma_f32 v[164:165], v[164:165], v[194:195], v[192:193]
  v_pk_add_f32 v[26:27], v[26:27], v[164:165]
  v_pk_fma_f32 v[28:29], v[164:165], v[164:165], v[28:29]
  v_lshlrev_b32 v196, 16, v59
  v_and_b32 v197, s54, v59
  v_lshlrev_b32 v198, 16, v99
  v_and_b32 v199, s54, v99
  v_pk_fma_f32 v[166:167], v[196:197], v[216:217], v[216:217] op_sel:[0,0,1] op_sel_hi:[1,0,1]
  v_pk_fma_f32 v[166:167], v[166:167], v[198:199], v[196:197]
  v_pk_add_f32 v[26:27], v[26:27], v[166:167]
  v_pk_fma_f32 v[28:29], v[166:167], v[166:167], v[28:29]
  s_waitcnt lgkmcnt(4)
  v_lshlrev_b32 v192, 16, v60
  v_and_b32 v193, s54, v60
  v_lshlrev_b32 v194, 16, v100
  v_and_b32 v195, s54, v100
  v_pk_fma_f32 v[168:169], v[192:193], v[216:217], v[216:217] op_sel:[0,0,1] op_sel_hi:[1,0,1]
  v_pk_fma_f32 v[168:169], v[168:169], v[194:195], v[192:193]
  v_pk_add_f32 v[26:27], v[26:27], v[168:169]
  v_pk_fma_f32 v[28:29], v[168:169], v[168:169], v[28:29]
  v_lshlrev_b32 v196, 16, v61
  v_and_b32 v197, s54, v61
  v_lshlrev_b32 v198, 16, v101
  v_and_b32 v199, s54, v101
  v_pk_fma_f32 v[170:171], v[196:197], v[216:217], v[216:217] op_sel:[0,0,1] op_sel_hi:[1,0,1]
  v_pk_fma_f32 v[170:171], v[170:171], v[198:199], v[196:197]
  v_pk_add_f32 v[26:27], v[26:27], v[170:171]
  v_pk_fma_f32 v[28:29], v[170:171], v[170:171], v[28:29]
  v_lshlrev_b32 v192, 16, v62
  v_and_b32 v193, s54, v62
  v_lshlrev_b32 v194, 16, v102
  v_and_b32 v195, s54, v102
  v_pk_fma_f32 v[172:173], v[192:193], v[216:217], v[216:217] op_sel:[0,0,1] op_sel_hi:[1,0,1]
  v_pk_fma_f32 v[172:173], v[172:173], v[194:195], v[192:193]
  v_pk_add_f32 v[26:27], v[26:27], v[172:173]
  v_pk_fma_f32 v[28:29], v[172:173], v[172:173], v[28:29]
  v_lshlrev_b32 v196, 16, v63
  v_and_b32 v197, s54, v63
  v_lshlrev_b32 v198, 16, v103
  v_and_b32 v199, s54, v103
  v_pk_fma_f32 v[174:175], v[196:197], v[216:217], v[216:217] op_sel:[0,0,1] op_sel_hi:[1,0,1]
  v_pk_fma_f32 v[174:175], v[174:175], v[198:199], v[196:197]
  v_pk_add_f32 v[26:27], v[26:27], v[174:175]
  v_pk_fma_f32 v[28:29], v[174:175], v[174:175], v[28:29]
  s_waitcnt lgkmcnt(2)
  v_lshlrev_b32 v192, 16, v64
  v_and_b32 v193, s54, v64
  v_lshlrev_b32 v194, 16, v104
  v_and_b32 v195, s54, v104
  v_pk_fma_f32 v[176:177], v[192:193], v[216:217], v[216:217] op_sel:[0,0,1] op_sel_hi:[1,0,1]
  v_pk_fma_f32 v[176:177], v[176:177], v[194:195], v[192:193]
  v_pk_add_f32 v[26:27], v[26:27], v[176:177]
  v_pk_fma_f32 v[28:29], v[176:177], v[176:177], v[28:29]
  v_lshlrev_b32 v196, 16, v65
  v_and_b32 v197, s54, v65
  v_lshlrev_b32 v198, 16, v105
  v_and_b32 v199, s54, v105
  v_pk_fma_f32 v[178:179], v[196:197], v[216:217], v[216:217] op_sel:[0,0,1] op_sel_hi:[1,0,1]
  v_pk_fma_f32 v[178:179], v[178:179], v[198:199], v[196:197]
  v_pk_add_f32 v[26:27], v[26:27], v[178:179]
  v_pk_fma_f32 v[28:29], v[178:179], v[178:179], v[28:29]
  v_lshlrev_b32 v192, 16, v66
  v_and_b32 v193, s54, v66
  v_lshlrev_b32 v194, 16, v106
  v_and_b32 v195, s54, v106
  v_pk_fma_f32 v[180:181], v[192:193], v[216:217], v[216:217] op_sel:[0,0,1] op_sel_hi:[1,0,1]
  v_pk_fma_f32 v[180:181], v[180:181], v[194:195], v[192:193]
  v_pk_add_f32 v[26:27], v[26:27], v[180:181]
  v_pk_fma_f32 v[28:29], v[180:181], v[180:181], v[28:29]
  v_lshlrev_b32 v196, 16, v67
  v_and_b32 v197, s54, v67
  v_lshlrev_b32 v198, 16, v107
  v_and_b32 v199, s54, v107
  v_pk_fma_f32 v[182:183], v[196:197], v[216:217], v[216:217] op_sel:[0,0,1] op_sel_hi:[1,0,1]
  v_pk_fma_f32 v[182:183], v[182:183], v[198:199], v[196:197]
  v_pk_add_f32 v[26:27], v[26:27], v[182:183]
  v_pk_fma_f32 v[28:29], v[182:183], v[182:183], v[28:29]
  s_waitcnt lgkmcnt(0)
  v_lshlrev_b32 v192, 16, v68
  v_and_b32 v193, s54, v68
  v_lshlrev_b32 v194, 16, v108
  v_and_b32 v195, s54, v108
  v_pk_fma_f32 v[184:185], v[192:193], v[216:217], v[216:217] op_sel:[0,0,1] op_sel_hi:[1,0,1]
  v_pk_fma_f32 v[184:185], v[184:185], v[194:195], v[192:193]
  v_pk_add_f32 v[26:27], v[26:27], v[184:185]
  v_pk_fma_f32 v[28:29], v[184:185], v[184:185], v[28:29]
  v_lshlrev_b32 v196, 16, v69
  v_and_b32 v197, s54, v69
  v_lshlrev_b32 v198, 16, v109
  v_and_b32 v199, s54, v109
  v_pk_fma_f32 v[186:187], v[196:197], v[216:217], v[216:217] op_sel:[0,0,1] op_sel_hi:[1,0,1]
  v_pk_fma_f32 v[186:187], v[186:187], v[198:199], v[196:197]
  v_pk_add_f32 v[26:27], v[26:27], v[186:187]
  v_pk_fma_f32 v[28:29], v[186:187], v[186:187], v[28:29]
  v_lshlrev_b32 v192, 16, v70
  v_and_b32 v193, s54, v70
  v_lshlrev_b32 v194, 16, v110
  v_and_b32 v195, s54, v110
  v_pk_fma_f32 v[188:189], v[192:193], v[216:217], v[216:217] op_sel:[0,0,1] op_sel_hi:[1,0,1]
  v_pk_fma_f32 v[188:189], v[188:189], v[194:195], v[192:193]
  v_pk_add_f32 v[26:27], v[26:27], v[188:189]
  v_pk_fma_f32 v[28:29], v[188:189], v[188:189], v[28:29]
  v_lshlrev_b32 v196, 16, v71
  v_and_b32 v197, s54, v71
  v_lshlrev_b32 v198, 16, v111
  v_and_b32 v199, s54, v111
  v_pk_fma_f32 v[190:191], v[196:197], v[216:217], v[216:217] op_sel:[0,0,1] op_sel_hi:[1,0,1]
  v_pk_fma_f32 v[190:191], v[190:191], v[198:199], v[196:197]
  v_pk_add_f32 v[26:27], v[26:27], v[190:191]
  v_pk_fma_f32 v[28:29], v[190:191], v[190:191], v[28:29]
  v_add_f32 v22, v22, v23
  v_add_f32 v24, v24, v25
  v_add_f32 v26, v26, v27
  v_add_f32 v28, v28, v29
  v_lshlrev_b32 v10, 4, v2
  v_lshl_add_u32 v11, v3, 2, v10
  s_lshl_b32 s37, s10, 8
  s_add_u32 s37, s37, 81920
  v_permlane32_swap_b32 v22, v26
  v_permlane32_swap_b32 v24, v28
  v_add_u32 v11, s37, v11
  v_add_u32 v10, 81920, v10
  v_add_f32 v22, v22, v26
  v_add_f32 v24, v24, v28
  s_nop 1
  v_permlane16_swap_b32 v22, v24
  v_add_f32 v22, v22, v24
  ds_write_b32 v11, v22
  s_waitcnt lgkmcnt(0)
  s_barrier
  ds_read_b128 v[192:195], v10 offset:0
  ds_read_b128 v[196:199], v10 offset:256
  ds_read_b128 v[200:203], v10 offset:512
  ds_read_b128 v[204:207], v10 offset:768
  s_waitcnt lgkmcnt(0)
  v_pk_add_f32 v[192:193], v[192:193], v[196:197]
  v_pk_add_f32 v[194:195], v[194:195], v[198:199]
  v_pk_add_f32 v[200:201], v[200:201], v[204:205]
  v_pk_add_f32 v[202:203], v[202:203], v[206:207]
  v_pk_add_f32 v[192:193], v[192:193], v[200:201]
  v_pk_add_f32 v[194:195], v[194:195], v[202:203]
  v_mul_f32 v192, s52, v192
  v_mul_f32 v194, s52, v194
  v_mul_f32 v193, s52, v193
  v_mul_f32 v195, s52, v195
  v_fma_f32 v193, -v192, v192, v193
  v_fma_f32 v195, -v194, v194, v195
  v_max_f32 v193, 0, v193
  v_max_f32 v195, 0, v195
  v_add_f32 v200, s53, v193
  v_add_f32 v204, s53, v195
  v_rsq_f32 v22, v200
  v_rsq_f32 v26, v204
  v_mul_f32 v23, -v192, v22
  v_mul_f32 v27, -v194, v26
  v_mul_f32 v200, v22, v22
  v_mul_f32 v204, v26, v26
  v_fma_f32 v200, v200, v193, s53
  v_fma_f32 v204, v204, v195, s53
  v_rsq_f32 v24, v200
  v_rsq_f32 v28, v204
  v_mul_f32 v244, v24, v24
  v_mul_f32 v246, v28, v28
  v_mul_f32 v245, s50, v24
  v_mul_f32 v247, s50, v28
  v_mul_f32 v244, v244, v24
  v_mul_f32 v246, v246, v28
  v_rcp_f32 v248, v24
  v_rcp_f32 v249, v28
  v_mul_f32 v244, s51, v244
  v_mul_f32 v246, s51, v246
  s_mul_i32 s37, s10, 5120
  v_add_u32 v11, s37, v4
  v_pk_fma_f32 v[192:193], v[112:113], v[22:23], v[22:23] op_sel:[0,0,1] op_sel_hi:[1,0,1]
  v_cvt_pk_bf16_f32 v32, v192, v193
  v_pk_fma_f32 v[194:195], v[114:115], v[22:23], v[22:23] op_sel:[0,0,1] op_sel_hi:[1,0,1]
  v_cvt_pk_bf16_f32 v33, v194, v195
  v_pk_fma_f32 v[192:193], v[116:117], v[22:23], v[22:23] op_sel:[0,0,1] op_sel_hi:[1,0,1]
  v_cvt_pk_bf16_f32 v34, v192, v193
  v_pk_fma_f32 v[194:195], v[118:119], v[22:23], v[22:23] op_sel:[0,0,1] op_sel_hi:[1,0,1]
  v_cvt_pk_bf16_f32 v35, v194, v195
  ds_write_b128 v11, v[32:35] offset:0
  v_pk_fma_f32 v[192:193], v[120:121], v[22:23], v[22:23] op_sel:[0,0,1] op_sel_hi:[1,0,1]
  v_cvt_pk_bf16_f32 v36, v192, v193
  v_pk_fma_f32 v[194:195], v[122:123], v[22:23], v[22:23] op_sel:[0,0,1] op_sel_hi:[1,0,1]
  v_cvt_pk_bf16_f32 v37, v194, v195
  v_pk_fma_f32 v[192:193], v[124:125], v[22:23], v[22:23] op_sel:[0,0,1] op_sel_hi:[1,0,1]
  v_cvt_pk_bf16_f32 v38, v192, v193
  v_pk_fma_f32 v[194:195], v[126:127], v[22:23], v[22:23] op_sel:[0,0,1] op_sel_hi:[1,0,1]
  v_cvt_pk_bf16_f32 v39, v194, v195
  ds_write_b128 v11, v[36:39] offset:1024
  v_pk_fma_f32 v[192:193], v[128:129], v[22:23], v[22:23] op_sel:[0,0,1] op_sel_hi:[1,0,1]
  v_cvt_pk_bf16_f32 v40, v192, v193
  v_pk_fma_f32 v[194:195], v[130:131], v[22:23], v[22:23] op_sel:[0,0,1] op_sel_hi:[1,0,1]
  v_cvt_pk_bf16_f32 v41, v194, v195
  v_pk_fma_f32 v[192:193], v[132:133], v[22:23], v[22:23] op_sel:[0,0,1] op_sel_hi:[1,0,1]
  v_cvt_pk_bf16_f32 v42, v192, v193
  v_pk_fma_f32 v[194:195], v[134:135], v[22:23], v[22:23] op_sel:[0,0,1] op_sel_hi:[1,0,1]
  v_cvt_pk_bf16_f32 v43, v194, v195
  ds_write_b128 v11, v[40:43] offset:2048
  v_pk_fma_f32 v[192:193], v[136:137], v[22:23], v[22:23] op_sel:[0,0,1] op_sel_hi:[1,0,1]
  v_cvt_pk_bf16_f32 v44, v192, v193
  v_pk_fma_f32 v[194:195], v[138:139], v[22:23], v[22:23] op_sel:[0,0,1] op_sel_hi:[1,0,1]
  v_cvt_pk_bf16_f32 v45, v194, v195
  v_pk_fma_f32 v[192:193], v[140:141], v[22:23], v[22:23] op_sel:[0,0,1] op_sel_hi:[1,0,1]
  v_cvt_pk_bf16_f32 v46, v192, v193
  v_pk_fma_f32 v[194:195], v[142:143], v[22:23], v[22:23] op_sel:[0,0,1] op_sel_hi:[1,0,1]
  v_cvt_pk_bf16_f32 v47, v194, v195
  ds_write_b128 v11, v[44:47] offset:3072
  v_pk_fma_f32 v[192:193], v[144:145], v[22:23], v[22:23] op_sel:[0,0,1] op_sel_hi:[1,0,1]
  v_cvt_pk_bf16_f32 v48, v192, v193
  v_pk_fma_f32 v[194:195], v[146:147], v[22:23], v[22:23] op_sel:[0,0,1] op_sel_hi:[1,0,1]
  v_cvt_pk_bf16_f32 v49, v194, v195
  v_pk_fma_f32 v[192:193], v[148:149], v[22:23], v[22:23] op_sel:[0,0,1] op_sel_hi:[1,0,1]
  v_cvt_pk_bf16_f32 v50, v192, v193
  v_pk_fma_f32 v[194:195], v[150:151], v[22:23], v[22:23] op_sel:[0,0,1] op_sel_hi:[1,0,1]
  v_cvt_pk_bf16_f32 v51, v194, v195
  ds_write_b128 v11, v[48:51] offset:4096
  v_pk_fma_f32 v[192:193], v[152:153], v[26:27], v[26:27] op_sel:[0,0,1] op_sel_hi:[1,0,1]
  v_cvt_pk_bf16_f32 v52, v192, v193
  v_pk_fma_f32 v[194:195], v[154:155], v[26:27], v[26:27] op_sel:[0,0,1] op_sel_hi:[1,0,1]
  v_cvt_pk_bf16_f32 v53, v194, v195
  v_pk_fma_f32 v[192:193], v[156:157], v[26:27], v[26:27] op_sel:[0,0,1] op_sel_hi:[1,0,1]
  v_cvt_pk_bf16_f32 v54, v192, v193
  v_pk_fma_f32 v[194:195], v[158:159], v[26:27], v[26:27] op_sel:[0,0,1] op_sel_hi:[1,0,1]
  v_cvt_pk_bf16_f32 v55, v194, v195
  ds_write_b128 v11, v[52:55] offset:20480
  v_pk_fma_f32 v[192:193], v[160:161], v[26:27], v[26:27] op_sel:[0,0,1] op_sel_hi:[1,0,1]
  v_cvt_pk_bf16_f32 v56, v192, v193
  v_pk_fma_f32 v[194:195], v[162:163], v[26:27], v[26:27] op_sel:[0,0,1] op_sel_hi:[1,0,1]
  v_cvt_pk_bf16_f32 v57, v194, v195
  v_pk_fma_f32 v[192:193], v[164:165], v[26:27], v[26:27] op_sel:[0,0,1] op_sel_hi:[1,0,1]
  v_cvt_pk_bf16_f32 v58, v192, v193
  v_pk_fma_f32 v[194:195], v[166:167], v[26:27], v[26:27] op_sel:[0,0,1] op_sel_hi:[1,0,1]
  v_cvt_pk_bf16_f32 v59, v194, v195
  ds_write_b128 v11, v[56:59] offset:21504
  v_pk_fma_f32 v[192:193], v[168:169], v[26:27], v[26:27] op_sel:[0,0,1] op_sel_hi:[1,0,1]
  v_cvt_pk_bf16_f32 v60, v192, v193
  v_pk_fma_f32 v[194:195], v[170:171], v[26:27], v[26:27] op_sel:[0,0,1] op_sel_hi:[1,0,1]
  v_cvt_pk_bf16_f32 v61, v194, v195
  v_pk_fma_f32 v[192:193], v[172:173], v[26:27], v[26:27] op_sel:[0,0,1] op_sel_hi:[1,0,1]
  v_cvt_pk_bf16_f32 v62, v192, v193
  v_pk_fma_f32 v[194:195], v[174:175], v[26:27], v[26:27] op_sel:[0,0,1] op_sel_hi:[1,0,1]
  v_cvt_pk_bf16_f32 v63, v194, v195
  ds_write_b128 v11, v[60:63] offset:22528
  v_pk_fma_f32 v[192:193], v[176:177], v[26:27], v[26:27] op_sel:[0,0,1] op_sel_hi:[1,0,1]
  v_cvt_pk_bf16_f32 v64, v192, v193
  v_pk_fma_f32 v[194:195], v[178:179], v[26:27], v[26:27] op_sel:[0,0,1] op_sel_hi:[1,0,1]
  v_cvt_pk_bf16_f32 v65, v194, v195
  v_pk_fma_f32 v[192:193], v[180:181], v[26:27], v[26:27] op_sel:[0,0,1] op_sel_hi:[1,0,1]
  v_cvt_pk_bf16_f32 v66, v192, v193
  v_pk_fma_f32 v[194:195], v[182:183], v[26:27], v[26:27] op_sel:[0,0,1] op_sel_hi:[1,0,1]
  v_cvt_pk_bf16_f32 v67, v194, v195
  ds_write_b128 v11, v[64:67] offset:23552
  v_pk_fma_f32 v[192:193], v[184:185], v[26:27], v[26:27] op_sel:[0,0,1] op_sel_hi:[1,0,1]
  v_cvt_pk_bf16_f32 v68, v192, v193
  v_pk_fma_f32 v[194:195], v[186:187], v[26:27], v[26:27] op_sel:[0,0,1] op_sel_hi:[1,0,1]
  v_cvt_pk_bf16_f32 v69, v194, v195
  v_pk_fma_f32 v[192:193], v[188:189], v[26:27], v[26:27] op_sel:[0,0,1] op_sel_hi:[1,0,1]
  v_cvt_pk_bf16_f32 v70, v192, v193
  v_pk_fma_f32 v[194:195], v[190:191], v[26:27], v[26:27] op_sel:[0,0,1] op_sel_hi:[1,0,1]
  v_cvt_pk_bf16_f32 v71, v194, v195
  ds_write_b128 v11, v[68:71] offset:24576
  s_lshl_b32 s37, s24, 1
  s_mul_i32 s37, s37, 20
  s_mul_i32 s38, s10, 5
  s_add_u32 s37, s37, s38
  s_lshl_b32 s37, s37, 10
  s_cmp_lg_u32 s25, 0
  s_cbranch_scc1 sequential_preLN__ssm_conv_h3__mixer_s_mlp__prompt_kernel_st1
  s_add_u32 s38, s37, 13979648
  s_add_u32 s39, s38, 4096
  buffer_store_dwordx4 v[32:35], v4, s[12:15], s38 offen offset:0 sc1
  buffer_store_dwordx4 v[36:39], v4, s[12:15], s38 offen offset:1024 sc1
  buffer_store_dwordx4 v[40:43], v4, s[12:15], s38 offen offset:2048 sc1
  buffer_store_dwordx4 v[44:47], v4, s[12:15], s38 offen offset:3072 sc1
  buffer_store_dwordx4 v[48:51], v4, s[12:15], s39 offen offset:0 sc1
  s_branch sequential_preLN__ssm_conv_h3__mixer_s_mlp__prompt_kernel_stdone
sequential_preLN__ssm_conv_h3__mixer_s_mlp__prompt_kernel_st1:
  s_cmp_lg_u32 s25, 1
  s_cbranch_scc1 sequential_preLN__ssm_conv_h3__mixer_s_mlp__prompt_kernel_st2
  s_add_u32 s38, s37, 14000128
  s_add_u32 s39, s38, 4096
  buffer_store_dwordx4 v[52:55], v4, s[12:15], s38 offen offset:0 sc1
  buffer_store_dwordx4 v[56:59], v4, s[12:15], s38 offen offset:1024 sc1
  buffer_store_dwordx4 v[60:63], v4, s[12:15], s38 offen offset:2048 sc1
  buffer_store_dwordx4 v[64:67], v4, s[12:15], s38 offen offset:3072 sc1
  buffer_store_dwordx4 v[68:71], v4, s[12:15], s39 offen offset:0 sc1
  s_branch sequential_preLN__ssm_conv_h3__mixer_s_mlp__prompt_kernel_stdone
sequential_preLN__ssm_conv_h3__mixer_s_mlp__prompt_kernel_st2:
  s_cmp_lg_u32 s25, 2
  s_cbranch_scc1 sequential_preLN__ssm_conv_h3__mixer_s_mlp__prompt_kernel_st3
  s_add_u32 s38, s37, 11358208
  s_add_u32 s39, s38, 4096
  v_cvt_pk_bf16_f32 v72, v112, v113
  v_cvt_pk_bf16_f32 v73, v114, v115
  v_cvt_pk_bf16_f32 v74, v116, v117
  v_cvt_pk_bf16_f32 v75, v118, v119
  buffer_store_dwordx4 v[72:75], v4, s[12:15], s38 offen offset:0 sc1
  v_cvt_pk_bf16_f32 v76, v120, v121
  v_cvt_pk_bf16_f32 v77, v122, v123
  v_cvt_pk_bf16_f32 v78, v124, v125
  v_cvt_pk_bf16_f32 v79, v126, v127
  buffer_store_dwordx4 v[76:79], v4, s[12:15], s38 offen offset:1024 sc1
  v_cvt_pk_bf16_f32 v80, v128, v129
  v_cvt_pk_bf16_f32 v81, v130, v131
  v_cvt_pk_bf16_f32 v82, v132, v133
  v_cvt_pk_bf16_f32 v83, v134, v135
  buffer_store_dwordx4 v[80:83], v4, s[12:15], s38 offen offset:2048 sc1
  v_cvt_pk_bf16_f32 v84, v136, v137
  v_cvt_pk_bf16_f32 v85, v138, v139
  v_cvt_pk_bf16_f32 v86, v140, v141
  v_cvt_pk_bf16_f32 v87, v142, v143
  buffer_store_dwordx4 v[84:87], v4, s[12:15], s38 offen offset:3072 sc1
  v_cvt_pk_bf16_f32 v88, v144, v145
  v_cvt_pk_bf16_f32 v89, v146, v147
  v_cvt_pk_bf16_f32 v90, v148, v149
  v_cvt_pk_bf16_f32 v91, v150, v151
  buffer_store_dwordx4 v[88:91], v4, s[12:15], s39 offen offset:0 sc1
  s_branch sequential_preLN__ssm_conv_h3__mixer_s_mlp__prompt_kernel_stdone
sequential_preLN__ssm_conv_h3__mixer_s_mlp__prompt_kernel_st3:
  s_add_u32 s38, s37, 11378688
  s_add_u32 s39, s38, 4096
  v_cvt_pk_bf16_f32 v72, v152, v153
  v_cvt_pk_bf16_f32 v73, v154, v155
  v_cvt_pk_bf16_f32 v74, v156, v157
  v_cvt_pk_bf16_f32 v75, v158, v159
  buffer_store_dwordx4 v[72:75], v4, s[12:15], s38 offen offset:0 sc1
  v_cvt_pk_bf16_f32 v76, v160, v161
  v_cvt_pk_bf16_f32 v77, v162, v163
  v_cvt_pk_bf16_f32 v78, v164, v165
  v_cvt_pk_bf16_f32 v79, v166, v167
  buffer_store_dwordx4 v[76:79], v4, s[12:15], s38 offen offset:1024 sc1
  v_cvt_pk_bf16_f32 v80, v168, v169
  v_cvt_pk_bf16_f32 v81, v170, v171
  v_cvt_pk_bf16_f32 v82, v172, v173
  v_cvt_pk_bf16_f32 v83, v174, v175
  buffer_store_dwordx4 v[80:83], v4, s[12:15], s38 offen offset:2048 sc1
  v_cvt_pk_bf16_f32 v84, v176, v177
  v_cvt_pk_bf16_f32 v85, v178, v179
  v_cvt_pk_bf16_f32 v86, v180, v181
  v_cvt_pk_bf16_f32 v87, v182, v183
  buffer_store_dwordx4 v[84:87], v4, s[12:15], s38 offen offset:3072 sc1
  v_cvt_pk_bf16_f32 v88, v184, v185
  v_cvt_pk_bf16_f32 v89, v186, v187
  v_cvt_pk_bf16_f32 v90, v188, v189
  v_cvt_pk_bf16_f32 v91, v190, v191
  buffer_store_dwordx4 v[88:91], v4, s[12:15], s39 offen offset:0 sc1
sequential_preLN__ssm_conv_h3__mixer_s_mlp__prompt_kernel_stdone:
  s_waitcnt lgkmcnt(0)
  s_barrier
  s_and_b32 s37, s10, 1
  s_mul_i32 s37, s37, 20480
  v_add_u32 v10, s37, v4
  ds_read_b128 v[192:195], v4 offset:0
  ds_read_b128 v[196:199], v4 offset:20480
  ds_read_b128 v[200:203], v10 offset:0
  ds_read_b128 v[204:207], v4 offset:1024
  ds_read_b128 v[208:211], v4 offset:21504
  ds_read_b128 v[212:215], v10 offset:1024
  ds_read_b128 v[216:219], v4 offset:2048
  ds_read_b128 v[220:223], v4 offset:22528
  ds_read_b128 v[224:227], v10 offset:2048
  s_waitcnt lgkmcnt(6)
  v_mfma_f32_16x16x32_bf16 v[112:115], a[0:3], v[192:195], 0
  ds_read_b128 v[228:231], v4 offset:3072
  v_mfma_f32_16x16x32_bf16 v[116:119], a[80:83], v[192:195], 0
  ds_read_b128 v[232:235], v4 offset:23552
  v_mfma_f32_16x16x32_bf16 v[120:123], a[0:3], v[196:199], 0
  ds_read_b128 v[236:239], v10 offset:3072
  v_mfma_f32_16x16x32_bf16 v[124:127], a[80:83], v[196:199], 0
  v_mfma_f32_16x16x32_bf16 v[128:131], a[160:163], v[200:203], 0
  s_waitcnt lgkmcnt(6)
  v_mfma_f32_16x16x32_bf16 v[112:115], a[4:7], v[204:207], v[112:115]
  ds_read_b128 v[192:195], v4 offset:4096
  v_mfma_f32_16x16x32_bf16 v[116:119], a[84:87], v[204:207], v[116:119]
  ds_read_b128 v[196:199], v4 offset:24576
  v_mfma_f32_16x16x32_bf16 v[120:123], a[4:7], v[208:211], v[120:123]
  ds_read_b128 v[200:203], v10 offset:4096
  v_mfma_f32_16x16x32_bf16 v[124:127], a[84:87], v[208:211], v[124:127]
  v_mfma_f32_16x16x32_bf16 v[128:131], a[164:167], v[212:215], v[128:131]
  s_waitcnt lgkmcnt(6)
  v_mfma_f32_16x16x32_bf16 v[112:115], a[8:11], v[216:219], v[112:115]
  ds_read_b128 v[204:207], v4 offset:5120
  v_mfma_f32_16x16x32_bf16 v[116:119], a[88:91], v[216:219], v[116:119]
  ds_read_b128 v[208:211], v4 offset:25600
  v_mfma_f32_16x16x32_bf16 v[120:123], a[8:11], v[220:223], v[120:123]
  ds_read_b128 v[212:215], v10 offset:5120
  v_mfma_f32_16x16x32_bf16 v[124:127], a[88:91], v[220:223], v[124:127]
  v_mfma_f32_16x16x32_bf16 v[128:131], a[168:171], v[224:227], v[128:131]
  s_waitcnt lgkmcnt(6)
  v_mfma_f32_16x16x32_bf16 v[112:115], a[12:15], v[228:231], v[112:115]
  ds_read_b128 v[216:219], v4 offset:6144
  v_mfma_f32_16x16x32_bf16 v[116:119], a[92:95], v[228:231], v[116:119]
  ds_read_b128 v[220:223], v4 offset:26624
  v_mfma_f32_16x16x32_bf16 v[120:123], a[12:15], v[232:235], v[120:123]
  ds_read_b128 v[224:227], v10 offset:6144
  v_mfma_f32_16x16x32_bf16 v[124:127], a[92:95], v[232:235], v[124:127]
  v_mfma_f32_16x16x32_bf16 v[128:131], a[172:175], v[236:239], v[128:131]
  s_waitcnt lgkmcnt(6)
  v_mfma_f32_16x16x32_bf16 v[112:115], a[16:19], v[192:195], v[112:115]
  ds_read_b128 v[228:231], v4 offset:7168
  v_mfma_f32_16x16x32_bf16 v[116:119], a[96:99], v[192:195], v[116:119]
  ds_read_b128 v[232:235], v4 offset:27648
  v_mfma_f32_16x16x32_bf16 v[120:123], a[16:19], v[196:199], v[120:123]
  ds_read_b128 v[236:239], v10 offset:7168
  v_mfma_f32_16x16x32_bf16 v[124:127], a[96:99], v[196:199], v[124:127]
  v_mfma_f32_16x16x32_bf16 v[128:131], a[176:179], v[200:203], v[128:131]
  s_waitcnt lgkmcnt(6)
  v_mfma_f32_16x16x32_bf16 v[112:115], a[20:23], v[204:207], v[112:115]
  ds_read_b128 v[192:195], v4 offset:8192
  v_mfma_f32_16x16x32_bf16 v[116:119], a[100:103], v[204:207], v[116:119]
  ds_read_b128 v[196:199], v4 offset:28672
  v_mfma_f32_16x16x32_bf16 v[120:123], a[20:23], v[208:211], v[120:123]
  ds_read_b128 v[200:203], v10 offset:8192
  v_mfma_f32_16x16x32_bf16 v[124:127], a[100:103], v[208:211], v[124:127]
  v_mfma_f32_16x16x32_bf16 v[128:131], a[180:183], v[212:215], v[128:131]
  s_waitcnt lgkmcnt(6)
  v_mfma_f32_16x16x32_bf16 v[112:115], a[24:27], v[216:219], v[112:115]
  ds_read_b128 v[204:207], v4 offset:9216
  v_mfma_f32_16x16x32_bf16 v[116:119], a[104:107], v[216:219], v[116:119]
  ds_read_b128 v[208:211], v4 offset:29696
  v_mfma_f32_16x16x32_bf16 v[120:123], a[24:27], v[220:223], v[120:123]
  ds_read_b128 v[212:215], v10 offset:9216
  v_mfma_f32_16x16x32_bf16 v[124:127], a[104:107], v[220:223], v[124:127]
  v_mfma_f32_16x16x32_bf16 v[128:131], a[184:187], v[224:227], v[128:131]
  s_waitcnt lgkmcnt(6)
  v_mfma_f32_16x16x32_bf16 v[112:115], a[28:31], v[228:231], v[112:115]
  ds_read_b128 v[216:219], v4 offset:10240
  v_mfma_f32_16x16x32_bf16 v[116:119], a[108:111], v[228:231], v[116:119]
  ds_read_b128 v[220:223], v4 offset:30720
  v_mfma_f32_16x16x32_bf16 v[120:123], a[28:31], v[232:235], v[120:123]
  ds_read_b128 v[224:227], v10 offset:10240
  v_mfma_f32_16x16x32_bf16 v[124:127], a[108:111], v[232:235], v[124:127]
  v_mfma_f32_16x16x32_bf16 v[128:131], a[188:191], v[236:239], v[128:131]
  s_waitcnt lgkmcnt(6)
  v_mfma_f32_16x16x32_bf16 v[112:115], a[32:35], v[192:195], v[112:115]
  ds_read_b128 v[228:231], v4 offset:11264
  v_mfma_f32_16x16x32_bf16 v[116:119], a[112:115], v[192:195], v[116:119]
  ds_read_b128 v[232:235], v4 offset:31744
  v_mfma_f32_16x16x32_bf16 v[120:123], a[32:35], v[196:199], v[120:123]
  ds_read_b128 v[236:239], v10 offset:11264
  v_mfma_f32_16x16x32_bf16 v[124:127], a[112:115], v[196:199], v[124:127]
  v_mfma_f32_16x16x32_bf16 v[128:131], a[192:195], v[200:203], v[128:131]
  s_waitcnt lgkmcnt(6)
  v_mfma_f32_16x16x32_bf16 v[112:115], a[36:39], v[204:207], v[112:115]
  ds_read_b128 v[192:195], v4 offset:12288
  v_mfma_f32_16x16x32_bf16 v[116:119], a[116:119], v[204:207], v[116:119]
  ds_read_b128 v[196:199], v4 offset:32768
  v_mfma_f32_16x16x32_bf16 v[120:123], a[36:39], v[208:211], v[120:123]
  ds_read_b128 v[200:203], v10 offset:12288
  v_mfma_f32_16x16x32_bf16 v[124:127], a[116:119], v[208:211], v[124:127]
  v_mfma_f32_16x16x32_bf16 v[128:131], a[196:199], v[212:215], v[128:131]
  s_waitcnt lgkmcnt(6)
  v_mfma_f32_16x16x32_bf16 v[112:115], a[40:43], v[216:219], v[112:115]
  ds_read_b128 v[204:207], v4 offset:13312
  v_mfma_f32_16x16x32_bf16 v[116:119], a[120:123], v[216:219], v[116:119]
  ds_read_b128 v[208:211], v4 offset:33792
  v_mfma_f32_16x16x32_bf16 v[120:123], a[40:43], v[220:223], v[120:123]
  ds_read_b128 v[212:215], v10 offset:13312
  v_mfma_f32_16x16x32_bf16 v[124:127], a[120:123], v[220:223], v[124:127]
  v_mfma_f32_16x16x32_bf16 v[128:131], a[200:203], v[224:227], v[128:131]
  s_waitcnt lgkmcnt(6)
  v_mfma_f32_16x16x32_bf16 v[112:115], a[44:47], v[228:231], v[112:115]
  ds_read_b128 v[216:219], v4 offset:14336
  v_mfma_f32_16x16x32_bf16 v[116:119], a[124:127], v[228:231], v[116:119]
  ds_read_b128 v[220:223], v4 offset:34816
  v_mfma_f32_16x16x32_bf16 v[120:123], a[44:47], v[232:235], v[120:123]
  ds_read_b128 v[224:227], v10 offset:14336
  v_mfma_f32_16x16x32_bf16 v[124:127], a[124:127], v[232:235], v[124:127]
  v_mfma_f32_16x16x32_bf16 v[128:131], a[204:207], v[236:239], v[128:131]
  s_waitcnt lgkmcnt(6)
  v_mfma_f32_16x16x32_bf16 v[112:115], a[48:51], v[192:195], v[112:115]
  ds_read_b128 v[228:231], v4 offset:15360
  v_mfma_f32_16x16x32_bf16 v[116:119], a[128:131], v[192:195], v[116:119]
  ds_read_b128 v[232:235], v4 offset:35840
  v_mfma_f32_16x16x32_bf16 v[120:123], a[48:51], v[196:199], v[120:123]
  ds_read_b128 v[236:239], v10 offset:15360
  v_mfma_f32_16x16x32_bf16 v[124:127], a[128:131], v[196:199], v[124:127]
  v_mfma_f32_16x16x32_bf16 v[128:131], a[208:211], v[200:203], v[128:131]
  s_waitcnt lgkmcnt(6)
  v_mfma_f32_16x16x32_bf16 v[112:115], a[52:55], v[204:207], v[112:115]
  ds_read_b128 v[192:195], v4 offset:16384
  v_mfma_f32_16x16x32_bf16 v[116:119], a[132:135], v[204:207], v[116:119]
  ds_read_b128 v[196:199], v4 offset:36864
  v_mfma_f32_16x16x32_bf16 v[120:123], a[52:55], v[208:211], v[120:123]
  ds_read_b128 v[200:203], v10 offset:16384
  v_mfma_f32_16x16x32_bf16 v[124:127], a[132:135], v[208:211], v[124:127]
  v_mfma_f32_16x16x32_bf16 v[128:131], a[212:215], v[212:215], v[128:131]
  s_waitcnt lgkmcnt(6)
  v_mfma_f32_16x16x32_bf16 v[112:115], a[56:59], v[216:219], v[112:115]
  ds_read_b128 v[204:207], v4 offset:17408
  v_mfma_f32_16x16x32_bf16 v[116:119], a[136:139], v[216:219], v[116:119]
  ds_read_b128 v[208:211], v4 offset:37888
  v_mfma_f32_16x16x32_bf16 v[120:123], a[56:59], v[220:223], v[120:123]
  ds_read_b128 v[212:215], v10 offset:17408
  v_mfma_f32_16x16x32_bf16 v[124:127], a[136:139], v[220:223], v[124:127]
  v_mfma_f32_16x16x32_bf16 v[128:131], a[216:219], v[224:227], v[128:131]
  s_waitcnt lgkmcnt(6)
  v_mfma_f32_16x16x32_bf16 v[112:115], a[60:63], v[228:231], v[112:115]
  ds_read_b128 v[216:219], v4 offset:18432
  v_mfma_f32_16x16x32_bf16 v[116:119], a[140:143], v[228:231], v[116:119]
  ds_read_b128 v[220:223], v4 offset:38912
  v_mfma_f32_16x16x32_bf16 v[120:123], a[60:63], v[232:235], v[120:123]
  ds_read_b128 v[224:227], v10 offset:18432
  v_mfma_f32_16x16x32_bf16 v[124:127], a[140:143], v[232:235], v[124:127]
  v_mfma_f32_16x16x32_bf16 v[128:131], a[220:223], v[236:239], v[128:131]
  s_waitcnt vmcnt(14) lgkmcnt(6)
  v_mfma_f32_16x16x32_bf16 v[112:115], a[64:67], v[192:195], v[112:115]
  ds_read_b128 v[228:231], v4 offset:19456
  v_mfma_f32_16x16x32_bf16 v[116:119], a[144:147], v[192:195], v[116:119]
  ds_read_b128 v[232:235], v4 offset:39936
  v_mfma_f32_16x16x32_bf16 v[120:123], a[64:67], v[196:199], v[120:123]
  ds_read_b128 v[236:239], v10 offset:19456
  v_mfma_f32_16x16x32_bf16 v[124:127], a[144:147], v[196:199], v[124:127]
  v_mfma_f32_16x16x32_bf16 v[128:131], a[224:227], v[200:203], v[128:131]
  s_waitcnt vmcnt(11) lgkmcnt(6)
  v_mfma_f32_16x16x32_bf16 v[112:115], a[68:71], v[204:207], v[112:115]
  v_mfma_f32_16x16x32_bf16 v[116:119], a[148:151], v[204:207], v[116:119]
  v_mfma_f32_16x16x32_bf16 v[120:123], a[68:71], v[208:211], v[120:123]
  v_mfma_f32_16x16x32_bf16 v[124:127], a[148:151], v[208:211], v[124:127]
  v_mfma_f32_16x16x32_bf16 v[128:131], a[228:231], v[212:215], v[128:131]
  s_waitcnt vmcnt(8) lgkmcnt(3)
  v_mfma_f32_16x16x32_bf16 v[112:115], a[72:75], v[216:219], v[112:115]
  v_mfma_f32_16x16x32_bf16 v[116:119], a[152:155], v[216:219], v[116:119]
  v_mfma_f32_16x16x32_bf16 v[120:123], a[72:75], v[220:223], v[120:123]
  v_mfma_f32_16x16x32_bf16 v[124:127], a[152:155], v[220:223], v[124:127]
  v_mfma_f32_16x16x32_bf16 v[128:131], a[232:235], v[224:227], v[128:131]
  s_waitcnt vmcnt(5) lgkmcnt(0)
  v_mfma_f32_16x16x32_bf16 v[112:115], a[76:79], v[228:231], v[112:115]
  v_mfma_f32_16x16x32_bf16 v[116:119], a[156:159], v[228:231], v[116:119]
  v_mfma_f32_16x16x32_bf16 v[120:123], a[76:79], v[232:235], v[120:123]
  v_mfma_f32_16x16x32_bf16 v[124:127], a[156:159], v[232:235], v[124:127]
  v_mfma_f32_16x16x32_bf16 v[128:131], a[236:239], v[236:239], v[128:131]
  s_barrier
  s_bitcmp1_b32 s10, 0
  s_cselect_b64 s[56:57], -1, 0
  v_cndmask_b32 v250, v244, v246, s[56:57]
  v_cndmask_b32 v251, v245, v247, s[56:57]
  v_cndmask_b32 v252, v248, v249, s[56:57]
  v_pk_mul_f32 v[64:65], v[112:113], v[112:113]
  v_pk_mul_f32 v[66:67], v[116:117], v[116:117]
  v_pk_mul_f32 v[68:69], v[120:121], v[120:121]
  v_pk_mul_f32 v[70:71], v[124:125], v[124:125]
  v_pk_mul_f32 v[72:73], v[128:129], v[128:129]
  v_pk_fma_f32 v[64:65], v[64:65], v[244:245], v[244:245] op_sel:[0,0,1] op_sel_hi:[1,0,1]
  v_pk_fma_f32 v[66:67], v[66:67], v[244:245], v[244:245] op_sel:[0,0,1] op_sel_hi:[1,0,1]
  v_pk_fma_f32 v[68:69], v[68:69], v[246:247], v[246:247] op_sel:[0,0,1] op_sel_hi:[1,0,1]
  v_pk_fma_f32 v[70:71], v[70:71], v[246:247], v[246:247] op_sel:[0,0,1] op_sel_hi:[1,0,1]
  v_pk_fma_f32 v[72:73], v[72:73], v[250:251], v[250:251] op_sel:[0,0,1] op_sel_hi:[1,0,1]
  v_pk_mul_f32 v[64:65], v[64:65], v[112:113]
  v_pk_mul_f32 v[66:67], v[66:67], v[116:117]
  v_pk_mul_f32 v[68:69], v[68:69], v[120:121]
  v_pk_mul_f32 v[70:71], v[70:71], v[124:125]
  v_pk_mul_f32 v[72:73], v[72:73], v[128:129]
  v_exp_f32 v64, v64
  v_exp_f32 v66, v66
  v_exp_f32 v68, v68
  v_exp_f32 v70, v70
  v_exp_f32 v72, v72
  v_exp_f32 v65, v65
  v_exp_f32 v67, v67
  v_exp_f32 v69, v69
  v_exp_f32 v71, v71
  v_exp_f32 v73, v73
  v_pk_fma_f32 v[64:65], v[64:65], v[248:249], v[248:249] op_sel:[0,0,0] op_sel_hi:[1,0,0]
  v_pk_fma_f32 v[66:67], v[66:67], v[248:249], v[248:249] op_sel:[0,0,0] op_sel_hi:[1,0,0]
  v_pk_fma_f32 v[68:69], v[68:69], v[248:249], v[248:249] op_sel:[0,1,1] op_sel_hi:[1,1,1]
  v_pk_fma_f32 v[70:71], v[70:71], v[248:249], v[248:249] op_sel:[0,1,1] op_sel_hi:[1,1,1]
  v_pk_fma_f32 v[72:73], v[72:73], v[252:253], v[252:253] op_sel:[0,0,0] op_sel_hi:[1,0,0]
  v_rcp_f32 v64, v64
  v_rcp_f32 v66, v66
  v_rcp_f32 v68, v68
  v_rcp_f32 v70, v70
  v_rcp_f32 v72, v72
  v_rcp_f32 v65, v65
  v_rcp_f32 v67, v67
  v_rcp_f32 v69, v69
  v_rcp_f32 v71, v71
  v_rcp_f32 v73, v73
  v_pk_mul_f32 v[64:65], v[64:65], v[112:113]
  v_pk_mul_f32 v[66:67], v[66:67], v[116:117]
  v_pk_mul_f32 v[68:69], v[68:69], v[120:121]
  v_pk_mul_f32 v[70:71], v[70:71], v[124:125]
  v_pk_mul_f32 v[72:73], v[72:73], v[128:129]
  v_cvt_pk_bf16_f32 v40, v64, v65
  v_cvt_pk_bf16_f32 v42, v66, v67
  v_cvt_pk_bf16_f32 v44, v68, v69
  v_cvt_pk_bf16_f32 v46, v70, v71
  v_cvt_pk_bf16_f32 v48, v72, v73
  v_pk_mul_f32 v[64:65], v[114:115], v[114:115]
  v_pk_mul_f32 v[66:67], v[118:119], v[118:119]
  v_pk_mul_f32 v[68:69], v[122:123], v[122:123]
  v_pk_mul_f32 v[70:71], v[126:127], v[126:127]
  v_pk_mul_f32 v[72:73], v[130:131], v[130:131]
  v_pk_fma_f32 v[64:65], v[64:65], v[244:245], v[244:245] op_sel:[0,0,1] op_sel_hi:[1,0,1]
  v_pk_fma_f32 v[66:67], v[66:67], v[244:245], v[244:245] op_sel:[0,0,1] op_sel_hi:[1,0,1]
  v_pk_fma_f32 v[68:69], v[68:69], v[246:247], v[246:247] op_sel:[0,0,1] op_sel_hi:[1,0,1]
  v_pk_fma_f32 v[70:71], v[70:71], v[246:247], v[246:247] op_sel:[0,0,1] op_sel_hi:[1,0,1]
  v_pk_fma_f32 v[72:73], v[72:73], v[250:251], v[250:251] op_sel:[0,0,1] op_sel_hi:[1,0,1]
  v_pk_mul_f32 v[64:65], v[64:65], v[114:115]
  v_pk_mul_f32 v[66:67], v[66:67], v[118:119]
  v_pk_mul_f32 v[68:69], v[68:69], v[122:123]
  v_pk_mul_f32 v[70:71], v[70:71], v[126:127]
  v_pk_mul_f32 v[72:73], v[72:73], v[130:131]
  v_exp_f32 v64, v64
  v_exp_f32 v66, v66
  v_exp_f32 v68, v68
  v_exp_f32 v70, v70
  v_exp_f32 v72, v72
  v_exp_f32 v65, v65
  v_exp_f32 v67, v67
  v_exp_f32 v69, v69
  v_exp_f32 v71, v71
  v_exp_f32 v73, v73
  v_pk_fma_f32 v[64:65], v[64:65], v[248:249], v[248:249] op_sel:[0,0,0] op_sel_hi:[1,0,0]
  v_pk_fma_f32 v[66:67], v[66:67], v[248:249], v[248:249] op_sel:[0,0,0] op_sel_hi:[1,0,0]
  v_pk_fma_f32 v[68:69], v[68:69], v[248:249], v[248:249] op_sel:[0,1,1] op_sel_hi:[1,1,1]
  v_pk_fma_f32 v[70:71], v[70:71], v[248:249], v[248:249] op_sel:[0,1,1] op_sel_hi:[1,1,1]
  v_pk_fma_f32 v[72:73], v[72:73], v[252:253], v[252:253] op_sel:[0,0,0] op_sel_hi:[1,0,0]
  v_rcp_f32 v64, v64
  v_rcp_f32 v66, v66
  v_rcp_f32 v68, v68
  v_rcp_f32 v70, v70
  v_rcp_f32 v72, v72
  v_rcp_f32 v65, v65
  v_rcp_f32 v67, v67
  v_rcp_f32 v69, v69
  v_rcp_f32 v71, v71
  v_rcp_f32 v73, v73
  v_pk_mul_f32 v[64:65], v[64:65], v[114:115]
  v_pk_mul_f32 v[66:67], v[66:67], v[118:119]
  v_pk_mul_f32 v[68:69], v[68:69], v[122:123]
  v_pk_mul_f32 v[70:71], v[70:71], v[126:127]
  v_pk_mul_f32 v[72:73], v[72:73], v[130:131]
  v_cvt_pk_bf16_f32 v41, v64, v65
  v_cvt_pk_bf16_f32 v43, v66, v67
  v_cvt_pk_bf16_f32 v45, v68, v69
  v_cvt_pk_bf16_f32 v47, v70, v71
  v_cvt_pk_bf16_f32 v49, v72, v73
  v_lshlrev_b32 v50, 3, v1
  s_and_b32 s37, s10, 1
  s_lshl_b32 s37, s37, 9
  s_add_u32 s37, s37, 143872
  v_add_u32 v50, s37, v50
  s_cmp_lt_u32 s10, 2
  s_cbranch_scc1 sequential_preLN__ssm_conv_h3__mixer_s_mlp__prompt_kernel_hsx0
  ds_write_b64 v50, v[48:49]
sequential_preLN__ssm_conv_h3__mixer_s_mlp__prompt_kernel_hsx0:
  s_waitcnt lgkmcnt(0)
  s_barrier
  ds_read_b64 v[50:51], v50
  v_cndmask_b32_e64 v40, v40, 0, s[40:41]
  v_cndmask_b32_e64 v41, v41, 0, s[40:41]
  v_cndmask_b32_e64 v42, v42, 0, s[40:41]
  v_cndmask_b32_e64 v43, v43, 0, s[40:41]
  buffer_store_dwordx4 v[40:43], v240, s[12:15], 0 offen sc1
  v_cndmask_b32_e64 v44, v44, 0, s[42:43]
  v_cndmask_b32_e64 v45, v45, 0, s[42:43]
  v_cndmask_b32_e64 v46, v46, 0, s[42:43]
  v_cndmask_b32_e64 v47, v47, 0, s[42:43]
  buffer_store_dwordx4 v[44:47], v241, s[12:15], 0 offen sc1
  s_waitcnt lgkmcnt(0)
  s_cmp_ge_u32 s10, 2
  s_cbranch_scc1 sequential_preLN__ssm_conv_h3__mixer_s_mlp__prompt_kernel_hsx1
  v_cndmask_b32_e64 v48, v48, 0, s[44:45]
  v_cndmask_b32_e64 v49, v49, 0, s[44:45]
  v_cndmask_b32_e64 v50, v50, 0, s[44:45]
  v_cndmask_b32_e64 v51, v51, 0, s[44:45]
  buffer_store_dwordx4 v[48:51], v242, s[12:15], 0 offen sc1
sequential_preLN__ssm_conv_h3__mixer_s_mlp__prompt_kernel_hsx1:
  s_add_u32 m0, s77, 0
  s_add_u32 s79, s72, 0
  buffer_load_dwordx4 v4, s[12:15], s79 offen sc1 lds
  s_add_u32 m0, s77, 1024
  s_add_u32 s79, s73, 0
  buffer_load_dwordx4 v4, s[12:15], s79 offen sc1 lds
  s_add_u32 m0, s77, 2048
  s_add_u32 s79, s74, 0
  buffer_load_dwordx4 v4, s[12:15], s79 offen sc1 lds
  s_add_u32 m0, s77, 3072
  s_add_u32 s79, s75, 0
  buffer_load_dwordx4 v4, s[12:15], s79 offen sc1 lds
  s_add_u32 m0, s77, 4096
  s_add_u32 s79, s76, 0
  buffer_load_dwordx4 v4, s[12:15], s79 offen sc1 lds
  s_add_u32 m0, s77, 20480
  s_add_u32 s79, s72, 4096
  buffer_load_dwordx4 v4, s[12:15], s79 offen sc1 lds
  s_add_u32 m0, s77, 21504
  s_add_u32 s79, s73, 4096
  buffer_load_dwordx4 v4, s[12:15], s79 offen sc1 lds
  s_add_u32 m0, s77, 22528
  s_add_u32 s79, s74, 4096
  buffer_load_dwordx4 v4, s[12:15], s79 offen sc1 lds
  s_add_u32 m0, s77, 23552
  s_add_u32 s79, s75, 4096
  buffer_load_dwordx4 v4, s[12:15], s79 offen sc1 lds
  s_add_u32 m0, s77, 24576
  s_add_u32 s79, s76, 4096
  buffer_load_dwordx4 v4, s[12:15], s79 offen sc1 lds
  s_waitcnt vmcnt(10)
  s_barrier
  s_cmp_lg_u32 s10, 0
  s_cbranch_scc1 sequential_preLN__ssm_conv_h3__mixer_s_mlp__prompt_kernel_sig17
  s_lshl_b32 s84, s24, 7
  s_add_u32 s84, s84, 29052928
  v_mov_b32 v5, 0
  v_mov_b32 v6, 1
  s_mov_b64 exec, 1
  buffer_atomic_add v6, v5, s[12:15], s84 offen sc1
  s_mov_b64 exec, -1
sequential_preLN__ssm_conv_h3__mixer_s_mlp__prompt_kernel_sig17:
sequential_preLN__ssm_conv_h3__mixer_s_mlp__prompt_kernel_ph3:
  s_and_b32 s36, s2, 7
  s_lshr_b32 s37, s2, 3
  s_and_b32 s24, s36, 3
  s_and_b32 s38, s37, 3
  s_lshl_b32 s38, s38, 2
  s_add_u32 s24, s24, s38
  s_lshr_b32 s25, s36, 2
  s_lshl_b32 s25, s25, 3
  s_lshr_b32 s38, s37, 2
  s_add_u32 s25, s25, s38
  s_mul_i32 s38, s25, 7
  s_cmp_eq_u32 s25, 15
  s_cselect_b32 s38, 103, s38
  s_cmp_ge_u32 s25, 14
  s_cselect_b32 s26, 2, 3
  s_and_b32 s27, s25, 1
  s_add_u32 s28, s38, s27
  s_lshl_b32 s29, s26, 1
  s_add_u32 s29, s29, s38
  s_cmp_eq_u32 s27, 1
  s_cselect_b32 s29, s38, s29
  s_lshl_b32 s30, s24, 3
  s_lshl_b32 s38, s10, 1
  s_add_u32 s30, s30, s38
  s_mul_i32 s40, s28, 20480
  s_mul_i32 s41, s10, 5120
  s_add_u32 s40, s40, s41
  s_add_u32 s40, s40, 6897664
  s_mul_i32 s42, s29, 20480
  s_add_u32 s42, s42, s41
  s_add_u32 s42, s42, 6897664
  s_add_u32 m0, s77, 40960
  s_add_u32 s79, s72, 8192
  buffer_load_dwordx4 v4, s[12:15], s79 offen sc1 lds
  s_add_u32 m0, s77, 41984
  s_add_u32 s79, s73, 8192
  buffer_load_dwordx4 v4, s[12:15], s79 offen sc1 lds
  s_add_u32 m0, s77, 43008
  s_add_u32 s79, s74, 8192
  buffer_load_dwordx4 v4, s[12:15], s79 offen sc1 lds
  s_add_u32 m0, s77, 44032
  s_add_u32 s79, s75, 8192
  buffer_load_dwordx4 v4, s[12:15], s79 offen sc1 lds
  s_add_u32 m0, s77, 45056
  s_add_u32 s79, s76, 8192
  buffer_load_dwordx4 v4, s[12:15], s79 offen sc1 lds
  s_add_u32 m0, s77, 61440
  s_add_u32 s79, s72, 12288
  buffer_load_dwordx4 v4, s[12:15], s79 offen sc1 lds
  s_add_u32 m0, s77, 62464
  s_add_u32 s79, s73, 12288
  buffer_load_dwordx4 v4, s[12:15], s79 offen sc1 lds
  s_add_u32 m0, s77, 63488
  s_add_u32 s79, s74, 12288
  buffer_load_dwordx4 v4, s[12:15], s79 offen sc1 lds
  s_add_u32 m0, s77, 64512
  s_add_u32 s79, s75, 12288
  buffer_load_dwordx4 v4, s[12:15], s79 offen sc1 lds
  s_add_u32 m0, s77, 65536
  s_add_u32 s79, s76, 12288
  buffer_load_dwordx4 v4, s[12:15], s79 offen sc1 lds
  s_add_u32 m0, s77, 81920
  s_add_u32 s79, s72, 16384
  buffer_load_dwordx4 v4, s[12:15], s79 offen sc1 lds
  s_add_u32 m0, s77, 82944
  s_add_u32 s79, s73, 16384
  buffer_load_dwordx4 v4, s[12:15], s79 offen sc1 lds
  s_add_u32 m0, s77, 83968
  s_add_u32 s79, s74, 16384
  buffer_load_dwordx4 v4, s[12:15], s79 offen sc1 lds
  s_add_u32 m0, s77, 84992
  s_add_u32 s79, s75, 16384
  buffer_load_dwordx4 v4, s[12:15], s79 offen sc1 lds
  s_add_u32 m0, s77, 86016
  s_add_u32 s79, s76, 16384
  buffer_load_dwordx4 v4, s[12:15], s79 offen sc1 lds
  s_cmp_lg_u32 s10, 0
  s_cbranch_scc1 sequential_preLN__ssm_conv_h3__mixer_s_mlp__prompt_kernel_wt18
  s_lshl_b32 s84, s60, 1
  s_sub_u32 s84, s84, 1
  v_and_b32 v5, 3, v1
  v_add_u32 v5, s84, v5
  v_and_b32 v5, 63, v5
  v_lshlrev_b32 v5, 7, v5
  v_add_u32 v5, 29052928, v5
  v_mov_b32 v7, 4
  s_mov_b32 s85, 0
sequential_preLN__ssm_conv_h3__mixer_s_mlp__prompt_kernel_pl19_l:
  buffer_load_dword v6, v5, s[12:15], 0 offen sc1
  s_add_u32 s85, s85, 1
  s_waitcnt vmcnt(0)
  v_cmp_gt_u32 vcc, v7, v6
  s_cmp_gt_u32 s85, 200000
  s_cbranch_scc1 sequential_preLN__ssm_conv_h3__mixer_s_mlp__prompt_kernel_pl19
  s_nop 2
  s_nop 2
  s_cbranch_vccnz sequential_preLN__ssm_conv_h3__mixer_s_mlp__prompt_kernel_pl19_l
sequential_preLN__ssm_conv_h3__mixer_s_mlp__prompt_kernel_pl19:
sequential_preLN__ssm_conv_h3__mixer_s_mlp__prompt_kernel_wt18:
  s_waitcnt vmcnt(0)
  s_barrier
  s_mul_i32 s80, s63, 20480
  s_add_u32 s80, s80, 16601088
  buffer_load_dwordx4 v[32:35], v4, s[12:15], s80 offen offset:0 sc1
  buffer_load_dwordx4 v[36:39], v4, s[12:15], s80 offen offset:1024 sc1
  buffer_load_dwordx4 v[40:43], v4, s[12:15], s80 offen offset:2048 sc1
  buffer_load_dwordx4 v[44:47], v4, s[12:15], s80 offen offset:3072 sc1
  s_add_u32 s80, s80, 4096
  buffer_load_dwordx4 v[48:51], v4, s[12:15], s80 offen offset:0 sc1
  buffer_load_dwordx4 v[52:55], v4, s[12:15], s80 offen offset:1024 sc1
  buffer_load_dwordx4 v[56:59], v4, s[12:15], s80 offen offset:2048 sc1
  buffer_load_dwordx4 v[60:63], v4, s[12:15], s80 offen offset:3072 sc1
  s_add_u32 s80, s80, 4096
  buffer_load_dwordx4 v[64:67], v4, s[12:15], s80 offen offset:0 sc1
  buffer_load_dwordx4 v[68:71], v4, s[12:15], s80 offen offset:1024 sc1
  v_add_u32 v6, 0x10000, v4
  ds_read_b128 v[124:127], v4 offset:0
  ds_read_b128 v[128:131], v4 offset:1024
  ds_read_b128 v[132:135], v4 offset:2048
  ds_read_b128 v[136:139], v4 offset:3072
  ds_read_b128 v[140:143], v4 offset:4096
  ds_read_b128 v[144:147], v4 offset:5120
  ds_read_b128 v[148:151], v4 offset:6144
  ds_read_b128 v[152:155], v4 offset:7168
  ds_read_b128 v[156:159], v4 offset:8192
  ds_read_b128 v[160:163], v4 offset:9216
  ds_read_b128 v[164:167], v4 offset:10240
  s_waitcnt vmcnt(9)
  s_waitcnt lgkmcnt(10)
  v_mfma_f32_16x16x32_bf16 v[8:11], v[124:127], v[32:35], 0
  ds_read_b128 v[168:171], v4 offset:11264
  s_waitcnt lgkmcnt(10)
  v_mfma_f32_16x16x32_bf16 v[12:15], v[128:131], v[32:35], 0
  ds_read_b128 v[172:175], v4 offset:12288
  s_waitcnt lgkmcnt(10)
  v_mfma_f32_16x16x32_bf16 v[16:19], v[132:135], v[32:35], 0
  ds_read_b128 v[176:179], v4 offset:13312
  buffer_load_dwordx4 v[72:75], v4, s[12:15], s80 offen offset:2048 sc1
  s_waitcnt lgkmcnt(10)
  v_mfma_f32_16x16x32_bf16 v[20:23], v[136:139], v[32:35], 0
  ds_read_b128 v[124:127], v4 offset:14336
  s_waitcnt lgkmcnt(10)
  v_mfma_f32_16x16x32_bf16 v[24:27], v[140:143], v[32:35], 0
  ds_read_b128 v[128:131], v4 offset:15360
  s_waitcnt vmcnt(9)
  s_waitcnt lgkmcnt(10)
  v_mfma_f32_16x16x32_bf16 v[8:11], v[144:147], v[36:39], v[8:11]
  ds_read_b128 v[132:135], v4 offset:16384
  s_waitcnt lgkmcnt(10)
  v_mfma_f32_16x16x32_bf16 v[12:15], v[148:151], v[36:39], v[12:15]
  ds_read_b128 v[136:139], v4 offset:17408
  s_waitcnt lgkmcnt(10)
  v_mfma_f32_16x16x32_bf16 v[16:19], v[152:155], v[36:39], v[16:19]
  ds_read_b128 v[140:143], v4 offset:18432
  buffer_load_dwordx4 v[76:79], v4, s[12:15], s80 offen offset:3072 sc1
  s_waitcnt lgkmcnt(10)
  v_mfma_f32_16x16x32_bf16 v[20:23], v[156:159], v[36:39], v[20:23]
  ds_read_b128 v[144:147], v4 offset:19456
  s_waitcnt lgkmcnt(10)
  v_mfma_f32_16x16x32_bf16 v[24:27], v[160:163], v[36:39], v[24:27]
  ds_read_b128 v[148:151], v4 offset:20480
  s_waitcnt vmcnt(9)
  s_waitcnt lgkmcnt(10)
  v_mfma_f32_16x16x32_bf16 v[8:11], v[164:167], v[40:43], v[8:11]
  ds_read_b128 v[152:155], v4 offset:21504
  s_waitcnt lgkmcnt(10)
  v_mfma_f32_16x16x32_bf16 v[12:15], v[168:171], v[40:43], v[12:15]
  ds_read_b128 v[156:159], v4 offset:22528
  s_waitcnt lgkmcnt(10)
  v_mfma_f32_16x16x32_bf16 v[16:19], v[172:175], v[40:43], v[16:19]
  ds_read_b128 v[160:163], v4 offset:23552
  s_add_u32 s80, s80, 4096
  buffer_load_dwordx4 v[80:83], v4, s[12:15], s80 offen offset:0 sc1
  s_waitcnt lgkmcnt(10)
  v_mfma_f32_16x16x32_bf16 v[20:23], v[176:179], v[40:43], v[20:23]
  ds_read_b128 v[164:167], v4 offset:24576
  s_waitcnt lgkmcnt(10)
  v_mfma_f32_16x16x32_bf16 v[24:27], v[124:127], v[40:43], v[24:27]
  ds_read_b128 v[168:171], v4 offset:25600
  s_waitcnt vmcnt(9)
  s_waitcnt lgkmcnt(10)
  v_mfma_f32_16x16x32_bf16 v[8:11], v[128:131], v[44:47], v[8:11]
  ds_read_b128 v[172:175], v4 offset:26624
  s_waitcnt lgkmcnt(10)
  v_mfma_f32_16x16x32_bf16 v[12:15], v[132:135], v[44:47], v[12:15]
  ds_read_b128 v[176:179], v4 offset:27648
  s_waitcnt lgkmcnt(10)
  v_mfma_f32_16x16x32_bf16 v[16:19], v[136:139], v[44:47], v[16:19]
  ds_read_b128 v[124:127], v4 offset:28672
  buffer_load_dwordx4 v[84:87], v4, s[12:15], s80 offen offset:1024 sc1
  s_waitcnt lgkmcnt(10)
  v_mfma_f32_16x16x32_bf16 v[20:23], v[140:143], v[44:47], v[20:23]
  ds_read_b128 v[128:131], v4 offset:29696
  s_waitcnt lgkmcnt(10)
  v_mfma_f32_16x16x32_bf16 v[24:27], v[144:147], v[44:47], v[24:27]
  ds_read_b128 v[132:135], v4 offset:30720
  s_waitcnt vmcnt(9)
  s_waitcnt lgkmcnt(10)
  v_mfma_f32_16x16x32_bf16 v[8:11], v[148:151], v[48:51], v[8:11]
  ds_read_b128 v[136:139], v4 offset:31744
  s_waitcnt lgkmcnt(10)
  v_mfma_f32_16x16x32_bf16 v[12:15], v[152:155], v[48:51], v[12:15]
  ds_read_b128 v[140:143], v4 offset:32768
  s_waitcnt lgkmcnt(10)
  v_mfma_f32_16x16x32_bf16 v[16:19], v[156:159], v[48:51], v[16:19]
  ds_read_b128 v[144:147], v4 offset:33792
  buffer_load_dwordx4 v[88:91], v4, s[12:15], s80 offen offset:2048 sc1
  s_waitcnt lgkmcnt(10)
  v_mfma_f32_16x16x32_bf16 v[20:23], v[160:163], v[48:51], v[20:23]
  ds_read_b128 v[148:151], v4 offset:34816
  s_waitcnt lgkmcnt(10)
  v_mfma_f32_16x16x32_bf16 v[24:27], v[164:167], v[48:51], v[24:27]
  ds_read_b128 v[152:155], v4 offset:35840
  s_waitcnt vmcnt(9)
  s_waitcnt lgkmcnt(10)
  v_mfma_f32_16x16x32_bf16 v[8:11], v[168:171], v[52:55], v[8:11]
  ds_read_b128 v[156:159], v4 offset:36864
  s_waitcnt lgkmcnt(10)
  v_mfma_f32_16x16x32_bf16 v[12:15], v[172:175], v[52:55], v[12:15]
  ds_read_b128 v[160:163], v4 offset:37888
  s_waitcnt lgkmcnt(10)
  v_mfma_f32_16x16x32_bf16 v[16:19], v[176:179], v[52:55], v[16:19]
  ds_read_b128 v[164:167], v4 offset:38912
  buffer_load_dwordx4 v[92:95], v4, s[12:15], s80 offen offset:3072 sc1
  s_waitcnt lgkmcnt(10)
  v_mfma_f32_16x16x32_bf16 v[20:23], v[124:127], v[52:55], v[20:23]
  ds_read_b128 v[168:171], v4 offset:39936
  s_waitcnt lgkmcnt(10)
  v_mfma_f32_16x16x32_bf16 v[24:27], v[128:131], v[52:55], v[24:27]
  ds_read_b128 v[172:175], v4 offset:40960
  s_add_u32 s80, s80, 4096
  buffer_load_dwordx4 v[96:99], v4, s[12:15], s80 offen offset:0 sc1
  s_waitcnt vmcnt(10)
  s_waitcnt lgkmcnt(10)
  v_mfma_f32_16x16x32_bf16 v[8:11], v[132:135], v[56:59], v[8:11]
  ds_read_b128 v[176:179], v4 offset:41984
  s_waitcnt lgkmcnt(10)
  v_mfma_f32_16x16x32_bf16 v[12:15], v[136:139], v[56:59], v[12:15]
  ds_read_b128 v[124:127], v4 offset:43008
  s_waitcnt lgkmcnt(10)
  v_mfma_f32_16x16x32_bf16 v[16:19], v[140:143], v[56:59], v[16:19]
  ds_read_b128 v[128:131], v4 offset:44032
  buffer_load_dwordx4 v[100:103], v4, s[12:15], s80 offen offset:1024 sc1
  s_waitcnt lgkmcnt(10)
  v_mfma_f32_16x16x32_bf16 v[20:23], v[144:147], v[56:59], v[20:23]
  ds_read_b128 v[132:135], v4 offset:45056
  s_waitcnt lgkmcnt(10)
  v_mfma_f32_16x16x32_bf16 v[24:27], v[148:151], v[56:59], v[24:27]
  ds_read_b128 v[136:139], v4 offset:46080
  buffer_load_dwordx4 v[104:107], v4, s[12:15], s80 offen offset:2048 sc1
  s_waitcnt vmcnt(11)
  s_waitcnt lgkmcnt(10)
  v_mfma_f32_16x16x32_bf16 v[8:11], v[152:155], v[60:63], v[8:11]
  ds_read_b128 v[140:143], v4 offset:47104
  s_waitcnt lgkmcnt(10)
  v_mfma_f32_16x16x32_bf16 v[12:15], v[156:159], v[60:63], v[12:15]
  ds_read_b128 v[144:147], v4 offset:48128
  s_waitcnt lgkmcnt(10)
  v_mfma_f32_16x16x32_bf16 v[16:19], v[160:163], v[60:63], v[16:19]
  ds_read_b128 v[148:151], v4 offset:49152
  buffer_load_dwordx4 v[108:111], v4, s[12:15], s80 offen offset:3072 sc1
  s_waitcnt lgkmcnt(10)
  v_mfma_f32_16x16x32_bf16 v[20:23], v[164:167], v[60:63], v[20:23]
  ds_read_b128 v[152:155], v4 offset:50176
  s_waitcnt lgkmcnt(10)
  v_mfma_f32_16x16x32_bf16 v[24:27], v[168:171], v[60:63], v[24:27]
  ds_read_b128 v[156:159], v4 offset:51200
  s_add_u32 s81, s70, 13979648
  buffer_load_dwordx4 v[112:115], v4, s[12:15], s81 offen sc1
  s_waitcnt vmcnt(12)
  s_waitcnt lgkmcnt(10)
  v_mfma_f32_16x16x32_bf16 v[8:11], v[172:175], v[64:67], v[8:11]
  ds_read_b128 v[160:163], v4 offset:52224
  s_waitcnt lgkmcnt(10)
  v_mfma_f32_16x16x32_bf16 v[12:15], v[176:179], v[64:67], v[12:15]
  ds_read_b128 v[164:167], v4 offset:53248
  s_waitcnt lgkmcnt(10)
  v_mfma_f32_16x16x32_bf16 v[16:19], v[124:127], v[64:67], v[16:19]
  ds_read_b128 v[168:171], v4 offset:54272
  buffer_load_dwordx4 v[116:119], v4, s[12:15], s81 offen offset:1024 sc1
  s_waitcnt lgkmcnt(10)
  v_mfma_f32_16x16x32_bf16 v[20:23], v[128:131], v[64:67], v[20:23]
  ds_read_b128 v[172:175], v4 offset:55296
  s_waitcnt lgkmcnt(10)
  v_mfma_f32_16x16x32_bf16 v[24:27], v[132:135], v[64:67], v[24:27]
  ds_read_b128 v[176:179], v4 offset:56320
  s_add_u32 s81, s71, 13979648
  buffer_load_dwordx2 v[120:121], v4, s[12:15], s81 offen sc1
  s_waitcnt vmcnt(13)
  s_waitcnt lgkmcnt(10)
  v_mfma_f32_16x16x32_bf16 v[8:11], v[136:139], v[68:71], v[8:11]
  ds_read_b128 v[124:127], v4 offset:57344
  s_waitcnt lgkmcnt(10)
  v_mfma_f32_16x16x32_bf16 v[12:15], v[140:143], v[68:71], v[12:15]
  ds_read_b128 v[128:131], v4 offset:58368
  s_waitcnt lgkmcnt(10)
  v_mfma_f32_16x16x32_bf16 v[16:19], v[144:147], v[68:71], v[16:19]
  ds_read_b128 v[132:135], v4 offset:59392
  v_lshrrev_b32 v192, 4, v0
  v_add_u32 v193, s28, v192
  v_cmp_eq_u32 vcc, 6, v192
  v_mov_b32 v194, s29
  s_nop 0
  v_cndmask_b32 v193, v193, v194, vcc
  v_lshlrev_b32 v193, 6, v193
  v_lshl_add_u32 v193, v2, 2, v193
  s_mov_b32 s45, 11321344
  buffer_load_dword v195, v193, s[12:15], s45 offen sc1
  s_waitcnt lgkmcnt(10)
  v_mfma_f32_16x16x32_bf16 v[20:23], v[148:151], v[68:71], v[20:23]
  ds_read_b128 v[136:139], v4 offset:60416
  s_waitcnt lgkmcnt(10)
  v_mfma_f32_16x16x32_bf16 v[24:27], v[152:155], v[68:71], v[24:27]
  ds_read_b128 v[140:143], v4 offset:61440
  s_mov_b32 s45, 11328256
  buffer_load_dword v196, v193, s[12:15], s45 offen sc1
  s_waitcnt vmcnt(14)
  s_waitcnt lgkmcnt(10)
  v_mfma_f32_16x16x32_bf16 v[8:11], v[156:159], v[72:75], v[8:11]
  ds_read_b128 v[144:147], v4 offset:62464
  s_waitcnt lgkmcnt(10)
  v_mfma_f32_16x16x32_bf16 v[12:15], v[160:163], v[72:75], v[12:15]
  ds_read_b128 v[148:151], v4 offset:63488
  s_waitcnt lgkmcnt(10)
  v_mfma_f32_16x16x32_bf16 v[16:19], v[164:167], v[72:75], v[16:19]
  ds_read_b128 v[152:155], v4 offset:64512
  s_mov_b32 s45, 11335168
  buffer_load_dword v197, v193, s[12:15], s45 offen sc1
  s_waitcnt lgkmcnt(10)
  v_mfma_f32_16x16x32_bf16 v[20:23], v[168:171], v[72:75], v[20:23]
  ds_read_b128 v[156:159], v6 offset:0
  s_waitcnt lgkmcnt(10)
  v_mfma_f32_16x16x32_bf16 v[24:27], v[172:175], v[72:75], v[24:27]
  ds_read_b128 v[160:163], v6 offset:1024
  s_mov_b32 s45, 11342080
  buffer_load_dword v198, v193, s[12:15], s45 offen sc1
  s_waitcnt vmcnt(15)
  s_waitcnt lgkmcnt(10)
  v_mfma_f32_16x16x32_bf16 v[8:11], v[176:179], v[76:79], v[8:11]
  ds_read_b128 v[164:167], v6 offset:2048
  s_waitcnt lgkmcnt(10)
  v_mfma_f32_16x16x32_bf16 v[12:15], v[124:127], v[76:79], v[12:15]
  ds_read_b128 v[168:171], v6 offset:3072
  s_waitcnt lgkmcnt(10)
  v_mfma_f32_16x16x32_bf16 v[16:19], v[128:131], v[76:79], v[16:19]
  ds_read_b128 v[172:175], v6 offset:4096
  s_mov_b32 s45, 11348992
  buffer_load_dword v199, v193, s[12:15], s45 offen sc1
  s_waitcnt lgkmcnt(10)
  v_mfma_f32_16x16x32_bf16 v[20:23], v[132:135], v[76:79], v[20:23]
  ds_read_b128 v[176:179], v6 offset:5120
  s_waitcnt lgkmcnt(10)
  v_mfma_f32_16x16x32_bf16 v[24:27], v[136:139], v[76:79], v[24:27]
  ds_read_b128 v[124:127], v6 offset:6144
  s_add_u32 m0, s41, 102400
  s_add_u32 s44, s40, 102400
  buffer_load_dwordx4 v4, s[12:15], s44 offen offset:0 sc1 lds
  s_waitcnt vmcnt(16)
  s_waitcnt lgkmcnt(10)
  v_mfma_f32_16x16x32_bf16 v[8:11], v[140:143], v[80:83], v[8:11]
  ds_read_b128 v[128:131], v6 offset:7168
  s_waitcnt lgkmcnt(10)
  v_mfma_f32_16x16x32_bf16 v[12:15], v[144:147], v[80:83], v[12:15]
  ds_read_b128 v[132:135], v6 offset:8192
  s_waitcnt lgkmcnt(10)
  v_mfma_f32_16x16x32_bf16 v[16:19], v[148:151], v[80:83], v[16:19]
  ds_read_b128 v[136:139], v6 offset:9216
  buffer_load_dwordx4 v4, s[12:15], s44 offen offset:1024 sc1 lds
  s_waitcnt lgkmcnt(10)
  v_mfma_f32_16x16x32_bf16 v[20:23], v[152:155], v[80:83], v[20:23]
  ds_read_b128 v[140:143], v6 offset:10240
  s_waitcnt lgkmcnt(10)
  v_mfma_f32_16x16x32_bf16 v[24:27], v[156:159], v[80:83], v[24:27]
  ds_read_b128 v[144:147], v6 offset:11264
  buffer_load_dwordx4 v4, s[12:15], s44 offen offset:2048 sc1 lds
  s_waitcnt vmcnt(17)
  s_waitcnt lgkmcnt(10)
  v_mfma_f32_16x16x32_bf16 v[8:11], v[160:163], v[84:87], v[8:11]
  ds_read_b128 v[148:151], v6 offset:12288
  s_waitcnt lgkmcnt(10)
  v_mfma_f32_16x16x32_bf16 v[12:15], v[164:167], v[84:87], v[12:15]
  ds_read_b128 v[152:155], v6 offset:13312
  s_waitcnt lgkmcnt(10)
  v_mfma_f32_16x16x32_bf16 v[16:19], v[168:171], v[84:87], v[16:19]
  ds_read_b128 v[156:159], v6 offset:14336
  buffer_load_dwordx4 v4, s[12:15], s44 offen offset:3072 sc1 lds
  s_waitcnt lgkmcnt(10)
  v_mfma_f32_16x16x32_bf16 v[20:23], v[172:175], v[84:87], v[20:23]
  ds_read_b128 v[160:163], v6 offset:15360
  s_waitcnt lgkmcnt(10)
  v_mfma_f32_16x16x32_bf16 v[24:27], v[176:179], v[84:87], v[24:27]
  ds_read_b128 v[164:167], v6 offset:16384
  s_add_u32 m0, s41, 106496
  s_add_u32 s44, s40, 106496
  buffer_load_dwordx4 v4, s[12:15], s44 offen offset:0 sc1 lds
  s_waitcnt vmcnt(18)
  s_waitcnt lgkmcnt(10)
  v_mfma_f32_16x16x32_bf16 v[8:11], v[124:127], v[88:91], v[8:11]
  ds_read_b128 v[168:171], v6 offset:17408
  s_waitcnt lgkmcnt(10)
  v_mfma_f32_16x16x32_bf16 v[12:15], v[128:131], v[88:91], v[12:15]
  ds_read_b128 v[172:175], v6 offset:18432
  s_waitcnt lgkmcnt(10)
  v_mfma_f32_16x16x32_bf16 v[16:19], v[132:135], v[88:91], v[16:19]
  ds_read_b128 v[176:179], v6 offset:19456
  s_add_u32 m0, s41, 122880
  s_mov_b32 s44, s42
  buffer_load_dwordx4 v4, s[12:15], s44 offen offset:0 sc1 lds
  s_waitcnt lgkmcnt(10)
  v_mfma_f32_16x16x32_bf16 v[20:23], v[136:139], v[88:91], v[20:23]
  ds_read_b128 v[124:127], v6 offset:20480
  s_waitcnt lgkmcnt(10)
  v_mfma_f32_16x16x32_bf16 v[24:27], v[140:143], v[88:91], v[24:27]
  ds_read_b128 v[128:131], v6 offset:21504
  buffer_load_dwordx4 v4, s[12:15], s44 offen offset:1024 sc1 lds
  s_waitcnt vmcnt(19)
  s_waitcnt lgkmcnt(10)
  v_mfma_f32_16x16x32_bf16 v[8:11], v[144:147], v[92:95], v[8:11]
  ds_read_b128 v[132:135], v6 offset:22528
  s_waitcnt lgkmcnt(10)
  v_mfma_f32_16x16x32_bf16 v[12:15], v[148:151], v[92:95], v[12:15]
  ds_read_b128 v[136:139], v6 offset:23552
  s_waitcnt lgkmcnt(10)
  v_mfma_f32_16x16x32_bf16 v[16:19], v[152:155], v[92:95], v[16:19]
  ds_read_b128 v[140:143], v6 offset:24576
  buffer_load_dwordx4 v4, s[12:15], s44 offen offset:2048 sc1 lds
  s_waitcnt lgkmcnt(10)
  v_mfma_f32_16x16x32_bf16 v[20:23], v[156:159], v[92:95], v[20:23]
  ds_read_b128 v[144:147], v6 offset:25600
  s_waitcnt lgkmcnt(10)
  v_mfma_f32_16x16x32_bf16 v[24:27], v[160:163], v[92:95], v[24:27]
  ds_read_b128 v[148:151], v6 offset:26624
  buffer_load_dwordx4 v4, s[12:15], s44 offen offset:3072 sc1 lds
  s_waitcnt vmcnt(20)
  s_waitcnt lgkmcnt(10)
  v_mfma_f32_16x16x32_bf16 v[8:11], v[164:167], v[96:99], v[8:11]
  ds_read_b128 v[152:155], v6 offset:27648
  s_waitcnt lgkmcnt(10)
  v_mfma_f32_16x16x32_bf16 v[12:15], v[168:171], v[96:99], v[12:15]
  ds_read_b128 v[156:159], v6 offset:28672
  s_waitcnt lgkmcnt(10)
  v_mfma_f32_16x16x32_bf16 v[16:19], v[172:175], v[96:99], v[16:19]
  ds_read_b128 v[160:163], v6 offset:29696
  s_add_u32 m0, s41, 126976
  s_add_u32 s44, s42, 4096
  buffer_load_dwordx4 v4, s[12:15], s44 offen offset:0 sc1 lds
  s_waitcnt lgkmcnt(10)
  v_mfma_f32_16x16x32_bf16 v[20:23], v[176:179], v[96:99], v[20:23]
  ds_read_b128 v[164:167], v6 offset:30720
  s_waitcnt lgkmcnt(10)
  v_mfma_f32_16x16x32_bf16 v[24:27], v[124:127], v[96:99], v[24:27]
  ds_read_b128 v[168:171], v6 offset:31744
  s_waitcnt vmcnt(20)
  s_waitcnt lgkmcnt(10)
  v_mfma_f32_16x16x32_bf16 v[8:11], v[128:131], v[100:103], v[8:11]
  ds_read_b128 v[172:175], v6 offset:32768
  s_waitcnt lgkmcnt(10)
  v_mfma_f32_16x16x32_bf16 v[12:15], v[132:135], v[100:103], v[12:15]
  ds_read_b128 v[176:179], v6 offset:33792
  s_waitcnt lgkmcnt(10)
  v_mfma_f32_16x16x32_bf16 v[16:19], v[136:139], v[100:103], v[16:19]
  ds_read_b128 v[124:127], v6 offset:34816
  s_waitcnt lgkmcnt(10)
  v_mfma_f32_16x16x32_bf16 v[20:23], v[140:143], v[100:103], v[20:23]
  ds_read_b128 v[128:131], v6 offset:35840
  s_waitcnt lgkmcnt(10)
  v_mfma_f32_16x16x32_bf16 v[24:27], v[144:147], v[100:103], v[24:27]
  s_waitcnt vmcnt(19)
  s_waitcnt lgkmcnt(9)
  v_mfma_f32_16x16x32_bf16 v[8:11], v[148:151], v[104:107], v[8:11]
  s_waitcnt lgkmcnt(8)
  v_mfma_f32_16x16x32_bf16 v[12:15], v[152:155], v[104:107], v[12:15]
  s_waitcnt lgkmcnt(7)
  v_mfma_f32_16x16x32_bf16 v[16:19], v[156:159], v[104:107], v[16:19]
  s_waitcnt lgkmcnt(6)
  v_mfma_f32_16x16x32_bf16 v[20:23], v[160:163], v[104:107], v[20:23]
  s_waitcnt lgkmcnt(5)
  v_mfma_f32_16x16x32_bf16 v[24:27], v[164:167], v[104:107], v[24:27]
  s_waitcnt vmcnt(18)
  s_waitcnt lgkmcnt(4)
  v_mfma_f32_16x16x32_bf16 v[8:11], v[168:171], v[108:111], v[8:11]
  s_waitcnt lgkmcnt(3)
  v_mfma_f32_16x16x32_bf16 v[12:15], v[172:175], v[108:111], v[12:15]
  s_waitcnt lgkmcnt(2)
  v_mfma_f32_16x16x32_bf16 v[16:19], v[176:179], v[108:111], v[16:19]
  s_waitcnt lgkmcnt(1)
  v_mfma_f32_16x16x32_bf16 v[20:23], v[124:127], v[108:111], v[20:23]
  s_waitcnt lgkmcnt(0)
  v_mfma_f32_16x16x32_bf16 v[24:27], v[128:131], v[108:111], v[24:27]
  s_barrier
  s_waitcnt vmcnt(15)
  s_mov_b32 s80, 0xffff0000
  v_lshlrev_b32 v32, 16, v112
  v_and_b32 v33, s80, v112
  v_pk_add_f32 v[8:9], v[8:9], v[32:33]
  v_lshlrev_b32 v34, 16, v113
  v_and_b32 v35, s80, v113
  v_pk_add_f32 v[10:11], v[10:11], v[34:35]
  v_lshlrev_b32 v36, 16, v114
  v_and_b32 v37, s80, v114
  v_pk_add_f32 v[12:13], v[12:13], v[36:37]
  v_lshlrev_b32 v38, 16, v115
  v_and_b32 v39, s80, v115
  v_pk_add_f32 v[14:15], v[14:15], v[38:39]
  v_lshlrev_b32 v40, 16, v116
  v_and_b32 v41, s80, v116
  v_pk_add_f32 v[16:17], v[16:17], v[40:41]
  v_lshlrev_b32 v42, 16, v117
  v_and_b32 v43, s80, v117
  v_pk_add_f32 v[18:19], v[18:19], v[42:43]
  v_lshlrev_b32 v44, 16, v118
  v_and_b32 v45, s80, v118
  v_pk_add_f32 v[20:21], v[20:21], v[44:45]
  v_lshlrev_b32 v46, 16, v119
  v_and_b32 v47, s80, v119
  v_pk_add_f32 v[22:23], v[22:23], v[46:47]
  v_lshlrev_b32 v48, 16, v120
  v_and_b32 v49, s80, v120
  v_pk_add_f32 v[24:25], v[24:25], v[48:49]
  v_lshlrev_b32 v50, 16, v121
  v_and_b32 v51, s80, v121
  v_pk_add_f32 v[26:27], v[26:27], v[50:51]
  v_cvt_pk_bf16_f32 v60, v8, v9
  v_cvt_pk_bf16_f32 v61, v10, v11
  v_cvt_pk_bf16_f32 v62, v12, v13
  v_cvt_pk_bf16_f32 v63, v14, v15
  v_cvt_pk_bf16_f32 v64, v16, v17
  v_cvt_pk_bf16_f32 v65, v18, v19
  v_cvt_pk_bf16_f32 v66, v20, v21
  v_cvt_pk_bf16_f32 v67, v22, v23
  v_cvt_pk_bf16_f32 v68, v24, v25
  v_cvt_pk_bf16_f32 v69, v26, v27
  s_add_u32 s80, s70, 19222528
  s_add_u32 s81, s71, 19222528
  buffer_store_dwordx4 v[60:63], v4, s[12:15], s80 offen sc1
  buffer_store_dwordx4 v[64:67], v4, s[12:15], s80 offen offset:1024 sc1
  v_lshlrev_b32 v80, 3, v1
  s_lshr_b32 s80, s10, 1
  s_lshl_b32 s80, s80, 9
  s_add_u32 s80, s80, 143872
  v_add_u32 v80, s80, v80
  s_bitcmp0_b32 s10, 0
  s_cbranch_scc1 sequential_preLN__ssm_conv_h3__mixer_s_mlp__prompt_kernel_x1x0
  ds_write_b64 v80, v[68:69]
sequential_preLN__ssm_conv_h3__mixer_s_mlp__prompt_kernel_x1x0:
  v_pk_mul_f32 v[72:73], v[8:9], v[8:9]
  v_pk_add_f32 v[74:75], v[8:9], v[10:11]
  v_pk_fma_f32 v[72:73], v[10:11], v[10:11], v[72:73]
  v_pk_add_f32 v[74:75], v[74:75], v[12:13]
  v_pk_fma_f32 v[72:73], v[12:13], v[12:13], v[72:73]
  v_pk_add_f32 v[74:75], v[74:75], v[14:15]
  v_pk_fma_f32 v[72:73], v[14:15], v[14:15], v[72:73]
  v_pk_add_f32 v[74:75], v[74:75], v[16:17]
  v_pk_fma_f32 v[72:73], v[16:17], v[16:17], v[72:73]
  v_pk_add_f32 v[74:75], v[74:75], v[18:19]
  v_pk_fma_f32 v[72:73], v[18:19], v[18:19], v[72:73]
  v_pk_add_f32 v[74:75], v[74:75], v[20:21]
  v_pk_fma_f32 v[72:73], v[20:21], v[20:21], v[72:73]
  v_pk_add_f32 v[74:75], v[74:75], v[22:23]
  v_pk_fma_f32 v[72:73], v[22:23], v[22:23], v[72:73]
  v_pk_add_f32 v[74:75], v[74:75], v[24:25]
  v_pk_fma_f32 v[72:73], v[24:25], v[24:25], v[72:73]
  v_pk_add_f32 v[74:75], v[74:75], v[26:27]
  v_pk_fma_f32 v[72:73], v[26:27], v[26:27], v[72:73]
  v_add_f32 v74, v74, v75
  v_add_f32 v72, v72, v73
  s_lshl_b32 s80, s63, 3
  s_add_u32 s80, s80, s61
  s_lshl_b32 s80, s80, 7
  s_add_u32 s80, s80, 21843968
  v_permlane32_swap_b32 v74, v72
  v_add_f32 v74, v74, v72
  v_mov_b32 v75, v74
  s_nop 1
  v_permlane16_swap_b32 v74, v75
  v_add_f32 v74, v74, v75
  v_mov_b32 v75, v74
  v_lshlrev_b32 v6, 3, v2
  s_nop 0
  v_permlane32_swap_b32 v74, v75
  s_mov_b64 exec, 0xffff
  buffer_store_dwordx2 v[74:75], v6, s[12:15], s80 offen sc1
  s_mov_b64 exec, -1
  s_waitcnt lgkmcnt(0)
  s_barrier
  s_bitcmp1_b32 s10, 0
  s_cbranch_scc1 sequential_preLN__ssm_conv_h3__mixer_s_mlp__prompt_kernel_x1x1
  ds_read_b64 v[70:71], v80
  s_add_u32 s80, s63, s62
  s_mul_i32 s80, s80, 20480
  s_lshr_b32 s81, s68, 1
  s_lshl_b32 s81, s81, 10
  s_add_u32 s80, s80, s81
  s_add_u32 s80, s80, 19222528
  s_waitcnt lgkmcnt(0)
  buffer_store_dwordx4 v[68:71], v4, s[12:15], s80 offen sc1
sequential_preLN__ssm_conv_h3__mixer_s_mlp__prompt_kernel_x1x1:
  s_add_u32 m0, s41, 0
  s_add_u32 s44, s40, 0
  buffer_load_dwordx4 v4, s[12:15], s44 offen offset:0 sc1 lds
  buffer_load_dwordx4 v4, s[12:15], s44 offen offset:1024 sc1 lds
  buffer_load_dwordx4 v4, s[12:15], s44 offen offset:2048 sc1 lds
  buffer_load_dwordx4 v4, s[12:15], s44 offen offset:3072 sc1 lds
  s_add_u32 m0, s41, 4096
  s_add_u32 s44, s40, 4096
  buffer_load_dwordx4 v4, s[12:15], s44 offen offset:0 sc1 lds
  s_add_u32 m0, s41, 20480
  s_add_u32 s44, s40, 20480
  buffer_load_dwordx4 v4, s[12:15], s44 offen offset:0 sc1 lds
  buffer_load_dwordx4 v4, s[12:15], s44 offen offset:1024 sc1 lds
  buffer_load_dwordx4 v4, s[12:15], s44 offen offset:2048 sc1 lds
  buffer_load_dwordx4 v4, s[12:15], s44 offen offset:3072 sc1 lds
  s_add_u32 m0, s41, 24576
  s_add_u32 s44, s40, 24576
  buffer_load_dwordx4 v4, s[12:15], s44 offen offset:0 sc1 lds
  s_waitcnt vmcnt(10)
  s_barrier
  s_cmp_lg_u32 s10, 0
  s_cbranch_scc1 sequential_preLN__ssm_conv_h3__mixer_s_mlp__prompt_kernel_sig20
  s_lshr_b32 s84, s60, 1
  s_lshl_b32 s84, s84, 2
  s_lshr_b32 s85, s61, 1
  s_add_u32 s84, s84, s85
  s_lshl_b32 s84, s84, 7
  s_add_u32 s84, s84, 29061120
  v_mov_b32 v5, 0
  v_mov_b32 v6, 1
  s_mov_b64 exec, 1
  buffer_atomic_add v6, v5, s[12:15], s84 offen sc1
  s_mov_b64 exec, -1
sequential_preLN__ssm_conv_h3__mixer_s_mlp__prompt_kernel_sig20:
sequential_preLN__ssm_conv_h3__mixer_s_mlp__prompt_kernel_ph4:
  s_mul_i32 s78, s10, 14336
  s_mul_i32 s72, s64, 55296
  s_add_u32 s72, s72, s78
  s_add_u32 s72, s72, 9109504
  s_mul_i32 s73, s65, 55296
  s_add_u32 s73, s73, s78
  s_add_u32 s73, s73, 9109504
  s_mul_i32 s74, s66, 55296
  s_add_u32 s74, s74, s78
  s_add_u32 s74, s74, 9109504
  s_mul_i32 s75, s67, 55296
  s_add_u32 s75, s75, s78
  s_add_u32 s75, s75, 9109504
  s_mul_i32 s76, s68, 55296
  s_add_u32 s76, s76, s78
  s_add_u32 s76, s76, 9109504
  s_cmp_eq_u32 s10, 3
  s_cselect_b32 s77, 0x40000000, 0
  s_add_u32 m0, s41, 40960
  s_add_u32 s44, s40, 40960
  buffer_load_dwordx4 v4, s[12:15], s44 offen offset:0 sc1 lds
  buffer_load_dwordx4 v4, s[12:15], s44 offen offset:1024 sc1 lds
  buffer_load_dwordx4 v4, s[12:15], s44 offen offset:2048 sc1 lds
  buffer_load_dwordx4 v4, s[12:15], s44 offen offset:3072 sc1 lds
  s_add_u32 m0, s41, 45056
  s_add_u32 s44, s40, 45056
  buffer_load_dwordx4 v4, s[12:15], s44 offen offset:0 sc1 lds
  s_add_u32 m0, s41, 61440
  s_add_u32 s44, s40, 61440
  buffer_load_dwordx4 v4, s[12:15], s44 offen offset:0 sc1 lds
  buffer_load_dwordx4 v4, s[12:15], s44 offen offset:1024 sc1 lds
  buffer_load_dwordx4 v4, s[12:15], s44 offen offset:2048 sc1 lds
  buffer_load_dwordx4 v4, s[12:15], s44 offen offset:3072 sc1 lds
  s_add_u32 m0, s41, 65536
  s_add_u32 s44, s40, 65536
  buffer_load_dwordx4 v4, s[12:15], s44 offen offset:0 sc1 lds
  s_add_u32 m0, s41, 81920
  s_add_u32 s44, s40, 81920
  buffer_load_dwordx4 v4, s[12:15], s44 offen offset:0 sc1 lds
  buffer_load_dwordx4 v4, s[12:15], s44 offen offset:1024 sc1 lds
  buffer_load_dwordx4 v4, s[12:15], s44 offen offset:2048 sc1 lds
  buffer_load_dwordx4 v4, s[12:15], s44 offen offset:3072 sc1 lds
  s_add_u32 m0, s41, 86016
  s_add_u32 s44, s40, 86016
  buffer_load_dwordx4 v4, s[12:15], s44 offen offset:0 sc1 lds
  s_cmp_lg_u32 s10, 0
  s_nop 4
  s_cbranch_scc1 sequential_preLN__ssm_conv_h3__mixer_s_mlp__prompt_kernel_wt21
  s_lshl_b32 s84, s24, 9
  s_add_u32 s84, s84, 29061120
  v_and_b32 v5, 3, v1
  v_lshlrev_b32 v5, 7, v5
  v_add_u32 v5, s84, v5
  v_mov_b32 v7, 4
  s_mov_b32 s85, 0
sequential_preLN__ssm_conv_h3__mixer_s_mlp__prompt_kernel_pl22_l:
  buffer_load_dword v6, v5, s[12:15], 0 offen sc1
  s_add_u32 s85, s85, 1
  s_waitcnt vmcnt(0)
  v_cmp_gt_u32 vcc, v7, v6
  s_cmp_gt_u32 s85, 200000
  s_nop 4
  s_cbranch_scc1 sequential_preLN__ssm_conv_h3__mixer_s_mlp__prompt_kernel_pl22
  s_nop 2
  s_cbranch_vccnz sequential_preLN__ssm_conv_h3__mixer_s_mlp__prompt_kernel_pl22_l
sequential_preLN__ssm_conv_h3__mixer_s_mlp__prompt_kernel_pl22:
sequential_preLN__ssm_conv_h3__mixer_s_mlp__prompt_kernel_wt21:
  s_waitcnt vmcnt(0)
  v_add_f32 v195, v195, v196
  v_add_f32 v197, v197, v198
  v_add_f32 v195, v195, v199
  v_add_f32 v195, v195, v197
  v_lshlrev_b32 v196, 2, v0
  v_add_u32 v196, 143360, v196
  v_cmp_gt_u32 vcc, 112, v0
  s_nop 4
  s_and_saveexec_b64 s[56:57], vcc
  s_cbranch_execz sequential_preLN__ssm_conv_h3__mixer_s_mlp__prompt_kernel_nocs
  ds_write_b32 v196, v195
sequential_preLN__ssm_conv_h3__mixer_s_mlp__prompt_kernel_nocs:
  s_mov_b64 exec, s[56:57]
  s_waitcnt lgkmcnt(0)
  s_barrier
  s_mul_i32 s47, s30, 20480
  s_add_u32 s47, s47, 19222528
  s_add_u32 s48, s47, 20480
  v_lshlrev_b32 v6, 8, v3
  v_lshl_add_u32 v6, v2, 3, v6
  s_lshl_b32 s37, s30, 10
  s_add_u32 s37, s37, 21843968
  buffer_load_dwordx4 a[0:3], v4, s[12:15], s47 offen offset:0 sc1
  buffer_load_dwordx4 a[4:7], v4, s[12:15], s48 offen offset:0 sc1
  buffer_load_dwordx4 a[8:11], v4, s[12:15], s47 offen offset:1024 sc1
  buffer_load_dwordx4 a[12:15], v4, s[12:15], s48 offen offset:1024 sc1
  buffer_load_dwordx2 v[8:9], v6, s[12:15], s37 offen offset:0 sc1
  buffer_load_dwordx2 v[10:11], v6, s[12:15], s37 offen offset:128 sc1
  buffer_load_dwordx2 v[12:13], v6, s[12:15], s37 offen offset:1024 sc1
  buffer_load_dwordx2 v[14:15], v6, s[12:15], s37 offen offset:1152 sc1
  buffer_load_dwordx4 v[88:91], v4, s[12:15], s47 offen offset:2048 sc1
  buffer_load_dwordx4 v[92:95], v4, s[12:15], s48 offen offset:2048 sc1
  buffer_load_dwordx4 a[24:27], v4, s[12:15], s47 offen offset:3072 sc1
  buffer_load_dwordx4 a[28:31], v4, s[12:15], s48 offen offset:3072 sc1
  s_add_u32 s47, s47, 4096
  s_add_u32 s48, s48, 4096
  buffer_load_dwordx4 a[32:35], v4, s[12:15], s47 offen offset:0 sc1
  buffer_load_dwordx4 a[36:39], v4, s[12:15], s48 offen offset:0 sc1
  s_mov_b32 s50, 0xc0135761
  s_mov_b32 s51, 0xbdd2d3e8
  s_mov_b32 s54, 0x3acccccd
  s_mov_b32 s55, 0x3727c5ac
  v_lshlrev_b32 v5, 4, v3
  v_add_u32 v5, 143360, v5
  ds_read_b128 v[120:123], v5 offset:0
  ds_read_b128 v[124:127], v5 offset:64
  ds_read_b128 v[128:131], v5 offset:128
  ds_read_b128 v[132:135], v5 offset:192
  ds_read_b128 v[136:139], v5 offset:256
  ds_read_b128 v[140:143], v5 offset:320
  ds_read_b128 v[144:147], v5 offset:384
  v_add_u32 v6, 0x10000, v4
  v_add_u32 v7, 0x20000, v4
  s_cmp_eq_u32 s26, 2
  s_cbranch_scc1 sequential_preLN__ssm_conv_h3__mixer_s_mlp__prompt_kernel_g5
  s_waitcnt lgkmcnt(0)
  ds_read_b128 v[176:179], v4 offset:0
  ds_read_b128 v[180:183], v4 offset:20480
  ds_read_b128 v[184:187], v4 offset:40960
  ds_read_b128 v[188:191], v4 offset:61440
  ds_read_b128 v[192:195], v6 offset:16384
  ds_read_b128 v[196:199], v6 offset:36864
  ds_read_b128 v[200:203], v6 offset:57344
  ds_read_b128 v[204:207], v4 offset:1024
  ds_read_b128 v[208:211], v4 offset:21504
  ds_read_b128 v[212:215], v4 offset:41984
  ds_read_b128 v[216:219], v4 offset:62464
  s_waitcnt vmcnt(12)
  s_waitcnt lgkmcnt(9)
  v_mfma_f32_16x16x32_bf16 v[32:35], v[176:179], a[0:3], 0
  ds_read_b128 v[220:223], v6 offset:17408
  v_mfma_f32_16x16x32_bf16 v[40:43], v[176:179], a[4:7], 0
  buffer_load_dwordx4 a[40:43], v4, s[12:15], s47 offen offset:1024 sc1
  v_mfma_f32_16x16x32_bf16 v[36:39], v[180:183], a[0:3], 0
  ds_read_b128 v[224:227], v6 offset:37888
  v_mfma_f32_16x16x32_bf16 v[44:47], v[180:183], a[4:7], 0
  s_waitcnt lgkmcnt(9)
  v_mfma_f32_16x16x32_bf16 v[48:51], v[184:187], a[0:3], 0
  ds_read_b128 v[228:231], v6 offset:58368
  v_mfma_f32_16x16x32_bf16 v[56:59], v[184:187], a[4:7], 0
  v_mfma_f32_16x16x32_bf16 v[52:55], v[188:191], a[0:3], 0
  ds_read_b128 v[176:179], v4 offset:2048
  v_mfma_f32_16x16x32_bf16 v[60:63], v[188:191], a[4:7], 0
  buffer_load_dwordx4 a[44:47], v4, s[12:15], s48 offen offset:1024 sc1
  s_waitcnt lgkmcnt(9)
  v_mfma_f32_16x16x32_bf16 v[64:67], v[192:195], a[0:3], 0
  ds_read_b128 v[180:183], v4 offset:22528
  v_mfma_f32_16x16x32_bf16 v[72:75], v[192:195], a[4:7], 0
  v_mfma_f32_16x16x32_bf16 v[68:71], v[196:199], a[0:3], 0
  ds_read_b128 v[184:187], v4 offset:43008
  v_mfma_f32_16x16x32_bf16 v[76:79], v[196:199], a[4:7], 0
  s_waitcnt lgkmcnt(9)
  v_mfma_f32_16x16x32_bf16 v[80:83], v[200:203], a[0:3], 0
  ds_read_b128 v[188:191], v4 offset:63488
  v_mfma_f32_16x16x32_bf16 v[84:87], v[200:203], a[4:7], 0
  s_waitcnt vmcnt(12)
  v_mfma_f32_16x16x32_bf16 v[32:35], v[204:207], a[8:11], v[32:35]
  ds_read_b128 v[192:195], v6 offset:18432
  v_mfma_f32_16x16x32_bf16 v[40:43], v[204:207], a[12:15], v[40:43]
  buffer_load_dwordx4 a[48:51], v4, s[12:15], s47 offen offset:2048 sc1
  s_waitcnt lgkmcnt(9)
  v_mfma_f32_16x16x32_bf16 v[36:39], v[208:211], a[8:11], v[36:39]
  ds_read_b128 v[196:199], v6 offset:38912
  v_mfma_f32_16x16x32_bf16 v[44:47], v[208:211], a[12:15], v[44:47]
  v_mfma_f32_16x16x32_bf16 v[48:51], v[212:215], a[8:11], v[48:51]
  ds_read_b128 v[200:203], v6 offset:59392
  v_mfma_f32_16x16x32_bf16 v[56:59], v[212:215], a[12:15], v[56:59]
  s_waitcnt lgkmcnt(9)
  v_mfma_f32_16x16x32_bf16 v[52:55], v[216:219], a[8:11], v[52:55]
  ds_read_b128 v[204:207], v4 offset:3072
  v_mfma_f32_16x16x32_bf16 v[60:63], v[216:219], a[12:15], v[60:63]
  buffer_load_dwordx4 a[52:55], v4, s[12:15], s48 offen offset:2048 sc1
  v_mfma_f32_16x16x32_bf16 v[64:67], v[220:223], a[8:11], v[64:67]
  ds_read_b128 v[208:211], v4 offset:23552
  v_mfma_f32_16x16x32_bf16 v[72:75], v[220:223], a[12:15], v[72:75]
  s_waitcnt lgkmcnt(9)
  v_mfma_f32_16x16x32_bf16 v[68:71], v[224:227], a[8:11], v[68:71]
  ds_read_b128 v[212:215], v4 offset:44032
  v_mfma_f32_16x16x32_bf16 v[76:79], v[224:227], a[12:15], v[76:79]
  v_mfma_f32_16x16x32_bf16 v[80:83], v[228:231], a[8:11], v[80:83]
  ds_read_b128 v[216:219], v4 offset:64512
  v_mfma_f32_16x16x32_bf16 v[84:87], v[228:231], a[12:15], v[84:87]
  s_waitcnt vmcnt(8)
  v_swap_b32 v90, v92
  v_swap_b32 v91, v93
  s_waitcnt lgkmcnt(9)
  s_nop 0
  v_mfma_f32_16x16x32_bf16 v[32:35], v[176:179], v[88:91], v[32:35]
  ds_read_b128 v[220:223], v6 offset:19456
  v_mfma_f32_16x16x32_bf16 v[40:43], v[176:179], v[92:95], v[40:43]
  buffer_load_dwordx4 v[96:99], v4, s[12:15], s47 offen offset:3072 sc1
  v_add_f32 v16, v8, v10
  v_mfma_f32_16x16x32_bf16 v[36:39], v[180:183], v[88:91], v[36:39]
  ds_read_b128 v[224:227], v6 offset:39936
  v_mfma_f32_16x16x32_bf16 v[44:47], v[180:183], v[92:95], v[44:47]
  v_add_f32 v17, v9, v11
  s_waitcnt lgkmcnt(9)
  v_mfma_f32_16x16x32_bf16 v[48:51], v[184:187], v[88:91], v[48:51]
  ds_read_b128 v[228:231], v6 offset:60416
  v_mfma_f32_16x16x32_bf16 v[56:59], v[184:187], v[92:95], v[56:59]
  v_add_f32 v18, v12, v14
  v_mfma_f32_16x16x32_bf16 v[52:55], v[188:191], v[88:91], v[52:55]
  ds_read_b128 v[176:179], v4 offset:4096
  v_mfma_f32_16x16x32_bf16 v[60:63], v[188:191], v[92:95], v[60:63]
  buffer_load_dwordx4 v[100:103], v4, s[12:15], s48 offen offset:3072 sc1
  v_add_f32 v19, v13, v15
  s_waitcnt lgkmcnt(9)
  v_mfma_f32_16x16x32_bf16 v[64:67], v[192:195], v[88:91], v[64:67]
  ds_read_b128 v[180:183], v4 offset:24576
  v_mfma_f32_16x16x32_bf16 v[72:75], v[192:195], v[92:95], v[72:75]
  v_mov_b32 v8, v16
  v_mfma_f32_16x16x32_bf16 v[68:71], v[196:199], v[88:91], v[68:71]
  ds_read_b128 v[184:187], v4 offset:45056
  v_mfma_f32_16x16x32_bf16 v[76:79], v[196:199], v[92:95], v[76:79]
  v_permlane32_swap_b32 v16, v8
  s_waitcnt lgkmcnt(9)
  v_mfma_f32_16x16x32_bf16 v[80:83], v[200:203], v[88:91], v[80:83]
  ds_read_b128 v[188:191], v6 offset:0
  v_mfma_f32_16x16x32_bf16 v[84:87], v[200:203], v[92:95], v[84:87]
  v_add_f32 v16, v16, v8
  s_waitcnt vmcnt(8)
  v_mfma_f32_16x16x32_bf16 v[32:35], v[204:207], a[24:27], v[32:35]
  ds_read_b128 v[192:195], v6 offset:20480
  v_mfma_f32_16x16x32_bf16 v[40:43], v[204:207], a[28:31], v[40:43]
  s_add_u32 s47, s47, 4096
  s_add_u32 s48, s48, 4096
  buffer_load_dwordx4 a[64:67], v4, s[12:15], s47 offen offset:0 sc1
  v_mov_b32 v8, v16
  s_waitcnt lgkmcnt(9)
  v_mfma_f32_16x16x32_bf16 v[36:39], v[208:211], a[24:27], v[36:39]
  ds_read_b128 v[196:199], v6 offset:40960
  v_mfma_f32_16x16x32_bf16 v[44:47], v[208:211], a[28:31], v[44:47]
  buffer_load_dwordx4 a[68:71], v4, s[12:15], s48 offen offset:0 sc1
  v_permlane16_swap_b32 v16, v8
  v_mfma_f32_16x16x32_bf16 v[48:51], v[212:215], a[24:27], v[48:51]
  ds_read_b128 v[200:203], v6 offset:61440
  v_mfma_f32_16x16x32_bf16 v[56:59], v[212:215], a[28:31], v[56:59]
  v_add_f32 v16, v16, v8
  s_waitcnt lgkmcnt(9)
  v_mfma_f32_16x16x32_bf16 v[52:55], v[216:219], a[24:27], v[52:55]
  ds_read_b128 v[204:207], v4 offset:5120
  v_mfma_f32_16x16x32_bf16 v[60:63], v[216:219], a[28:31], v[60:63]
  buffer_load_dwordx4 a[72:75], v4, s[12:15], s47 offen offset:1024 sc1
  v_mov_b32 v9, v17
  v_mfma_f32_16x16x32_bf16 v[64:67], v[220:223], a[24:27], v[64:67]
  ds_read_b128 v[208:211], v4 offset:25600
  v_mfma_f32_16x16x32_bf16 v[72:75], v[220:223], a[28:31], v[72:75]
  v_permlane32_swap_b32 v17, v9
  s_waitcnt lgkmcnt(9)
  v_mfma_f32_16x16x32_bf16 v[68:71], v[224:227], a[24:27], v[68:71]
  ds_read_b128 v[212:215], v4 offset:46080
  v_mfma_f32_16x16x32_bf16 v[76:79], v[224:227], a[28:31], v[76:79]
  v_add_f32 v17, v17, v9
  v_mfma_f32_16x16x32_bf16 v[80:83], v[228:231], a[24:27], v[80:83]
  ds_read_b128 v[216:219], v6 offset:1024
  v_mfma_f32_16x16x32_bf16 v[84:87], v[228:231], a[28:31], v[84:87]
  v_mov_b32 v9, v17
  s_waitcnt vmcnt(9)
  s_waitcnt lgkmcnt(9)
  v_mfma_f32_16x16x32_bf16 v[32:35], v[176:179], a[32:35], v[32:35]
  ds_read_b128 v[220:223], v6 offset:21504
  v_mfma_f32_16x16x32_bf16 v[40:43], v[176:179], a[36:39], v[40:43]
  buffer_load_dwordx4 a[76:79], v4, s[12:15], s48 offen offset:1024 sc1
  v_permlane16_swap_b32 v17, v9
  v_mfma_f32_16x16x32_bf16 v[36:39], v[180:183], a[32:35], v[36:39]
  ds_read_b128 v[224:227], v6 offset:41984
  v_mfma_f32_16x16x32_bf16 v[44:47], v[180:183], a[36:39], v[44:47]
  buffer_load_dwordx4 a[80:83], v4, s[12:15], s47 offen offset:2048 sc1
  v_add_f32 v17, v17, v9
  s_waitcnt lgkmcnt(9)
  v_mfma_f32_16x16x32_bf16 v[48:51], v[184:187], a[32:35], v[48:51]
  ds_read_b128 v[228:231], v6 offset:62464
  v_mfma_f32_16x16x32_bf16 v[56:59], v[184:187], a[36:39], v[56:59]
  v_mov_b32 v10, v18
  v_mfma_f32_16x16x32_bf16 v[52:55], v[188:191], a[32:35], v[52:55]
  ds_read_b128 v[176:179], v4 offset:6144
  v_mfma_f32_16x16x32_bf16 v[60:63], v[188:191], a[36:39], v[60:63]
  buffer_load_dwordx4 a[84:87], v4, s[12:15], s48 offen offset:2048 sc1
  v_permlane32_swap_b32 v18, v10
  s_waitcnt lgkmcnt(9)
  v_mfma_f32_16x16x32_bf16 v[64:67], v[192:195], a[32:35], v[64:67]
  ds_read_b128 v[180:183], v4 offset:26624
  v_mfma_f32_16x16x32_bf16 v[72:75], v[192:195], a[36:39], v[72:75]
  v_add_f32 v18, v18, v10
  v_mfma_f32_16x16x32_bf16 v[68:71], v[196:199], a[32:35], v[68:71]
  ds_read_b128 v[184:187], v4 offset:47104
  v_mfma_f32_16x16x32_bf16 v[76:79], v[196:199], a[36:39], v[76:79]
  v_mov_b32 v10, v18
  s_waitcnt lgkmcnt(9)
  v_mfma_f32_16x16x32_bf16 v[80:83], v[200:203], a[32:35], v[80:83]
  ds_read_b128 v[188:191], v6 offset:2048
  v_mfma_f32_16x16x32_bf16 v[84:87], v[200:203], a[36:39], v[84:87]
  v_permlane16_swap_b32 v18, v10
  s_waitcnt vmcnt(10)
  v_mfma_f32_16x16x32_bf16 v[32:35], v[204:207], a[40:43], v[32:35]
  ds_read_b128 v[192:195], v6 offset:22528
  v_mfma_f32_16x16x32_bf16 v[40:43], v[204:207], a[44:47], v[40:43]
  buffer_load_dwordx4 a[88:91], v4, s[12:15], s47 offen offset:3072 sc1
  v_add_f32 v18, v18, v10
  s_waitcnt lgkmcnt(9)
  v_mfma_f32_16x16x32_bf16 v[36:39], v[208:211], a[40:43], v[36:39]
  ds_read_b128 v[196:199], v6 offset:43008
  v_mfma_f32_16x16x32_bf16 v[44:47], v[208:211], a[44:47], v[44:47]
  buffer_load_dwordx4 a[92:95], v4, s[12:15], s48 offen offset:3072 sc1
  v_mov_b32 v11, v19
  v_mfma_f32_16x16x32_bf16 v[48:51], v[212:215], a[40:43], v[48:51]
  ds_read_b128 v[200:203], v6 offset:63488
  v_mfma_f32_16x16x32_bf16 v[56:59], v[212:215], a[44:47], v[56:59]
  v_permlane32_swap_b32 v19, v11
  s_waitcnt lgkmcnt(9)
  v_mfma_f32_16x16x32_bf16 v[52:55], v[216:219], a[40:43], v[52:55]
  ds_read_b128 v[204:207], v4 offset:7168
  v_mfma_f32_16x16x32_bf16 v[60:63], v[216:219], a[44:47], v[60:63]
  s_add_u32 s47, s47, 4096
  s_add_u32 s48, s48, 4096
  buffer_load_dwordx4 v[104:107], v4, s[12:15], s47 offen offset:0 sc1
  v_add_f32 v19, v19, v11
  v_mfma_f32_16x16x32_bf16 v[64:67], v[220:223], a[40:43], v[64:67]
  ds_read_b128 v[208:211], v4 offset:27648
  v_mfma_f32_16x16x32_bf16 v[72:75], v[220:223], a[44:47], v[72:75]
  v_mov_b32 v11, v19
  s_waitcnt lgkmcnt(9)
  v_mfma_f32_16x16x32_bf16 v[68:71], v[224:227], a[40:43], v[68:71]
  ds_read_b128 v[212:215], v4 offset:48128
  v_mfma_f32_16x16x32_bf16 v[76:79], v[224:227], a[44:47], v[76:79]
  v_permlane16_swap_b32 v19, v11
  v_mfma_f32_16x16x32_bf16 v[80:83], v[228:231], a[40:43], v[80:83]
  ds_read_b128 v[216:219], v6 offset:3072
  v_mfma_f32_16x16x32_bf16 v[84:87], v[228:231], a[44:47], v[84:87]
  v_add_f32 v19, v19, v11
  s_waitcnt vmcnt(11)
  s_waitcnt lgkmcnt(9)
  v_mfma_f32_16x16x32_bf16 v[32:35], v[176:179], a[48:51], v[32:35]
  ds_read_b128 v[220:223], v6 offset:23552
  v_mfma_f32_16x16x32_bf16 v[40:43], v[176:179], a[52:55], v[40:43]
  buffer_load_dwordx4 v[108:111], v4, s[12:15], s48 offen offset:0 sc1
  v_mul_f32 v16, s54, v16
  v_mfma_f32_16x16x32_bf16 v[36:39], v[180:183], a[48:51], v[36:39]
  ds_read_b128 v[224:227], v6 offset:44032
  v_mfma_f32_16x16x32_bf16 v[44:47], v[180:183], a[52:55], v[44:47]
  buffer_load_dwordx4 a[104:107], v4, s[12:15], s47 offen offset:1024 sc1
  v_mul_f32 v17, s54, v17
  s_waitcnt lgkmcnt(9)
  v_mfma_f32_16x16x32_bf16 v[48:51], v[184:187], a[48:51], v[48:51]
  ds_read_b128 v[228:231], v6 offset:64512
  v_mfma_f32_16x16x32_bf16 v[56:59], v[184:187], a[52:55], v[56:59]
  v_fma_f32 v17, -v16, v16, v17
  v_mfma_f32_16x16x32_bf16 v[52:55], v[188:191], a[48:51], v[52:55]
  ds_read_b128 v[176:179], v4 offset:8192
  v_mfma_f32_16x16x32_bf16 v[60:63], v[188:191], a[52:55], v[60:63]
  buffer_load_dwordx4 a[108:111], v4, s[12:15], s48 offen offset:1024 sc1
  v_max_f32 v17, 0, v17
  s_waitcnt lgkmcnt(9)
  v_mfma_f32_16x16x32_bf16 v[64:67], v[192:195], a[48:51], v[64:67]
  ds_read_b128 v[180:183], v4 offset:28672
  v_mfma_f32_16x16x32_bf16 v[72:75], v[192:195], a[52:55], v[72:75]
  v_add_f32 v17, s55, v17
  v_mfma_f32_16x16x32_bf16 v[68:71], v[196:199], a[48:51], v[68:71]
  ds_read_b128 v[184:187], v4 offset:49152
  v_mfma_f32_16x16x32_bf16 v[76:79], v[196:199], a[52:55], v[76:79]
  v_rsq_f32 v17, v17
  s_waitcnt lgkmcnt(9)
  v_mfma_f32_16x16x32_bf16 v[80:83], v[200:203], a[48:51], v[80:83]
  ds_read_b128 v[188:191], v6 offset:4096
  v_mfma_f32_16x16x32_bf16 v[84:87], v[200:203], a[52:55], v[84:87]
  v_mul_f32 v168, v17, v17
  s_waitcnt vmcnt(12)
  v_swap_b32 v98, v100
  v_swap_b32 v99, v101
  s_nop 1
  v_mfma_f32_16x16x32_bf16 v[32:35], v[204:207], v[96:99], v[32:35]
  ds_read_b128 v[192:195], v6 offset:24576
  v_mfma_f32_16x16x32_bf16 v[40:43], v[204:207], v[100:103], v[40:43]
  buffer_load_dwordx4 a[112:115], v4, s[12:15], s47 offen offset:2048 sc1
  v_mul_f32 v169, s50, v17
  s_waitcnt lgkmcnt(9)
  v_mfma_f32_16x16x32_bf16 v[36:39], v[208:211], v[96:99], v[36:39]
  ds_read_b128 v[196:199], v6 offset:45056
  v_mfma_f32_16x16x32_bf16 v[44:47], v[208:211], v[100:103], v[44:47]
  buffer_load_dwordx4 a[116:119], v4, s[12:15], s48 offen offset:2048 sc1
  v_mul_f32 v168, v168, v17
  v_mfma_f32_16x16x32_bf16 v[48:51], v[212:215], v[96:99], v[48:51]
  ds_read_b128 v[200:203], v7 offset:0
  v_mfma_f32_16x16x32_bf16 v[56:59], v[212:215], v[100:103], v[56:59]
  v_rcp_f32 v172, v17
  s_waitcnt lgkmcnt(9)
  v_mfma_f32_16x16x32_bf16 v[52:55], v[216:219], v[96:99], v[52:55]
  ds_read_b128 v[204:207], v4 offset:9216
  v_mfma_f32_16x16x32_bf16 v[60:63], v[216:219], v[100:103], v[60:63]
  buffer_load_dwordx4 a[120:123], v4, s[12:15], s47 offen offset:3072 sc1
  v_mul_f32 v168, s51, v168
  v_mfma_f32_16x16x32_bf16 v[64:67], v[220:223], v[96:99], v[64:67]
  ds_read_b128 v[208:211], v4 offset:29696
  v_mfma_f32_16x16x32_bf16 v[72:75], v[220:223], v[100:103], v[72:75]
  v_mul_f32 v18, s54, v18
  s_waitcnt lgkmcnt(9)
  v_mfma_f32_16x16x32_bf16 v[68:71], v[224:227], v[96:99], v[68:71]
  ds_read_b128 v[212:215], v4 offset:50176
  v_mfma_f32_16x16x32_bf16 v[76:79], v[224:227], v[100:103], v[76:79]
  v_mul_f32 v19, s54, v19
  v_mfma_f32_16x16x32_bf16 v[80:83], v[228:231], v[96:99], v[80:83]
  ds_read_b128 v[216:219], v6 offset:5120
  v_mfma_f32_16x16x32_bf16 v[84:87], v[228:231], v[100:103], v[84:87]
  v_fma_f32 v19, -v18, v18, v19
  s_waitcnt vmcnt(13)
  s_waitcnt lgkmcnt(9)
  v_mfma_f32_16x16x32_bf16 v[32:35], v[176:179], a[64:67], v[32:35]
  ds_read_b128 v[220:223], v6 offset:25600
  v_mfma_f32_16x16x32_bf16 v[40:43], v[176:179], a[68:71], v[40:43]
  buffer_load_dwordx4 a[124:127], v4, s[12:15], s48 offen offset:3072 sc1
  v_max_f32 v19, 0, v19
  v_mfma_f32_16x16x32_bf16 v[36:39], v[180:183], a[64:67], v[36:39]
  ds_read_b128 v[224:227], v6 offset:46080
  v_mfma_f32_16x16x32_bf16 v[44:47], v[180:183], a[68:71], v[44:47]
  s_add_u32 s47, s47, 4096
  s_add_u32 s48, s48, 4096
  buffer_load_dwordx4 a[128:131], v4, s[12:15], s47 offen offset:0 sc1
  v_add_f32 v19, s55, v19
  s_waitcnt lgkmcnt(9)
  v_mfma_f32_16x16x32_bf16 v[48:51], v[184:187], a[64:67], v[48:51]
  ds_read_b128 v[228:231], v7 offset:1024
  v_mfma_f32_16x16x32_bf16 v[56:59], v[184:187], a[68:71], v[56:59]
  v_rsq_f32 v19, v19
  v_mfma_f32_16x16x32_bf16 v[52:55], v[188:191], a[64:67], v[52:55]
  ds_read_b128 v[176:179], v4 offset:10240
  v_mfma_f32_16x16x32_bf16 v[60:63], v[188:191], a[68:71], v[60:63]
  buffer_load_dwordx4 a[132:135], v4, s[12:15], s48 offen offset:0 sc1
  v_mul_f32 v170, v19, v19
  s_waitcnt lgkmcnt(9)
  v_mfma_f32_16x16x32_bf16 v[64:67], v[192:195], a[64:67], v[64:67]
  ds_read_b128 v[180:183], v4 offset:30720
  v_mfma_f32_16x16x32_bf16 v[72:75], v[192:195], a[68:71], v[72:75]
  v_mul_f32 v171, s50, v19
  v_mfma_f32_16x16x32_bf16 v[68:71], v[196:199], a[64:67], v[68:71]
  ds_read_b128 v[184:187], v4 offset:51200
  v_mfma_f32_16x16x32_bf16 v[76:79], v[196:199], a[68:71], v[76:79]
  v_mul_f32 v170, v170, v19
  s_waitcnt lgkmcnt(9)
  v_mfma_f32_16x16x32_bf16 v[80:83], v[200:203], a[64:67], v[80:83]
  ds_read_b128 v[188:191], v6 offset:6144
  v_mfma_f32_16x16x32_bf16 v[84:87], v[200:203], a[68:71], v[84:87]
  v_rcp_f32 v173, v19
  s_waitcnt vmcnt(14)
  v_mfma_f32_16x16x32_bf16 v[32:35], v[204:207], a[72:75], v[32:35]
  ds_read_b128 v[192:195], v6 offset:26624
  v_mfma_f32_16x16x32_bf16 v[40:43], v[204:207], a[76:79], v[40:43]
  buffer_load_dwordx4 v[112:115], v4, s[12:15], s47 offen offset:1024 sc1
  v_mul_f32 v170, s51, v170
  s_waitcnt lgkmcnt(9)
  v_mfma_f32_16x16x32_bf16 v[36:39], v[208:211], a[72:75], v[36:39]
  ds_read_b128 v[196:199], v6 offset:47104
  v_mfma_f32_16x16x32_bf16 v[44:47], v[208:211], a[76:79], v[44:47]
  buffer_load_dwordx4 v[116:119], v4, s[12:15], s48 offen offset:1024 sc1
  v_mfma_f32_16x16x32_bf16 v[48:51], v[212:215], a[72:75], v[48:51]
  ds_read_b128 v[200:203], v7 offset:2048
  v_mfma_f32_16x16x32_bf16 v[56:59], v[212:215], a[76:79], v[56:59]
  s_waitcnt lgkmcnt(9)
  v_mfma_f32_16x16x32_bf16 v[52:55], v[216:219], a[72:75], v[52:55]
  ds_read_b128 v[204:207], v4 offset:11264
  v_mfma_f32_16x16x32_bf16 v[60:63], v[216:219], a[76:79], v[60:63]
  buffer_load_dwordx4 a[144:147], v4, s[12:15], s47 offen offset:2048 sc1
  v_mfma_f32_16x16x32_bf16 v[64:67], v[220:223], a[72:75], v[64:67]
  ds_read_b128 v[208:211], v4 offset:31744
  v_mfma_f32_16x16x32_bf16 v[72:75], v[220:223], a[76:79], v[72:75]
  s_waitcnt lgkmcnt(9)
  v_mfma_f32_16x16x32_bf16 v[68:71], v[224:227], a[72:75], v[68:71]
  ds_read_b128 v[212:215], v4 offset:52224
  v_mfma_f32_16x16x32_bf16 v[76:79], v[224:227], a[76:79], v[76:79]
  v_mfma_f32_16x16x32_bf16 v[80:83], v[228:231], a[72:75], v[80:83]
  ds_read_b128 v[216:219], v6 offset:7168
  v_mfma_f32_16x16x32_bf16 v[84:87], v[228:231], a[76:79], v[84:87]
  s_waitcnt vmcnt(15)
  s_waitcnt lgkmcnt(9)
  v_mfma_f32_16x16x32_bf16 v[32:35], v[176:179], a[80:83], v[32:35]
  ds_read_b128 v[220:223], v6 offset:27648
  v_mfma_f32_16x16x32_bf16 v[40:43], v[176:179], a[84:87], v[40:43]
  buffer_load_dwordx4 a[148:151], v4, s[12:15], s48 offen offset:2048 sc1
  v_mfma_f32_16x16x32_bf16 v[36:39], v[180:183], a[80:83], v[36:39]
  ds_read_b128 v[224:227], v6 offset:48128
  v_mfma_f32_16x16x32_bf16 v[44:47], v[180:183], a[84:87], v[44:47]
  buffer_load_dwordx4 a[152:155], v4, s[12:15], s47 offen offset:3072 sc1
  s_waitcnt lgkmcnt(9)
  v_mfma_f32_16x16x32_bf16 v[48:51], v[184:187], a[80:83], v[48:51]
  ds_read_b128 v[228:231], v7 offset:3072
  v_mfma_f32_16x16x32_bf16 v[56:59], v[184:187], a[84:87], v[56:59]
  v_mfma_f32_16x16x32_bf16 v[52:55], v[188:191], a[80:83], v[52:55]
  ds_read_b128 v[176:179], v4 offset:12288
  v_mfma_f32_16x16x32_bf16 v[60:63], v[188:191], a[84:87], v[60:63]
  buffer_load_dwordx4 a[156:159], v4, s[12:15], s48 offen offset:3072 sc1
  s_waitcnt lgkmcnt(9)
  v_mfma_f32_16x16x32_bf16 v[64:67], v[192:195], a[80:83], v[64:67]
  ds_read_b128 v[180:183], v4 offset:32768
  v_mfma_f32_16x16x32_bf16 v[72:75], v[192:195], a[84:87], v[72:75]
  v_mfma_f32_16x16x32_bf16 v[68:71], v[196:199], a[80:83], v[68:71]
  ds_read_b128 v[184:187], v4 offset:53248
  v_mfma_f32_16x16x32_bf16 v[76:79], v[196:199], a[84:87], v[76:79]
  s_waitcnt lgkmcnt(9)
  v_mfma_f32_16x16x32_bf16 v[80:83], v[200:203], a[80:83], v[80:83]
  ds_read_b128 v[188:191], v6 offset:8192
  v_mfma_f32_16x16x32_bf16 v[84:87], v[200:203], a[84:87], v[84:87]
  s_waitcnt vmcnt(16)
  v_mfma_f32_16x16x32_bf16 v[32:35], v[204:207], a[88:91], v[32:35]
  ds_read_b128 v[192:195], v6 offset:28672
  v_mfma_f32_16x16x32_bf16 v[40:43], v[204:207], a[92:95], v[40:43]
  s_add_u32 s79, s72, 8192
  buffer_load_dwordx4 a[160:163], v4, s[12:15], s79 offen offset:0 sc1
  s_waitcnt lgkmcnt(9)
  v_mfma_f32_16x16x32_bf16 v[36:39], v[208:211], a[88:91], v[36:39]
  ds_read_b128 v[196:199], v6 offset:49152
  v_mfma_f32_16x16x32_bf16 v[44:47], v[208:211], a[92:95], v[44:47]
  s_add_u32 s79, s73, 8192
  buffer_load_dwordx4 a[164:167], v4, s[12:15], s79 offen offset:0 sc1
  v_mfma_f32_16x16x32_bf16 v[48:51], v[212:215], a[88:91], v[48:51]
  ds_read_b128 v[200:203], v7 offset:4096
  v_mfma_f32_16x16x32_bf16 v[56:59], v[212:215], a[92:95], v[56:59]
  s_waitcnt lgkmcnt(9)
  v_mfma_f32_16x16x32_bf16 v[52:55], v[216:219], a[88:91], v[52:55]
  ds_read_b128 v[204:207], v4 offset:13312
  v_mfma_f32_16x16x32_bf16 v[60:63], v[216:219], a[92:95], v[60:63]
  s_add_u32 s79, s74, 8192
  buffer_load_dwordx4 a[168:171], v4, s[12:15], s79 offen offset:0 sc1
  v_mfma_f32_16x16x32_bf16 v[64:67], v[220:223], a[88:91], v[64:67]
  ds_read_b128 v[208:211], v4 offset:33792
  v_mfma_f32_16x16x32_bf16 v[72:75], v[220:223], a[92:95], v[72:75]
  s_waitcnt lgkmcnt(9)
  v_mfma_f32_16x16x32_bf16 v[68:71], v[224:227], a[88:91], v[68:71]
  ds_read_b128 v[212:215], v4 offset:54272
  v_mfma_f32_16x16x32_bf16 v[76:79], v[224:227], a[92:95], v[76:79]
  v_mfma_f32_16x16x32_bf16 v[80:83], v[228:231], a[88:91], v[80:83]
  ds_read_b128 v[216:219], v6 offset:9216
  v_mfma_f32_16x16x32_bf16 v[84:87], v[228:231], a[92:95], v[84:87]
  s_waitcnt vmcnt(17)
  v_swap_b32 v106, v108
  v_swap_b32 v107, v109
  s_waitcnt lgkmcnt(9)
  s_nop 0
  v_mfma_f32_16x16x32_bf16 v[32:35], v[176:179], v[104:107], v[32:35]
  ds_read_b128 v[220:223], v6 offset:29696
  v_mfma_f32_16x16x32_bf16 v[40:43], v[176:179], v[108:111], v[40:43]
  s_add_u32 s79, s75, 8192
  buffer_load_dwordx4 a[172:175], v4, s[12:15], s79 offen offset:0 sc1
  v_mfma_f32_16x16x32_bf16 v[36:39], v[180:183], v[104:107], v[36:39]
  ds_read_b128 v[224:227], v6 offset:50176
  v_mfma_f32_16x16x32_bf16 v[44:47], v[180:183], v[108:111], v[44:47]
  s_add_u32 s79, s76, 8192
  buffer_load_dwordx4 a[176:179], v4, s[12:15], s79 offen offset:0 sc1
  s_waitcnt lgkmcnt(9)
  v_mfma_f32_16x16x32_bf16 v[48:51], v[184:187], v[104:107], v[48:51]
  ds_read_b128 v[228:231], v7 offset:5120
  v_mfma_f32_16x16x32_bf16 v[56:59], v[184:187], v[108:111], v[56:59]
  v_mfma_f32_16x16x32_bf16 v[52:55], v[188:191], v[104:107], v[52:55]
  ds_read_b128 v[176:179], v4 offset:14336
  v_mfma_f32_16x16x32_bf16 v[60:63], v[188:191], v[108:111], v[60:63]
  s_add_u32 s79, s72, 8192
  buffer_load_dwordx4 a[180:183], v4, s[12:15], s79 offen offset:1024 sc1
  s_waitcnt lgkmcnt(9)
  v_mfma_f32_16x16x32_bf16 v[64:67], v[192:195], v[104:107], v[64:67]
  ds_read_b128 v[180:183], v4 offset:34816
  v_mfma_f32_16x16x32_bf16 v[72:75], v[192:195], v[108:111], v[72:75]
  v_mfma_f32_16x16x32_bf16 v[68:71], v[196:199], v[104:107], v[68:71]
  ds_read_b128 v[184:187], v4 offset:55296
  v_mfma_f32_16x16x32_bf16 v[76:79], v[196:199], v[108:111], v[76:79]
  s_waitcnt lgkmcnt(9)
  v_mfma_f32_16x16x32_bf16 v[80:83], v[200:203], v[104:107], v[80:83]
  ds_read_b128 v[188:191], v6 offset:10240
  v_mfma_f32_16x16x32_bf16 v[84:87], v[200:203], v[108:111], v[84:87]
  s_waitcnt vmcnt(18)
  v_mfma_f32_16x16x32_bf16 v[32:35], v[204:207], a[104:107], v[32:35]
  ds_read_b128 v[192:195], v6 offset:30720
  v_mfma_f32_16x16x32_bf16 v[40:43], v[204:207], a[108:111], v[40:43]
  s_add_u32 s79, s73, 8192
  buffer_load_dwordx4 a[184:187], v4, s[12:15], s79 offen offset:1024 sc1
  s_waitcnt lgkmcnt(9)
  v_mfma_f32_16x16x32_bf16 v[36:39], v[208:211], a[104:107], v[36:39]
  ds_read_b128 v[196:199], v6 offset:51200
  v_mfma_f32_16x16x32_bf16 v[44:47], v[208:211], a[108:111], v[44:47]
  s_add_u32 s79, s74, 8192
  buffer_load_dwordx4 a[188:191], v4, s[12:15], s79 offen offset:1024 sc1
  v_mfma_f32_16x16x32_bf16 v[48:51], v[212:215], a[104:107], v[48:51]
  ds_read_b128 v[200:203], v7 offset:6144
  v_mfma_f32_16x16x32_bf16 v[56:59], v[212:215], a[108:111], v[56:59]
  s_waitcnt lgkmcnt(9)
  v_mfma_f32_16x16x32_bf16 v[52:55], v[216:219], a[104:107], v[52:55]
  ds_read_b128 v[204:207], v4 offset:15360
  v_mfma_f32_16x16x32_bf16 v[60:63], v[216:219], a[108:111], v[60:63]
  s_add_u32 s79, s75, 8192
  buffer_load_dwordx4 a[192:195], v4, s[12:15], s79 offen offset:1024 sc1
  v_mfma_f32_16x16x32_bf16 v[64:67], v[220:223], a[104:107], v[64:67]
  ds_read_b128 v[208:211], v4 offset:35840
  v_mfma_f32_16x16x32_bf16 v[72:75], v[220:223], a[108:111], v[72:75]
  s_waitcnt lgkmcnt(9)
  v_mfma_f32_16x16x32_bf16 v[68:71], v[224:227], a[104:107], v[68:71]
  ds_read_b128 v[212:215], v4 offset:56320
  v_mfma_f32_16x16x32_bf16 v[76:79], v[224:227], a[108:111], v[76:79]
  v_mfma_f32_16x16x32_bf16 v[80:83], v[228:231], a[104:107], v[80:83]
  ds_read_b128 v[216:219], v6 offset:11264
  v_mfma_f32_16x16x32_bf16 v[84:87], v[228:231], a[108:111], v[84:87]
  s_waitcnt vmcnt(19)
  s_waitcnt lgkmcnt(9)
  v_mfma_f32_16x16x32_bf16 v[32:35], v[176:179], a[112:115], v[32:35]
  ds_read_b128 v[220:223], v6 offset:31744
  v_mfma_f32_16x16x32_bf16 v[40:43], v[176:179], a[116:119], v[40:43]
  s_add_u32 s79, s76, 8192
  buffer_load_dwordx4 a[196:199], v4, s[12:15], s79 offen offset:1024 sc1
  v_mfma_f32_16x16x32_bf16 v[36:39], v[180:183], a[112:115], v[36:39]
  ds_read_b128 v[224:227], v6 offset:52224
  v_mfma_f32_16x16x32_bf16 v[44:47], v[180:183], a[116:119], v[44:47]
  s_add_u32 s79, s72, 8192
  buffer_load_dwordx4 a[200:203], v4, s[12:15], s79 offen offset:2048 sc1
  s_waitcnt lgkmcnt(9)
  v_mfma_f32_16x16x32_bf16 v[48:51], v[184:187], a[112:115], v[48:51]
  ds_read_b128 v[228:231], v7 offset:7168
  v_mfma_f32_16x16x32_bf16 v[56:59], v[184:187], a[116:119], v[56:59]
  v_mfma_f32_16x16x32_bf16 v[52:55], v[188:191], a[112:115], v[52:55]
  ds_read_b128 v[176:179], v4 offset:16384
  v_mfma_f32_16x16x32_bf16 v[60:63], v[188:191], a[116:119], v[60:63]
  s_add_u32 s79, s73, 8192
  buffer_load_dwordx4 a[204:207], v4, s[12:15], s79 offen offset:2048 sc1
  s_waitcnt lgkmcnt(9)
  v_mfma_f32_16x16x32_bf16 v[64:67], v[192:195], a[112:115], v[64:67]
  ds_read_b128 v[180:183], v4 offset:36864
  v_mfma_f32_16x16x32_bf16 v[72:75], v[192:195], a[116:119], v[72:75]
  v_mfma_f32_16x16x32_bf16 v[68:71], v[196:199], a[112:115], v[68:71]
  ds_read_b128 v[184:187], v4 offset:57344
  v_mfma_f32_16x16x32_bf16 v[76:79], v[196:199], a[116:119], v[76:79]
  s_waitcnt lgkmcnt(9)
  v_mfma_f32_16x16x32_bf16 v[80:83], v[200:203], a[112:115], v[80:83]
  ds_read_b128 v[188:191], v6 offset:12288
  v_mfma_f32_16x16x32_bf16 v[84:87], v[200:203], a[116:119], v[84:87]
  s_waitcnt vmcnt(20)
  v_mfma_f32_16x16x32_bf16 v[32:35], v[204:207], a[120:123], v[32:35]
  ds_read_b128 v[192:195], v6 offset:32768
  v_mfma_f32_16x16x32_bf16 v[40:43], v[204:207], a[124:127], v[40:43]
  s_add_u32 s79, s74, 8192
  buffer_load_dwordx4 a[208:211], v4, s[12:15], s79 offen offset:2048 sc1
  s_waitcnt lgkmcnt(9)
  v_mfma_f32_16x16x32_bf16 v[36:39], v[208:211], a[120:123], v[36:39]
  ds_read_b128 v[196:199], v6 offset:53248
  v_mfma_f32_16x16x32_bf16 v[44:47], v[208:211], a[124:127], v[44:47]
  s_add_u32 s79, s75, 8192
  buffer_load_dwordx4 a[212:215], v4, s[12:15], s79 offen offset:2048 sc1
  v_mfma_f32_16x16x32_bf16 v[48:51], v[212:215], a[120:123], v[48:51]
  ds_read_b128 v[200:203], v7 offset:8192
  v_mfma_f32_16x16x32_bf16 v[56:59], v[212:215], a[124:127], v[56:59]
  s_waitcnt lgkmcnt(9)
  v_mfma_f32_16x16x32_bf16 v[52:55], v[216:219], a[120:123], v[52:55]
  ds_read_b128 v[204:207], v4 offset:17408
  v_mfma_f32_16x16x32_bf16 v[60:63], v[216:219], a[124:127], v[60:63]
  s_add_u32 s79, s76, 8192
  buffer_load_dwordx4 a[216:219], v4, s[12:15], s79 offen offset:2048 sc1
  v_mfma_f32_16x16x32_bf16 v[64:67], v[220:223], a[120:123], v[64:67]
  ds_read_b128 v[208:211], v4 offset:37888
  v_mfma_f32_16x16x32_bf16 v[72:75], v[220:223], a[124:127], v[72:75]
  s_waitcnt lgkmcnt(9)
  v_mfma_f32_16x16x32_bf16 v[68:71], v[224:227], a[120:123], v[68:71]
  ds_read_b128 v[212:215], v4 offset:58368
  v_mfma_f32_16x16x32_bf16 v[76:79], v[224:227], a[124:127], v[76:79]
  v_mfma_f32_16x16x32_bf16 v[80:83], v[228:231], a[120:123], v[80:83]
  ds_read_b128 v[216:219], v6 offset:13312
  v_mfma_f32_16x16x32_bf16 v[84:87], v[228:231], a[124:127], v[84:87]
  s_waitcnt vmcnt(21)
  s_waitcnt lgkmcnt(9)
  v_mfma_f32_16x16x32_bf16 v[32:35], v[176:179], a[128:131], v[32:35]
  ds_read_b128 v[220:223], v6 offset:33792
  v_mfma_f32_16x16x32_bf16 v[40:43], v[176:179], a[132:135], v[40:43]
  s_add_u32 s79, s72, 8192
  buffer_load_dwordx4 a[220:223], v4, s[12:15], s79 offen offset:3072 sc1
  v_mfma_f32_16x16x32_bf16 v[36:39], v[180:183], a[128:131], v[36:39]
  ds_read_b128 v[224:227], v6 offset:54272
  v_mfma_f32_16x16x32_bf16 v[44:47], v[180:183], a[132:135], v[44:47]
  s_add_u32 s79, s73, 8192
  buffer_load_dwordx4 a[224:227], v4, s[12:15], s79 offen offset:3072 sc1
  s_waitcnt lgkmcnt(9)
  v_mfma_f32_16x16x32_bf16 v[48:51], v[184:187], a[128:131], v[48:51]
  ds_read_b128 v[228:231], v7 offset:9216
  v_mfma_f32_16x16x32_bf16 v[56:59], v[184:187], a[132:135], v[56:59]
  s_add_u32 s79, s74, 8192
  buffer_load_dwordx4 a[228:231], v4, s[12:15], s79 offen offset:3072 sc1
  v_mfma_f32_16x16x32_bf16 v[52:55], v[188:191], a[128:131], v[52:55]
  ds_read_b128 v[176:179], v4 offset:18432
  v_mfma_f32_16x16x32_bf16 v[60:63], v[188:191], a[132:135], v[60:63]
  s_add_u32 s79, s75, 8192
  buffer_load_dwordx4 a[232:235], v4, s[12:15], s79 offen offset:3072 sc1
  s_waitcnt lgkmcnt(9)
  v_mfma_f32_16x16x32_bf16 v[64:67], v[192:195], a[128:131], v[64:67]
  ds_read_b128 v[180:183], v4 offset:38912
  v_mfma_f32_16x16x32_bf16 v[72:75], v[192:195], a[132:135], v[72:75]
  v_mfma_f32_16x16x32_bf16 v[68:71], v[196:199], a[128:131], v[68:71]
  ds_read_b128 v[184:187], v4 offset:59392
  v_mfma_f32_16x16x32_bf16 v[76:79], v[196:199], a[132:135], v[76:79]
  s_waitcnt lgkmcnt(9)
  v_mfma_f32_16x16x32_bf16 v[80:83], v[200:203], a[128:131], v[80:83]
  ds_read_b128 v[188:191], v6 offset:14336
  v_mfma_f32_16x16x32_bf16 v[84:87], v[200:203], a[132:135], v[84:87]
  s_waitcnt vmcnt(23)
  v_swap_b32 v114, v116
  v_swap_b32 v115, v117
  s_nop 1
  v_mfma_f32_16x16x32_bf16 v[32:35], v[204:207], v[112:115], v[32:35]
  ds_read_b128 v[192:195], v6 offset:34816
  v_mfma_f32_16x16x32_bf16 v[40:43], v[204:207], v[116:119], v[40:43]
  s_add_u32 s79, s76, 8192
  buffer_load_dwordx4 a[236:239], v4, s[12:15], s79 offen offset:3072 sc1
  s_waitcnt lgkmcnt(9)
  v_mfma_f32_16x16x32_bf16 v[36:39], v[208:211], v[112:115], v[36:39]
  ds_read_b128 v[196:199], v6 offset:55296
  v_mfma_f32_16x16x32_bf16 v[44:47], v[208:211], v[116:119], v[44:47]
  s_add_u32 s79, s72, 12288
  s_add_u32 s79, s79, s77
  buffer_load_dwordx4 a[240:243], v4, s[12:15], s79 offen offset:0 sc1
  v_mfma_f32_16x16x32_bf16 v[48:51], v[212:215], v[112:115], v[48:51]
  ds_read_b128 v[200:203], v7 offset:10240
  v_mfma_f32_16x16x32_bf16 v[56:59], v[212:215], v[116:119], v[56:59]
  s_add_u32 s79, s73, 12288
  s_add_u32 s79, s79, s77
  buffer_load_dwordx4 a[244:247], v4, s[12:15], s79 offen offset:0 sc1
  s_waitcnt lgkmcnt(9)
  v_mfma_f32_16x16x32_bf16 v[52:55], v[216:219], v[112:115], v[52:55]
  ds_read_b128 v[204:207], v4 offset:19456
  v_mfma_f32_16x16x32_bf16 v[60:63], v[216:219], v[116:119], v[60:63]
  s_add_u32 s79, s74, 12288
  s_add_u32 s79, s79, s77
  buffer_load_dwordx4 a[248:251], v4, s[12:15], s79 offen offset:0 sc1
  v_mfma_f32_16x16x32_bf16 v[64:67], v[220:223], v[112:115], v[64:67]
  ds_read_b128 v[208:211], v4 offset:39936
  v_mfma_f32_16x16x32_bf16 v[72:75], v[220:223], v[116:119], v[72:75]
  s_waitcnt lgkmcnt(9)
  v_mfma_f32_16x16x32_bf16 v[68:71], v[224:227], v[112:115], v[68:71]
  ds_read_b128 v[212:215], v4 offset:60416
  v_mfma_f32_16x16x32_bf16 v[76:79], v[224:227], v[116:119], v[76:79]
  v_mfma_f32_16x16x32_bf16 v[80:83], v[228:231], v[112:115], v[80:83]
  ds_read_b128 v[216:219], v6 offset:15360
  v_mfma_f32_16x16x32_bf16 v[84:87], v[228:231], v[116:119], v[84:87]
  s_waitcnt vmcnt(25)
  s_waitcnt lgkmcnt(9)
  v_mfma_f32_16x16x32_bf16 v[32:35], v[176:179], a[144:147], v[32:35]
  ds_read_b128 v[220:223], v6 offset:35840
  v_mfma_f32_16x16x32_bf16 v[40:43], v[176:179], a[148:151], v[40:43]
  s_add_u32 s79, s75, 12288
  s_add_u32 s79, s79, s77
  buffer_load_dwordx4 a[252:255], v4, s[12:15], s79 offen offset:0 sc1
  v_mfma_f32_16x16x32_bf16 v[36:39], v[180:183], a[144:147], v[36:39]
  ds_read_b128 v[224:227], v6 offset:56320
  v_mfma_f32_16x16x32_bf16 v[44:47], v[180:183], a[148:151], v[44:47]
  s_add_u32 s79, s76, 12288
  s_add_u32 s79, s79, s77
  buffer_load_dwordx4 v[232:235], v4, s[12:15], s79 offen offset:0 sc1
  s_waitcnt lgkmcnt(9)
  v_mfma_f32_16x16x32_bf16 v[48:51], v[184:187], a[144:147], v[48:51]
  ds_read_b128 v[228:231], v7 offset:11264
  v_mfma_f32_16x16x32_bf16 v[56:59], v[184:187], a[148:151], v[56:59]
  s_add_u32 s79, s72, 12288
  s_add_u32 s79, s79, s77
  buffer_load_dwordx4 v[236:239], v4, s[12:15], s79 offen offset:1024 sc1
  v_mfma_f32_16x16x32_bf16 v[52:55], v[188:191], a[144:147], v[52:55]
  v_mfma_f32_16x16x32_bf16 v[60:63], v[188:191], a[148:151], v[60:63]
  s_add_u32 s79, s73, 12288
  s_add_u32 s79, s79, s77
  buffer_load_dwordx4 v[240:243], v4, s[12:15], s79 offen offset:1024 sc1
  s_waitcnt lgkmcnt(8)
  v_mfma_f32_16x16x32_bf16 v[64:67], v[192:195], a[144:147], v[64:67]
  v_mfma_f32_16x16x32_bf16 v[72:75], v[192:195], a[148:151], v[72:75]
  v_mfma_f32_16x16x32_bf16 v[68:71], v[196:199], a[144:147], v[68:71]
  v_mfma_f32_16x16x32_bf16 v[76:79], v[196:199], a[148:151], v[76:79]
  s_waitcnt lgkmcnt(6)
  v_mfma_f32_16x16x32_bf16 v[80:83], v[200:203], a[144:147], v[80:83]
  v_mfma_f32_16x16x32_bf16 v[84:87], v[200:203], a[148:151], v[84:87]
  s_waitcnt vmcnt(27)
  v_mfma_f32_16x16x32_bf16 v[32:35], v[204:207], a[152:155], v[32:35]
  v_mfma_f32_16x16x32_bf16 v[40:43], v[204:207], a[156:159], v[40:43]
  s_add_u32 s79, s74, 12288
  s_add_u32 s79, s79, s77
  buffer_load_dwordx4 v[244:247], v4, s[12:15], s79 offen offset:1024 sc1
  s_waitcnt lgkmcnt(4)
  v_mfma_f32_16x16x32_bf16 v[36:39], v[208:211], a[152:155], v[36:39]
  v_mfma_f32_16x16x32_bf16 v[44:47], v[208:211], a[156:159], v[44:47]
  s_add_u32 s79, s75, 12288
  s_add_u32 s79, s79, s77
  buffer_load_dwordx4 v[248:251], v4, s[12:15], s79 offen offset:1024 sc1
  v_mfma_f32_16x16x32_bf16 v[48:51], v[212:215], a[152:155], v[48:51]
  v_mfma_f32_16x16x32_bf16 v[56:59], v[212:215], a[156:159], v[56:59]
  s_add_u32 s79, s76, 12288
  s_add_u32 s79, s79, s77
  buffer_load_dwordx4 v[252:255], v4, s[12:15], s79 offen offset:1024 sc1
  s_waitcnt lgkmcnt(2)
  v_mfma_f32_16x16x32_bf16 v[52:55], v[216:219], a[152:155], v[52:55]
  v_mfma_f32_16x16x32_bf16 v[60:63], v[216:219], a[156:159], v[60:63]
  v_mfma_f32_16x16x32_bf16 v[64:67], v[220:223], a[152:155], v[64:67]
  v_mfma_f32_16x16x32_bf16 v[72:75], v[220:223], a[156:159], v[72:75]
  s_waitcnt lgkmcnt(0)
  v_mfma_f32_16x16x32_bf16 v[68:71], v[224:227], a[152:155], v[68:71]
  v_mfma_f32_16x16x32_bf16 v[76:79], v[224:227], a[156:159], v[76:79]
  v_mfma_f32_16x16x32_bf16 v[80:83], v[228:231], a[152:155], v[80:83]
  v_mfma_f32_16x16x32_bf16 v[84:87], v[228:231], a[156:159], v[84:87]
  s_branch sequential_preLN__ssm_conv_h3__mixer_s_mlp__prompt_kernel_gdone
sequential_preLN__ssm_conv_h3__mixer_s_mlp__prompt_kernel_g5:
  s_waitcnt lgkmcnt(0)
  ds_read_b128 v[176:179], v4 offset:0
  ds_read_b128 v[180:183], v4 offset:20480
  ds_read_b128 v[184:187], v4 offset:40960
  ds_read_b128 v[188:191], v4 offset:61440
  ds_read_b128 v[192:195], v6 offset:57344
  ds_read_b128 v[196:199], v4 offset:1024
  ds_read_b128 v[200:203], v4 offset:21504
  ds_read_b128 v[204:207], v4 offset:41984
  ds_read_b128 v[208:211], v4 offset:62464
  ds_read_b128 v[212:215], v6 offset:58368
  ds_read_b128 v[216:219], v4 offset:2048
  s_waitcnt vmcnt(12)
  s_waitcnt lgkmcnt(9)
  v_mfma_f32_16x16x32_bf16 v[32:35], v[176:179], a[0:3], 0
  ds_read_b128 v[220:223], v4 offset:22528
  v_mfma_f32_16x16x32_bf16 v[40:43], v[176:179], a[4:7], 0
  buffer_load_dwordx4 a[40:43], v4, s[12:15], s47 offen offset:1024 sc1
  v_mfma_f32_16x16x32_bf16 v[36:39], v[180:183], a[0:3], 0
  ds_read_b128 v[224:227], v4 offset:43008
  v_mfma_f32_16x16x32_bf16 v[44:47], v[180:183], a[4:7], 0
  s_waitcnt lgkmcnt(9)
  v_mfma_f32_16x16x32_bf16 v[48:51], v[184:187], a[0:3], 0
  ds_read_b128 v[228:231], v4 offset:63488
  v_mfma_f32_16x16x32_bf16 v[56:59], v[184:187], a[4:7], 0
  v_mfma_f32_16x16x32_bf16 v[52:55], v[188:191], a[0:3], 0
  ds_read_b128 v[176:179], v6 offset:59392
  v_mfma_f32_16x16x32_bf16 v[60:63], v[188:191], a[4:7], 0
  buffer_load_dwordx4 a[44:47], v4, s[12:15], s48 offen offset:1024 sc1
  s_waitcnt lgkmcnt(9)
  v_mfma_f32_16x16x32_bf16 v[80:83], v[192:195], a[0:3], 0
  ds_read_b128 v[180:183], v4 offset:3072
  v_mfma_f32_16x16x32_bf16 v[84:87], v[192:195], a[4:7], 0
  s_waitcnt vmcnt(12)
  v_mfma_f32_16x16x32_bf16 v[32:35], v[196:199], a[8:11], v[32:35]
  ds_read_b128 v[184:187], v4 offset:23552
  v_mfma_f32_16x16x32_bf16 v[40:43], v[196:199], a[12:15], v[40:43]
  buffer_load_dwordx4 a[48:51], v4, s[12:15], s47 offen offset:2048 sc1
  s_waitcnt lgkmcnt(9)
  v_mfma_f32_16x16x32_bf16 v[36:39], v[200:203], a[8:11], v[36:39]
  ds_read_b128 v[188:191], v4 offset:44032
  v_mfma_f32_16x16x32_bf16 v[44:47], v[200:203], a[12:15], v[44:47]
  v_mfma_f32_16x16x32_bf16 v[48:51], v[204:207], a[8:11], v[48:51]
  ds_read_b128 v[192:195], v4 offset:64512
  v_mfma_f32_16x16x32_bf16 v[56:59], v[204:207], a[12:15], v[56:59]
  s_waitcnt lgkmcnt(9)
  v_mfma_f32_16x16x32_bf16 v[52:55], v[208:211], a[8:11], v[52:55]
  ds_read_b128 v[196:199], v6 offset:60416
  v_mfma_f32_16x16x32_bf16 v[60:63], v[208:211], a[12:15], v[60:63]
  buffer_load_dwordx4 a[52:55], v4, s[12:15], s48 offen offset:2048 sc1
  v_mfma_f32_16x16x32_bf16 v[80:83], v[212:215], a[8:11], v[80:83]
  ds_read_b128 v[200:203], v4 offset:4096
  v_mfma_f32_16x16x32_bf16 v[84:87], v[212:215], a[12:15], v[84:87]
  s_waitcnt vmcnt(8)
  v_swap_b32 v90, v92
  v_swap_b32 v91, v93
  s_waitcnt lgkmcnt(9)
  s_nop 0
  v_mfma_f32_16x16x32_bf16 v[32:35], v[216:219], v[88:91], v[32:35]
  ds_read_b128 v[204:207], v4 offset:24576
  v_mfma_f32_16x16x32_bf16 v[40:43], v[216:219], v[92:95], v[40:43]
  buffer_load_dwordx4 v[96:99], v4, s[12:15], s47 offen offset:3072 sc1
  v_add_f32 v16, v8, v10
  v_mfma_f32_16x16x32_bf16 v[36:39], v[220:223], v[88:91], v[36:39]
  ds_read_b128 v[208:211], v4 offset:45056
  v_mfma_f32_16x16x32_bf16 v[44:47], v[220:223], v[92:95], v[44:47]
  v_add_f32 v17, v9, v11
  s_waitcnt lgkmcnt(9)
  v_mfma_f32_16x16x32_bf16 v[48:51], v[224:227], v[88:91], v[48:51]
  ds_read_b128 v[212:215], v6 offset:0
  v_mfma_f32_16x16x32_bf16 v[56:59], v[224:227], v[92:95], v[56:59]
  v_add_f32 v18, v12, v14
  v_mfma_f32_16x16x32_bf16 v[52:55], v[228:231], v[88:91], v[52:55]
  ds_read_b128 v[216:219], v6 offset:61440
  v_mfma_f32_16x16x32_bf16 v[60:63], v[228:231], v[92:95], v[60:63]
  buffer_load_dwordx4 v[100:103], v4, s[12:15], s48 offen offset:3072 sc1
  v_add_f32 v19, v13, v15
  s_waitcnt lgkmcnt(9)
  v_mfma_f32_16x16x32_bf16 v[80:83], v[176:179], v[88:91], v[80:83]
  ds_read_b128 v[220:223], v4 offset:5120
  v_mfma_f32_16x16x32_bf16 v[84:87], v[176:179], v[92:95], v[84:87]
  v_mov_b32 v8, v16
  s_waitcnt vmcnt(8)
  v_mfma_f32_16x16x32_bf16 v[32:35], v[180:183], a[24:27], v[32:35]
  ds_read_b128 v[224:227], v4 offset:25600
  v_mfma_f32_16x16x32_bf16 v[40:43], v[180:183], a[28:31], v[40:43]
  s_add_u32 s47, s47, 4096
  s_add_u32 s48, s48, 4096
  buffer_load_dwordx4 a[64:67], v4, s[12:15], s47 offen offset:0 sc1
  v_permlane32_swap_b32 v16, v8
  s_waitcnt lgkmcnt(9)
  v_mfma_f32_16x16x32_bf16 v[36:39], v[184:187], a[24:27], v[36:39]
  ds_read_b128 v[228:231], v4 offset:46080
  v_mfma_f32_16x16x32_bf16 v[44:47], v[184:187], a[28:31], v[44:47]
  buffer_load_dwordx4 a[68:71], v4, s[12:15], s48 offen offset:0 sc1
  v_add_f32 v16, v16, v8
  v_mfma_f32_16x16x32_bf16 v[48:51], v[188:191], a[24:27], v[48:51]
  ds_read_b128 v[176:179], v6 offset:1024
  v_mfma_f32_16x16x32_bf16 v[56:59], v[188:191], a[28:31], v[56:59]
  v_mov_b32 v8, v16
  s_waitcnt lgkmcnt(9)
  v_mfma_f32_16x16x32_bf16 v[52:55], v[192:195], a[24:27], v[52:55]
  ds_read_b128 v[180:183], v6 offset:62464
  v_mfma_f32_16x16x32_bf16 v[60:63], v[192:195], a[28:31], v[60:63]
  buffer_load_dwordx4 a[72:75], v4, s[12:15], s47 offen offset:1024 sc1
  v_permlane16_swap_b32 v16, v8
  v_mfma_f32_16x16x32_bf16 v[80:83], v[196:199], a[24:27], v[80:83]
  ds_read_b128 v[184:187], v4 offset:6144
  v_mfma_f32_16x16x32_bf16 v[84:87], v[196:199], a[28:31], v[84:87]
  v_add_f32 v16, v16, v8
  s_waitcnt vmcnt(9)
  s_waitcnt lgkmcnt(9)
  v_mfma_f32_16x16x32_bf16 v[32:35], v[200:203], a[32:35], v[32:35]
  ds_read_b128 v[188:191], v4 offset:26624
  v_mfma_f32_16x16x32_bf16 v[40:43], v[200:203], a[36:39], v[40:43]
  buffer_load_dwordx4 a[76:79], v4, s[12:15], s48 offen offset:1024 sc1
  v_mov_b32 v9, v17
  v_mfma_f32_16x16x32_bf16 v[36:39], v[204:207], a[32:35], v[36:39]
  ds_read_b128 v[192:195], v4 offset:47104
  v_mfma_f32_16x16x32_bf16 v[44:47], v[204:207], a[36:39], v[44:47]
  buffer_load_dwordx4 a[80:83], v4, s[12:15], s47 offen offset:2048 sc1
  v_permlane32_swap_b32 v17, v9
  s_waitcnt lgkmcnt(9)
  v_mfma_f32_16x16x32_bf16 v[48:51], v[208:211], a[32:35], v[48:51]
  ds_read_b128 v[196:199], v6 offset:2048
  v_mfma_f32_16x16x32_bf16 v[56:59], v[208:211], a[36:39], v[56:59]
  v_add_f32 v17, v17, v9
  v_mfma_f32_16x16x32_bf16 v[52:55], v[212:215], a[32:35], v[52:55]
  ds_read_b128 v[200:203], v6 offset:63488
  v_mfma_f32_16x16x32_bf16 v[60:63], v[212:215], a[36:39], v[60:63]
  buffer_load_dwordx4 a[84:87], v4, s[12:15], s48 offen offset:2048 sc1
  v_mov_b32 v9, v17
  s_waitcnt lgkmcnt(9)
  v_mfma_f32_16x16x32_bf16 v[80:83], v[216:219], a[32:35], v[80:83]
  ds_read_b128 v[204:207], v4 offset:7168
  v_mfma_f32_16x16x32_bf16 v[84:87], v[216:219], a[36:39], v[84:87]
  v_permlane16_swap_b32 v17, v9
  s_waitcnt vmcnt(10)
  v_mfma_f32_16x16x32_bf16 v[32:35], v[220:223], a[40:43], v[32:35]
  ds_read_b128 v[208:211], v4 offset:27648
  v_mfma_f32_16x16x32_bf16 v[40:43], v[220:223], a[44:47], v[40:43]
  buffer_load_dwordx4 a[88:91], v4, s[12:15], s47 offen offset:3072 sc1
  v_add_f32 v17, v17, v9
  s_waitcnt lgkmcnt(9)
  v_mfma_f32_16x16x32_bf16 v[36:39], v[224:227], a[40:43], v[36:39]
  ds_read_b128 v[212:215], v4 offset:48128
  v_mfma_f32_16x16x32_bf16 v[44:47], v[224:227], a[44:47], v[44:47]
  buffer_load_dwordx4 a[92:95], v4, s[12:15], s48 offen offset:3072 sc1
  v_mov_b32 v10, v18
  v_mfma_f32_16x16x32_bf16 v[48:51], v[228:231], a[40:43], v[48:51]
  ds_read_b128 v[216:219], v6 offset:3072
  v_mfma_f32_16x16x32_bf16 v[56:59], v[228:231], a[44:47], v[56:59]
  v_permlane32_swap_b32 v18, v10
  s_waitcnt lgkmcnt(9)
  v_mfma_f32_16x16x32_bf16 v[52:55], v[176:179], a[40:43], v[52:55]
  ds_read_b128 v[220:223], v6 offset:64512
  v_mfma_f32_16x16x32_bf16 v[60:63], v[176:179], a[44:47], v[60:63]
  s_add_u32 s47, s47, 4096
  s_add_u32 s48, s48, 4096
  buffer_load_dwordx4 v[104:107], v4, s[12:15], s47 offen offset:0 sc1
  v_add_f32 v18, v18, v10
  v_mfma_f32_16x16x32_bf16 v[80:83], v[180:183], a[40:43], v[80:83]
  ds_read_b128 v[224:227], v4 offset:8192
  v_mfma_f32_16x16x32_bf16 v[84:87], v[180:183], a[44:47], v[84:87]
  v_mov_b32 v10, v18
  s_waitcnt vmcnt(11)
  s_waitcnt lgkmcnt(9)
  v_mfma_f32_16x16x32_bf16 v[32:35], v[184:187], a[48:51], v[32:35]
  ds_read_b128 v[228:231], v4 offset:28672
  v_mfma_f32_16x16x32_bf16 v[40:43], v[184:187], a[52:55], v[40:43]
  buffer_load_dwordx4 v[108:111], v4, s[12:15], s48 offen offset:0 sc1
  v_permlane16_swap_b32 v18, v10
  v_mfma_f32_16x16x32_bf16 v[36:39], v[188:191], a[48:51], v[36:39]
  ds_read_b128 v[176:179], v4 offset:49152
  v_mfma_f32_16x16x32_bf16 v[44:47], v[188:191], a[52:55], v[44:47]
  buffer_load_dwordx4 a[104:107], v4, s[12:15], s47 offen offset:1024 sc1
  v_add_f32 v18, v18, v10
  s_waitcnt lgkmcnt(9)
  v_mfma_f32_16x16x32_bf16 v[48:51], v[192:195], a[48:51], v[48:51]
  ds_read_b128 v[180:183], v6 offset:4096
  v_mfma_f32_16x16x32_bf16 v[56:59], v[192:195], a[52:55], v[56:59]
  v_mov_b32 v11, v19
  v_mfma_f32_16x16x32_bf16 v[52:55], v[196:199], a[48:51], v[52:55]
  ds_read_b128 v[184:187], v7 offset:0
  v_mfma_f32_16x16x32_bf16 v[60:63], v[196:199], a[52:55], v[60:63]
  buffer_load_dwordx4 a[108:111], v4, s[12:15], s48 offen offset:1024 sc1
  v_permlane32_swap_b32 v19, v11
  s_waitcnt lgkmcnt(9)
  v_mfma_f32_16x16x32_bf16 v[80:83], v[200:203], a[48:51], v[80:83]
  ds_read_b128 v[188:191], v4 offset:9216
  v_mfma_f32_16x16x32_bf16 v[84:87], v[200:203], a[52:55], v[84:87]
  v_add_f32 v19, v19, v11
  s_waitcnt vmcnt(12)
  v_swap_b32 v98, v100
  v_swap_b32 v99, v101
  s_nop 1
  v_mfma_f32_16x16x32_bf16 v[32:35], v[204:207], v[96:99], v[32:35]
  ds_read_b128 v[192:195], v4 offset:29696
  v_mfma_f32_16x16x32_bf16 v[40:43], v[204:207], v[100:103], v[40:43]
  buffer_load_dwordx4 a[112:115], v4, s[12:15], s47 offen offset:2048 sc1
  v_mov_b32 v11, v19
  s_waitcnt lgkmcnt(9)
  v_mfma_f32_16x16x32_bf16 v[36:39], v[208:211], v[96:99], v[36:39]
  ds_read_b128 v[196:199], v4 offset:50176
  v_mfma_f32_16x16x32_bf16 v[44:47], v[208:211], v[100:103], v[44:47]
  buffer_load_dwordx4 a[116:119], v4, s[12:15], s48 offen offset:2048 sc1
  v_permlane16_swap_b32 v19, v11
  v_mfma_f32_16x16x32_bf16 v[48:51], v[212:215], v[96:99], v[48:51]
  ds_read_b128 v[200:203], v6 offset:5120
  v_mfma_f32_16x16x32_bf16 v[56:59], v[212:215], v[100:103], v[56:59]
  v_add_f32 v19, v19, v11
  s_waitcnt lgkmcnt(9)
  v_mfma_f32_16x16x32_bf16 v[52:55], v[216:219], v[96:99], v[52:55]
  ds_read_b128 v[204:207], v7 offset:1024
  v_mfma_f32_16x16x32_bf16 v[60:63], v[216:219], v[100:103], v[60:63]
  buffer_load_dwordx4 a[120:123], v4, s[12:15], s47 offen offset:3072 sc1
  v_mul_f32 v16, s54, v16
  v_mfma_f32_16x16x32_bf16 v[80:83], v[220:223], v[96:99], v[80:83]
  ds_read_b128 v[208:211], v4 offset:10240
  v_mfma_f32_16x16x32_bf16 v[84:87], v[220:223], v[100:103], v[84:87]
  v_mul_f32 v17, s54, v17
  s_waitcnt vmcnt(13)
  s_waitcnt lgkmcnt(9)
  v_mfma_f32_16x16x32_bf16 v[32:35], v[224:227], a[64:67], v[32:35]
  ds_read_b128 v[212:215], v4 offset:30720
  v_mfma_f32_16x16x32_bf16 v[40:43], v[224:227], a[68:71], v[40:43]
  buffer_load_dwordx4 a[124:127], v4, s[12:15], s48 offen offset:3072 sc1
  v_fma_f32 v17, -v16, v16, v17
  v_mfma_f32_16x16x32_bf16 v[36:39], v[228:231], a[64:67], v[36:39]
  ds_read_b128 v[216:219], v4 offset:51200
  v_mfma_f32_16x16x32_bf16 v[44:47], v[228:231], a[68:71], v[44:47]
  s_add_u32 s47, s47, 4096
  s_add_u32 s48, s48, 4096
  buffer_load_dwordx4 a[128:131], v4, s[12:15], s47 offen offset:0 sc1
  v_max_f32 v17, 0, v17
  s_waitcnt lgkmcnt(9)
  v_mfma_f32_16x16x32_bf16 v[48:51], v[176:179], a[64:67], v[48:51]
  ds_read_b128 v[220:223], v6 offset:6144
  v_mfma_f32_16x16x32_bf16 v[56:59], v[176:179], a[68:71], v[56:59]
  v_add_f32 v17, s55, v17
  v_mfma_f32_16x16x32_bf16 v[52:55], v[180:183], a[64:67], v[52:55]
  ds_read_b128 v[224:227], v7 offset:2048
  v_mfma_f32_16x16x32_bf16 v[60:63], v[180:183], a[68:71], v[60:63]
  buffer_load_dwordx4 a[132:135], v4, s[12:15], s48 offen offset:0 sc1
  v_rsq_f32 v17, v17
  s_waitcnt lgkmcnt(9)
  v_mfma_f32_16x16x32_bf16 v[80:83], v[184:187], a[64:67], v[80:83]
  ds_read_b128 v[228:231], v4 offset:11264
  v_mfma_f32_16x16x32_bf16 v[84:87], v[184:187], a[68:71], v[84:87]
  v_mul_f32 v168, v17, v17
  s_waitcnt vmcnt(14)
  v_mfma_f32_16x16x32_bf16 v[32:35], v[188:191], a[72:75], v[32:35]
  ds_read_b128 v[176:179], v4 offset:31744
  v_mfma_f32_16x16x32_bf16 v[40:43], v[188:191], a[76:79], v[40:43]
  buffer_load_dwordx4 v[112:115], v4, s[12:15], s47 offen offset:1024 sc1
  v_mul_f32 v169, s50, v17
  s_waitcnt lgkmcnt(9)
  v_mfma_f32_16x16x32_bf16 v[36:39], v[192:195], a[72:75], v[36:39]
  ds_read_b128 v[180:183], v4 offset:52224
  v_mfma_f32_16x16x32_bf16 v[44:47], v[192:195], a[76:79], v[44:47]
  buffer_load_dwordx4 v[116:119], v4, s[12:15], s48 offen offset:1024 sc1
  v_mul_f32 v168, v168, v17
  v_mfma_f32_16x16x32_bf16 v[48:51], v[196:199], a[72:75], v[48:51]
  ds_read_b128 v[184:187], v6 offset:7168
  v_mfma_f32_16x16x32_bf16 v[56:59], v[196:199], a[76:79], v[56:59]
  v_rcp_f32 v172, v17
  s_waitcnt lgkmcnt(9)
  v_mfma_f32_16x16x32_bf16 v[52:55], v[200:203], a[72:75], v[52:55]
  ds_read_b128 v[188:191], v7 offset:3072
  v_mfma_f32_16x16x32_bf16 v[60:63], v[200:203], a[76:79], v[60:63]
  buffer_load_dwordx4 a[144:147], v4, s[12:15], s47 offen offset:2048 sc1
  v_mul_f32 v168, s51, v168
  v_mfma_f32_16x16x32_bf16 v[80:83], v[204:207], a[72:75], v[80:83]
  ds_read_b128 v[192:195], v4 offset:12288
  v_mfma_f32_16x16x32_bf16 v[84:87], v[204:207], a[76:79], v[84:87]
  v_mul_f32 v18, s54, v18
  s_waitcnt vmcnt(15)
  s_waitcnt lgkmcnt(9)
  v_mfma_f32_16x16x32_bf16 v[32:35], v[208:211], a[80:83], v[32:35]
  ds_read_b128 v[196:199], v4 offset:32768
  v_mfma_f32_16x16x32_bf16 v[40:43], v[208:211], a[84:87], v[40:43]
  buffer_load_dwordx4 a[148:151], v4, s[12:15], s48 offen offset:2048 sc1
  v_mul_f32 v19, s54, v19
  v_mfma_f32_16x16x32_bf16 v[36:39], v[212:215], a[80:83], v[36:39]
  ds_read_b128 v[200:203], v4 offset:53248
  v_mfma_f32_16x16x32_bf16 v[44:47], v[212:215], a[84:87], v[44:47]
  buffer_load_dwordx4 a[152:155], v4, s[12:15], s47 offen offset:3072 sc1
  v_fma_f32 v19, -v18, v18, v19
  s_waitcnt lgkmcnt(9)
  v_mfma_f32_16x16x32_bf16 v[48:51], v[216:219], a[80:83], v[48:51]
  ds_read_b128 v[204:207], v6 offset:8192
  v_mfma_f32_16x16x32_bf16 v[56:59], v[216:219], a[84:87], v[56:59]
  v_max_f32 v19, 0, v19
  v_mfma_f32_16x16x32_bf16 v[52:55], v[220:223], a[80:83], v[52:55]
  ds_read_b128 v[208:211], v7 offset:4096
  v_mfma_f32_16x16x32_bf16 v[60:63], v[220:223], a[84:87], v[60:63]
  buffer_load_dwordx4 a[156:159], v4, s[12:15], s48 offen offset:3072 sc1
  v_add_f32 v19, s55, v19
  s_waitcnt lgkmcnt(9)
  v_mfma_f32_16x16x32_bf16 v[80:83], v[224:227], a[80:83], v[80:83]
  ds_read_b128 v[212:215], v4 offset:13312
  v_mfma_f32_16x16x32_bf16 v[84:87], v[224:227], a[84:87], v[84:87]
  v_rsq_f32 v19, v19
  s_waitcnt vmcnt(16)
  v_mfma_f32_16x16x32_bf16 v[32:35], v[228:231], a[88:91], v[32:35]
  ds_read_b128 v[216:219], v4 offset:33792
  v_mfma_f32_16x16x32_bf16 v[40:43], v[228:231], a[92:95], v[40:43]
  s_add_u32 s79, s72, 8192
  buffer_load_dwordx4 a[160:163], v4, s[12:15], s79 offen offset:0 sc1
  v_mul_f32 v170, v19, v19
  s_waitcnt lgkmcnt(9)
  v_mfma_f32_16x16x32_bf16 v[36:39], v[176:179], a[88:91], v[36:39]
  ds_read_b128 v[220:223], v4 offset:54272
  v_mfma_f32_16x16x32_bf16 v[44:47], v[176:179], a[92:95], v[44:47]
  s_add_u32 s79, s73, 8192
  buffer_load_dwordx4 a[164:167], v4, s[12:15], s79 offen offset:0 sc1
  v_mul_f32 v171, s50, v19
  v_mfma_f32_16x16x32_bf16 v[48:51], v[180:183], a[88:91], v[48:51]
  ds_read_b128 v[224:227], v6 offset:9216
  v_mfma_f32_16x16x32_bf16 v[56:59], v[180:183], a[92:95], v[56:59]
  v_mul_f32 v170, v170, v19
  s_waitcnt lgkmcnt(9)
  v_mfma_f32_16x16x32_bf16 v[52:55], v[184:187], a[88:91], v[52:55]
  ds_read_b128 v[228:231], v7 offset:5120
  v_mfma_f32_16x16x32_bf16 v[60:63], v[184:187], a[92:95], v[60:63]
  s_add_u32 s79, s74, 8192
  buffer_load_dwordx4 a[168:171], v4, s[12:15], s79 offen offset:0 sc1
  v_rcp_f32 v173, v19
  v_mfma_f32_16x16x32_bf16 v[80:83], v[188:191], a[88:91], v[80:83]
  ds_read_b128 v[176:179], v4 offset:14336
  v_mfma_f32_16x16x32_bf16 v[84:87], v[188:191], a[92:95], v[84:87]
  v_mul_f32 v170, s51, v170
  s_waitcnt vmcnt(17)
  v_swap_b32 v106, v108
  v_swap_b32 v107, v109
  s_waitcnt lgkmcnt(9)
  s_nop 0
  v_mfma_f32_16x16x32_bf16 v[32:35], v[192:195], v[104:107], v[32:35]
  ds_read_b128 v[180:183], v4 offset:34816
  v_mfma_f32_16x16x32_bf16 v[40:43], v[192:195], v[108:111], v[40:43]
  s_add_u32 s79, s75, 8192
  buffer_load_dwordx4 a[172:175], v4, s[12:15], s79 offen offset:0 sc1
  v_mfma_f32_16x16x32_bf16 v[36:39], v[196:199], v[104:107], v[36:39]
  ds_read_b128 v[184:187], v4 offset:55296
  v_mfma_f32_16x16x32_bf16 v[44:47], v[196:199], v[108:111], v[44:47]
  s_add_u32 s79, s76, 8192
  buffer_load_dwordx4 a[176:179], v4, s[12:15], s79 offen offset:0 sc1
  s_waitcnt lgkmcnt(9)
  v_mfma_f32_16x16x32_bf16 v[48:51], v[200:203], v[104:107], v[48:51]
  ds_read_b128 v[188:191], v6 offset:10240
  v_mfma_f32_16x16x32_bf16 v[56:59], v[200:203], v[108:111], v[56:59]
  v_mfma_f32_16x16x32_bf16 v[52:55], v[204:207], v[104:107], v[52:55]
  ds_read_b128 v[192:195], v7 offset:6144
  v_mfma_f32_16x16x32_bf16 v[60:63], v[204:207], v[108:111], v[60:63]
  s_add_u32 s79, s72, 8192
  buffer_load_dwordx4 a[180:183], v4, s[12:15], s79 offen offset:1024 sc1
  s_waitcnt lgkmcnt(9)
  v_mfma_f32_16x16x32_bf16 v[80:83], v[208:211], v[104:107], v[80:83]
  ds_read_b128 v[196:199], v4 offset:15360
  v_mfma_f32_16x16x32_bf16 v[84:87], v[208:211], v[108:111], v[84:87]
  s_waitcnt vmcnt(18)
  v_mfma_f32_16x16x32_bf16 v[32:35], v[212:215], a[104:107], v[32:35]
  ds_read_b128 v[200:203], v4 offset:35840
  v_mfma_f32_16x16x32_bf16 v[40:43], v[212:215], a[108:111], v[40:43]
  s_add_u32 s79, s73, 8192
  buffer_load_dwordx4 a[184:187], v4, s[12:15], s79 offen offset:1024 sc1
  s_waitcnt lgkmcnt(9)
  v_mfma_f32_16x16x32_bf16 v[36:39], v[216:219], a[104:107], v[36:39]
  ds_read_b128 v[204:207], v4 offset:56320
  v_mfma_f32_16x16x32_bf16 v[44:47], v[216:219], a[108:111], v[44:47]
  s_add_u32 s79, s74, 8192
  buffer_load_dwordx4 a[188:191], v4, s[12:15], s79 offen offset:1024 sc1
  v_mfma_f32_16x16x32_bf16 v[48:51], v[220:223], a[104:107], v[48:51]
  ds_read_b128 v[208:211], v6 offset:11264
  v_mfma_f32_16x16x32_bf16 v[56:59], v[220:223], a[108:111], v[56:59]
  s_waitcnt lgkmcnt(9)
  v_mfma_f32_16x16x32_bf16 v[52:55], v[224:227], a[104:107], v[52:55]
  ds_read_b128 v[212:215], v7 offset:7168
  v_mfma_f32_16x16x32_bf16 v[60:63], v[224:227], a[108:111], v[60:63]
  s_add_u32 s79, s75, 8192
  buffer_load_dwordx4 a[192:195], v4, s[12:15], s79 offen offset:1024 sc1
  v_mfma_f32_16x16x32_bf16 v[80:83], v[228:231], a[104:107], v[80:83]
  ds_read_b128 v[216:219], v4 offset:16384
  v_mfma_f32_16x16x32_bf16 v[84:87], v[228:231], a[108:111], v[84:87]
  s_waitcnt vmcnt(19)
  s_waitcnt lgkmcnt(9)
  v_mfma_f32_16x16x32_bf16 v[32:35], v[176:179], a[112:115], v[32:35]
  ds_read_b128 v[220:223], v4 offset:36864
  v_mfma_f32_16x16x32_bf16 v[40:43], v[176:179], a[116:119], v[40:43]
  s_add_u32 s79, s76, 8192
  buffer_load_dwordx4 a[196:199], v4, s[12:15], s79 offen offset:1024 sc1
  v_mfma_f32_16x16x32_bf16 v[36:39], v[180:183], a[112:115], v[36:39]
  ds_read_b128 v[224:227], v4 offset:57344
  v_mfma_f32_16x16x32_bf16 v[44:47], v[180:183], a[116:119], v[44:47]
  s_add_u32 s79, s72, 8192
  buffer_load_dwordx4 a[200:203], v4, s[12:15], s79 offen offset:2048 sc1
  s_waitcnt lgkmcnt(9)
  v_mfma_f32_16x16x32_bf16 v[48:51], v[184:187], a[112:115], v[48:51]
  ds_read_b128 v[228:231], v6 offset:12288
  v_mfma_f32_16x16x32_bf16 v[56:59], v[184:187], a[116:119], v[56:59]
  v_mfma_f32_16x16x32_bf16 v[52:55], v[188:191], a[112:115], v[52:55]
  ds_read_b128 v[176:179], v7 offset:8192
  v_mfma_f32_16x16x32_bf16 v[60:63], v[188:191], a[116:119], v[60:63]
  s_add_u32 s79, s73, 8192
  buffer_load_dwordx4 a[204:207], v4, s[12:15], s79 offen offset:2048 sc1
  s_waitcnt lgkmcnt(9)
  v_mfma_f32_16x16x32_bf16 v[80:83], v[192:195], a[112:115], v[80:83]
  ds_read_b128 v[180:183], v4 offset:17408
  v_mfma_f32_16x16x32_bf16 v[84:87], v[192:195], a[116:119], v[84:87]
  s_waitcnt vmcnt(20)
  v_mfma_f32_16x16x32_bf16 v[32:35], v[196:199], a[120:123], v[32:35]
  ds_read_b128 v[184:187], v4 offset:37888
  v_mfma_f32_16x16x32_bf16 v[40:43], v[196:199], a[124:127], v[40:43]
  s_add_u32 s79, s74, 8192
  buffer_load_dwordx4 a[208:211], v4, s[12:15], s79 offen offset:2048 sc1
  s_waitcnt lgkmcnt(9)
  v_mfma_f32_16x16x32_bf16 v[36:39], v[200:203], a[120:123], v[36:39]
  ds_read_b128 v[188:191], v4 offset:58368
  v_mfma_f32_16x16x32_bf16 v[44:47], v[200:203], a[124:127], v[44:47]
  s_add_u32 s79, s75, 8192
  buffer_load_dwordx4 a[212:215], v4, s[12:15], s79 offen offset:2048 sc1
  v_mfma_f32_16x16x32_bf16 v[48:51], v[204:207], a[120:123], v[48:51]
  ds_read_b128 v[192:195], v6 offset:13312
  v_mfma_f32_16x16x32_bf16 v[56:59], v[204:207], a[124:127], v[56:59]
  s_waitcnt lgkmcnt(9)
  v_mfma_f32_16x16x32_bf16 v[52:55], v[208:211], a[120:123], v[52:55]
  ds_read_b128 v[196:199], v7 offset:9216
  v_mfma_f32_16x16x32_bf16 v[60:63], v[208:211], a[124:127], v[60:63]
  s_add_u32 s79, s76, 8192
  buffer_load_dwordx4 a[216:219], v4, s[12:15], s79 offen offset:2048 sc1
  v_mfma_f32_16x16x32_bf16 v[80:83], v[212:215], a[120:123], v[80:83]
  ds_read_b128 v[200:203], v4 offset:18432
  v_mfma_f32_16x16x32_bf16 v[84:87], v[212:215], a[124:127], v[84:87]
  s_waitcnt vmcnt(21)
  s_waitcnt lgkmcnt(9)
  v_mfma_f32_16x16x32_bf16 v[32:35], v[216:219], a[128:131], v[32:35]
  ds_read_b128 v[204:207], v4 offset:38912
  v_mfma_f32_16x16x32_bf16 v[40:43], v[216:219], a[132:135], v[40:43]
  s_add_u32 s79, s72, 8192
  buffer_load_dwordx4 a[220:223], v4, s[12:15], s79 offen offset:3072 sc1
  v_mfma_f32_16x16x32_bf16 v[36:39], v[220:223], a[128:131], v[36:39]
  ds_read_b128 v[208:211], v4 offset:59392
  v_mfma_f32_16x16x32_bf16 v[44:47], v[220:223], a[132:135], v[44:47]
  s_add_u32 s79, s73, 8192
  buffer_load_dwordx4 a[224:227], v4, s[12:15], s79 offen offset:3072 sc1
  s_waitcnt lgkmcnt(9)
  v_mfma_f32_16x16x32_bf16 v[48:51], v[224:227], a[128:131], v[48:51]
  ds_read_b128 v[212:215], v6 offset:14336
  v_mfma_f32_16x16x32_bf16 v[56:59], v[224:227], a[132:135], v[56:59]
  s_add_u32 s79, s74, 8192
  buffer_load_dwordx4 a[228:231], v4, s[12:15], s79 offen offset:3072 sc1
  v_mfma_f32_16x16x32_bf16 v[52:55], v[228:231], a[128:131], v[52:55]
  ds_read_b128 v[216:219], v7 offset:10240
  v_mfma_f32_16x16x32_bf16 v[60:63], v[228:231], a[132:135], v[60:63]
  s_add_u32 s79, s75, 8192
  buffer_load_dwordx4 a[232:235], v4, s[12:15], s79 offen offset:3072 sc1
  s_waitcnt lgkmcnt(9)
  v_mfma_f32_16x16x32_bf16 v[80:83], v[176:179], a[128:131], v[80:83]
  ds_read_b128 v[220:223], v4 offset:19456
  v_mfma_f32_16x16x32_bf16 v[84:87], v[176:179], a[132:135], v[84:87]
  s_waitcnt vmcnt(23)
  v_swap_b32 v114, v116
  v_swap_b32 v115, v117
  s_nop 1
  v_mfma_f32_16x16x32_bf16 v[32:35], v[180:183], v[112:115], v[32:35]
  ds_read_b128 v[224:227], v4 offset:39936
  v_mfma_f32_16x16x32_bf16 v[40:43], v[180:183], v[116:119], v[40:43]
  s_add_u32 s79, s76, 8192
  buffer_load_dwordx4 a[236:239], v4, s[12:15], s79 offen offset:3072 sc1
  s_waitcnt lgkmcnt(9)
  v_mfma_f32_16x16x32_bf16 v[36:39], v[184:187], v[112:115], v[36:39]
  ds_read_b128 v[228:231], v4 offset:60416
  v_mfma_f32_16x16x32_bf16 v[44:47], v[184:187], v[116:119], v[44:47]
  s_add_u32 s79, s72, 12288
  s_add_u32 s79, s79, s77
  buffer_load_dwordx4 a[240:243], v4, s[12:15], s79 offen offset:0 sc1
  v_mfma_f32_16x16x32_bf16 v[48:51], v[188:191], v[112:115], v[48:51]
  ds_read_b128 v[176:179], v6 offset:15360
  v_mfma_f32_16x16x32_bf16 v[56:59], v[188:191], v[116:119], v[56:59]
  s_add_u32 s79, s73, 12288
  s_add_u32 s79, s79, s77
  buffer_load_dwordx4 a[244:247], v4, s[12:15], s79 offen offset:0 sc1
  s_waitcnt lgkmcnt(9)
  v_mfma_f32_16x16x32_bf16 v[52:55], v[192:195], v[112:115], v[52:55]
  ds_read_b128 v[180:183], v7 offset:11264
  v_mfma_f32_16x16x32_bf16 v[60:63], v[192:195], v[116:119], v[60:63]
  s_add_u32 s79, s74, 12288
  s_add_u32 s79, s79, s77
  buffer_load_dwordx4 a[248:251], v4, s[12:15], s79 offen offset:0 sc1
  v_mfma_f32_16x16x32_bf16 v[80:83], v[196:199], v[112:115], v[80:83]
  v_mfma_f32_16x16x32_bf16 v[84:87], v[196:199], v[116:119], v[84:87]
  s_waitcnt vmcnt(25)
  s_waitcnt lgkmcnt(8)
  v_mfma_f32_16x16x32_bf16 v[32:35], v[200:203], a[144:147], v[32:35]
  v_mfma_f32_16x16x32_bf16 v[40:43], v[200:203], a[148:151], v[40:43]
  s_add_u32 s79, s75, 12288
  s_add_u32 s79, s79, s77
  buffer_load_dwordx4 a[252:255], v4, s[12:15], s79 offen offset:0 sc1
  v_mfma_f32_16x16x32_bf16 v[36:39], v[204:207], a[144:147], v[36:39]
  v_mfma_f32_16x16x32_bf16 v[44:47], v[204:207], a[148:151], v[44:47]
  s_add_u32 s79, s76, 12288
  s_add_u32 s79, s79, s77
  buffer_load_dwordx4 v[232:235], v4, s[12:15], s79 offen offset:0 sc1
  s_waitcnt lgkmcnt(6)
  v_mfma_f32_16x16x32_bf16 v[48:51], v[208:211], a[144:147], v[48:51]
  v_mfma_f32_16x16x32_bf16 v[56:59], v[208:211], a[148:151], v[56:59]
  s_add_u32 s79, s72, 12288
  s_add_u32 s79, s79, s77
  buffer_load_dwordx4 v[236:239], v4, s[12:15], s79 offen offset:1024 sc1
  v_mfma_f32_16x16x32_bf16 v[52:55], v[212:215], a[144:147], v[52:55]
  v_mfma_f32_16x16x32_bf16 v[60:63], v[212:215], a[148:151], v[60:63]
  s_add_u32 s79, s73, 12288
  s_add_u32 s79, s79, s77
  buffer_load_dwordx4 v[240:243], v4, s[12:15], s79 offen offset:1024 sc1
  s_waitcnt lgkmcnt(4)
  v_mfma_f32_16x16x32_bf16 v[80:83], v[216:219], a[144:147], v[80:83]
  v_mfma_f32_16x16x32_bf16 v[84:87], v[216:219], a[148:151], v[84:87]
  s_waitcnt vmcnt(27)
  v_mfma_f32_16x16x32_bf16 v[32:35], v[220:223], a[152:155], v[32:35]
  v_mfma_f32_16x16x32_bf16 v[40:43], v[220:223], a[156:159], v[40:43]
  s_add_u32 s79, s74, 12288
  s_add_u32 s79, s79, s77
  buffer_load_dwordx4 v[244:247], v4, s[12:15], s79 offen offset:1024 sc1
  s_waitcnt lgkmcnt(2)
  v_mfma_f32_16x16x32_bf16 v[36:39], v[224:227], a[152:155], v[36:39]
  v_mfma_f32_16x16x32_bf16 v[44:47], v[224:227], a[156:159], v[44:47]
  s_add_u32 s79, s75, 12288
  s_add_u32 s79, s79, s77
  buffer_load_dwordx4 v[248:251], v4, s[12:15], s79 offen offset:1024 sc1
  v_mfma_f32_16x16x32_bf16 v[48:51], v[228:231], a[152:155], v[48:51]
  v_mfma_f32_16x16x32_bf16 v[56:59], v[228:231], a[156:159], v[56:59]
  s_add_u32 s79, s76, 12288
  s_add_u32 s79, s79, s77
  buffer_load_dwordx4 v[252:255], v4, s[12:15], s79 offen offset:1024 sc1
  s_waitcnt lgkmcnt(0)
  v_mfma_f32_16x16x32_bf16 v[52:55], v[176:179], a[152:155], v[52:55]
  v_mfma_f32_16x16x32_bf16 v[60:63], v[176:179], a[156:159], v[60:63]
  v_mfma_f32_16x16x32_bf16 v[80:83], v[180:183], a[152:155], v[80:83]
  v_mfma_f32_16x16x32_bf16 v[84:87], v[180:183], a[156:159], v[84:87]
sequential_preLN__ssm_conv_h3__mixer_s_mlp__prompt_kernel_gdone:
  s_mul_i32 s58, s30, 55296
  s_lshr_b32 s59, s28, 1
  s_lshl_b32 s59, s59, 10
  s_add_u32 s58, s58, s59
  s_add_u32 s58, s58, 21975040
  s_add_u32 s59, s58, 55296
  v_pk_fma_f32 v[32:33], v[120:121], v[16:17], v[32:33] op_sel:[0,0,0] op_sel_hi:[1,0,1] neg_lo:[1,0,0] neg_hi:[1,0,0]
  v_pk_fma_f32 v[36:37], v[124:125], v[16:17], v[36:37] op_sel:[0,0,0] op_sel_hi:[1,0,1] neg_lo:[1,0,0] neg_hi:[1,0,0]
  v_pk_fma_f32 v[40:41], v[120:121], v[18:19], v[40:41] op_sel:[0,0,0] op_sel_hi:[1,0,1] neg_lo:[1,0,0] neg_hi:[1,0,0]
  v_pk_fma_f32 v[44:45], v[124:125], v[18:19], v[44:45] op_sel:[0,0,0] op_sel_hi:[1,0,1] neg_lo:[1,0,0] neg_hi:[1,0,0]
  v_pk_mul_f32 v[24:25], v[32:33], v[32:33]
  v_pk_mul_f32 v[26:27], v[36:37], v[36:37]
  v_pk_mul_f32 v[28:29], v[40:41], v[40:41]
  v_pk_mul_f32 v[30:31], v[44:45], v[44:45]
  v_pk_fma_f32 v[24:25], v[24:25], v[168:169], v[168:169] op_sel:[0,0,1] op_sel_hi:[1,0,1]
  v_pk_fma_f32 v[26:27], v[26:27], v[168:169], v[168:169] op_sel:[0,0,1] op_sel_hi:[1,0,1]
  v_pk_fma_f32 v[28:29], v[28:29], v[170:171], v[170:171] op_sel:[0,0,1] op_sel_hi:[1,0,1]
  v_pk_fma_f32 v[30:31], v[30:31], v[170:171], v[170:171] op_sel:[0,0,1] op_sel_hi:[1,0,1]
  v_pk_mul_f32 v[24:25], v[24:25], v[32:33]
  v_pk_mul_f32 v[26:27], v[26:27], v[36:37]
  v_pk_mul_f32 v[28:29], v[28:29], v[40:41]
  v_pk_mul_f32 v[30:31], v[30:31], v[44:45]
  v_exp_f32 v24, v24
  v_exp_f32 v26, v26
  v_exp_f32 v28, v28
  v_exp_f32 v30, v30
  v_exp_f32 v25, v25
  v_exp_f32 v27, v27
  v_exp_f32 v29, v29
  v_exp_f32 v31, v31
  s_mov_b32 s79, s72
  buffer_load_dwordx4 a[0:3], v4, s[12:15], s79 offen offset:0 sc1
  v_pk_fma_f32 v[24:25], v[24:25], v[172:173], v[172:173] op_sel:[0,0,0] op_sel_hi:[1,0,0]
  v_pk_fma_f32 v[26:27], v[26:27], v[172:173], v[172:173] op_sel:[0,0,0] op_sel_hi:[1,0,0]
  v_pk_fma_f32 v[28:29], v[28:29], v[172:173], v[172:173] op_sel:[0,1,1] op_sel_hi:[1,1,1]
  v_pk_fma_f32 v[30:31], v[30:31], v[172:173], v[172:173] op_sel:[0,1,1] op_sel_hi:[1,1,1]
  v_rcp_f32 v24, v24
  v_rcp_f32 v26, v26
  v_rcp_f32 v28, v28
  v_rcp_f32 v30, v30
  v_rcp_f32 v25, v25
  v_rcp_f32 v27, v27
  v_rcp_f32 v29, v29
  v_rcp_f32 v31, v31
  v_pk_mul_f32 v[24:25], v[24:25], v[32:33]
  v_pk_mul_f32 v[26:27], v[26:27], v[36:37]
  v_pk_mul_f32 v[28:29], v[28:29], v[40:41]
  v_pk_mul_f32 v[30:31], v[30:31], v[44:45]
  v_cvt_pk_bf16_f32 v148, v24, v25
  v_cvt_pk_bf16_f32 v150, v26, v27
  v_cvt_pk_bf16_f32 v152, v28, v29
  v_cvt_pk_bf16_f32 v154, v30, v31
  v_pk_fma_f32 v[34:35], v[122:123], v[16:17], v[34:35] op_sel:[0,0,0] op_sel_hi:[1,0,1] neg_lo:[1,0,0] neg_hi:[1,0,0]
  v_pk_fma_f32 v[38:39], v[126:127], v[16:17], v[38:39] op_sel:[0,0,0] op_sel_hi:[1,0,1] neg_lo:[1,0,0] neg_hi:[1,0,0]
  v_pk_fma_f32 v[42:43], v[122:123], v[18:19], v[42:43] op_sel:[0,0,0] op_sel_hi:[1,0,1] neg_lo:[1,0,0] neg_hi:[1,0,0]
  v_pk_fma_f32 v[46:47], v[126:127], v[18:19], v[46:47] op_sel:[0,0,0] op_sel_hi:[1,0,1] neg_lo:[1,0,0] neg_hi:[1,0,0]
  s_mov_b32 s79, s73
  buffer_load_dwordx4 a[4:7], v4, s[12:15], s79 offen offset:0 sc1
  v_pk_mul_f32 v[24:25], v[34:35], v[34:35]
  v_pk_mul_f32 v[26:27], v[38:39], v[38:39]
  v_pk_mul_f32 v[28:29], v[42:43], v[42:43]
  v_pk_mul_f32 v[30:31], v[46:47], v[46:47]
  v_pk_fma_f32 v[24:25], v[24:25], v[168:169], v[168:169] op_sel:[0,0,1] op_sel_hi:[1,0,1]
  v_pk_fma_f32 v[26:27], v[26:27], v[168:169], v[168:169] op_sel:[0,0,1] op_sel_hi:[1,0,1]
  v_pk_fma_f32 v[28:29], v[28:29], v[170:171], v[170:171] op_sel:[0,0,1] op_sel_hi:[1,0,1]
  v_pk_fma_f32 v[30:31], v[30:31], v[170:171], v[170:171] op_sel:[0,0,1] op_sel_hi:[1,0,1]
  v_pk_mul_f32 v[24:25], v[24:25], v[34:35]
  v_pk_mul_f32 v[26:27], v[26:27], v[38:39]
  v_pk_mul_f32 v[28:29], v[28:29], v[42:43]
  v_pk_mul_f32 v[30:31], v[30:31], v[46:47]
  v_exp_f32 v24, v24
  v_exp_f32 v26, v26
  v_exp_f32 v28, v28
  v_exp_f32 v30, v30
  v_exp_f32 v25, v25
  v_exp_f32 v27, v27
  v_exp_f32 v29, v29
  v_exp_f32 v31, v31
  v_pk_fma_f32 v[24:25], v[24:25], v[172:173], v[172:173] op_sel:[0,0,0] op_sel_hi:[1,0,0]
  v_pk_fma_f32 v[26:27], v[26:27], v[172:173], v[172:173] op_sel:[0,0,0] op_sel_hi:[1,0,0]
  v_pk_fma_f32 v[28:29], v[28:29], v[172:173], v[172:173] op_sel:[0,1,1] op_sel_hi:[1,1,1]
  v_pk_fma_f32 v[30:31], v[30:31], v[172:173], v[172:173] op_sel:[0,1,1] op_sel_hi:[1,1,1]
  s_mov_b32 s79, s74
  buffer_load_dwordx4 a[8:11], v4, s[12:15], s79 offen offset:0 sc1
  v_rcp_f32 v24, v24
  v_rcp_f32 v26, v26
  v_rcp_f32 v28, v28
  v_rcp_f32 v30, v30
  v_rcp_f32 v25, v25
  v_rcp_f32 v27, v27
  v_rcp_f32 v29, v29
  v_rcp_f32 v31, v31
  v_pk_mul_f32 v[24:25], v[24:25], v[34:35]
  v_pk_mul_f32 v[26:27], v[26:27], v[38:39]
  v_pk_mul_f32 v[28:29], v[28:29], v[42:43]
  v_pk_mul_f32 v[30:31], v[30:31], v[46:47]
  v_cvt_pk_bf16_f32 v149, v24, v25
  v_cvt_pk_bf16_f32 v151, v26, v27
  v_cvt_pk_bf16_f32 v153, v28, v29
  v_cvt_pk_bf16_f32 v155, v30, v31
  buffer_store_dwordx4 v[148:151], v4, s[12:15], s58 offen offset:0 sc1
  buffer_store_dwordx4 v[152:155], v4, s[12:15], s59 offen offset:0 sc1
  v_pk_fma_f32 v[48:49], v[128:129], v[16:17], v[48:49] op_sel:[0,0,0] op_sel_hi:[1,0,1] neg_lo:[1,0,0] neg_hi:[1,0,0]
  v_pk_fma_f32 v[52:53], v[132:133], v[16:17], v[52:53] op_sel:[0,0,0] op_sel_hi:[1,0,1] neg_lo:[1,0,0] neg_hi:[1,0,0]
  v_pk_fma_f32 v[56:57], v[128:129], v[18:19], v[56:57] op_sel:[0,0,0] op_sel_hi:[1,0,1] neg_lo:[1,0,0] neg_hi:[1,0,0]
  v_pk_fma_f32 v[60:61], v[132:133], v[18:19], v[60:61] op_sel:[0,0,0] op_sel_hi:[1,0,1] neg_lo:[1,0,0] neg_hi:[1,0,0]
  v_pk_mul_f32 v[24:25], v[48:49], v[48:49]
  v_pk_mul_f32 v[26:27], v[52:53], v[52:53]
  v_pk_mul_f32 v[28:29], v[56:57], v[56:57]
  v_pk_mul_f32 v[30:31], v[60:61], v[60:61]
  v_pk_fma_f32 v[24:25], v[24:25], v[168:169], v[168:169] op_sel:[0,0,1] op_sel_hi:[1,0,1]
  v_pk_fma_f32 v[26:27], v[26:27], v[168:169], v[168:169] op_sel:[0,0,1] op_sel_hi:[1,0,1]
  v_pk_fma_f32 v[28:29], v[28:29], v[170:171], v[170:171] op_sel:[0,0,1] op_sel_hi:[1,0,1]
  v_pk_fma_f32 v[30:31], v[30:31], v[170:171], v[170:171] op_sel:[0,0,1] op_sel_hi:[1,0,1]
  v_pk_mul_f32 v[24:25], v[24:25], v[48:49]
  v_pk_mul_f32 v[26:27], v[26:27], v[52:53]
  v_pk_mul_f32 v[28:29], v[28:29], v[56:57]
  v_pk_mul_f32 v[30:31], v[30:31], v[60:61]
  v_exp_f32 v24, v24
  v_exp_f32 v26, v26
  v_exp_f32 v28, v28
  v_exp_f32 v30, v30
  v_exp_f32 v25, v25
  v_exp_f32 v27, v27
  v_exp_f32 v29, v29
  v_exp_f32 v31, v31
  s_mov_b32 s79, s75
  buffer_load_dwordx4 a[12:15], v4, s[12:15], s79 offen offset:0 sc1
  v_pk_fma_f32 v[24:25], v[24:25], v[172:173], v[172:173] op_sel:[0,0,0] op_sel_hi:[1,0,0]
  v_pk_fma_f32 v[26:27], v[26:27], v[172:173], v[172:173] op_sel:[0,0,0] op_sel_hi:[1,0,0]
  v_pk_fma_f32 v[28:29], v[28:29], v[172:173], v[172:173] op_sel:[0,1,1] op_sel_hi:[1,1,1]
  v_pk_fma_f32 v[30:31], v[30:31], v[172:173], v[172:173] op_sel:[0,1,1] op_sel_hi:[1,1,1]
  v_rcp_f32 v24, v24
  v_rcp_f32 v26, v26
  v_rcp_f32 v28, v28
  v_rcp_f32 v30, v30
  v_rcp_f32 v25, v25
  v_rcp_f32 v27, v27
  v_rcp_f32 v29, v29
  v_rcp_f32 v31, v31
  v_pk_mul_f32 v[24:25], v[24:25], v[48:49]
  v_pk_mul_f32 v[26:27], v[26:27], v[52:53]
  v_pk_mul_f32 v[28:29], v[28:29], v[56:57]
  v_pk_mul_f32 v[30:31], v[30:31], v[60:61]
  v_cvt_pk_bf16_f32 v156, v24, v25
  v_cvt_pk_bf16_f32 v158, v26, v27
  v_cvt_pk_bf16_f32 v160, v28, v29
  v_cvt_pk_bf16_f32 v162, v30, v31
  v_pk_fma_f32 v[50:51], v[130:131], v[16:17], v[50:51] op_sel:[0,0,0] op_sel_hi:[1,0,1] neg_lo:[1,0,0] neg_hi:[1,0,0]
  v_pk_fma_f32 v[54:55], v[134:135], v[16:17], v[54:55] op_sel:[0,0,0] op_sel_hi:[1,0,1] neg_lo:[1,0,0] neg_hi:[1,0,0]
  v_pk_fma_f32 v[58:59], v[130:131], v[18:19], v[58:59] op_sel:[0,0,0] op_sel_hi:[1,0,1] neg_lo:[1,0,0] neg_hi:[1,0,0]
  v_pk_fma_f32 v[62:63], v[134:135], v[18:19], v[62:63] op_sel:[0,0,0] op_sel_hi:[1,0,1] neg_lo:[1,0,0] neg_hi:[1,0,0]
  s_mov_b32 s79, s76
  buffer_load_dwordx4 a[16:19], v4, s[12:15], s79 offen offset:0 sc1
  v_pk_mul_f32 v[24:25], v[50:51], v[50:51]
  v_pk_mul_f32 v[26:27], v[54:55], v[54:55]
  v_pk_mul_f32 v[28:29], v[58:59], v[58:59]
  v_pk_mul_f32 v[30:31], v[62:63], v[62:63]
  v_pk_fma_f32 v[24:25], v[24:25], v[168:169], v[168:169] op_sel:[0,0,1] op_sel_hi:[1,0,1]
  v_pk_fma_f32 v[26:27], v[26:27], v[168:169], v[168:169] op_sel:[0,0,1] op_sel_hi:[1,0,1]
  v_pk_fma_f32 v[28:29], v[28:29], v[170:171], v[170:171] op_sel:[0,0,1] op_sel_hi:[1,0,1]
  v_pk_fma_f32 v[30:31], v[30:31], v[170:171], v[170:171] op_sel:[0,0,1] op_sel_hi:[1,0,1]
  v_pk_mul_f32 v[24:25], v[24:25], v[50:51]
  v_pk_mul_f32 v[26:27], v[26:27], v[54:55]
  v_pk_mul_f32 v[28:29], v[28:29], v[58:59]
  v_pk_mul_f32 v[30:31], v[30:31], v[62:63]
  v_exp_f32 v24, v24
  v_exp_f32 v26, v26
  v_exp_f32 v28, v28
  v_exp_f32 v30, v30
  v_exp_f32 v25, v25
  v_exp_f32 v27, v27
  v_exp_f32 v29, v29
  v_exp_f32 v31, v31
  v_pk_fma_f32 v[24:25], v[24:25], v[172:173], v[172:173] op_sel:[0,0,0] op_sel_hi:[1,0,0]
  v_pk_fma_f32 v[26:27], v[26:27], v[172:173], v[172:173] op_sel:[0,0,0] op_sel_hi:[1,0,0]
  v_pk_fma_f32 v[28:29], v[28:29], v[172:173], v[172:173] op_sel:[0,1,1] op_sel_hi:[1,1,1]
  v_pk_fma_f32 v[30:31], v[30:31], v[172:173], v[172:173] op_sel:[0,1,1] op_sel_hi:[1,1,1]
  s_mov_b32 s79, s72
  buffer_load_dwordx4 a[20:23], v4, s[12:15], s79 offen offset:1024 sc1
  v_rcp_f32 v24, v24
  v_rcp_f32 v26, v26
  v_rcp_f32 v28, v28
  v_rcp_f32 v30, v30
  v_rcp_f32 v25, v25
  v_rcp_f32 v27, v27
  v_rcp_f32 v29, v29
  v_rcp_f32 v31, v31
  v_pk_mul_f32 v[24:25], v[24:25], v[50:51]
  v_pk_mul_f32 v[26:27], v[26:27], v[54:55]
  v_pk_mul_f32 v[28:29], v[28:29], v[58:59]
  v_pk_mul_f32 v[30:31], v[30:31], v[62:63]
  v_cvt_pk_bf16_f32 v157, v24, v25
  v_cvt_pk_bf16_f32 v159, v26, v27
  v_cvt_pk_bf16_f32 v161, v28, v29
  v_cvt_pk_bf16_f32 v163, v30, v31
  buffer_store_dwordx4 v[156:159], v4, s[12:15], s58 offen offset:1024 sc1
  buffer_store_dwordx4 v[160:163], v4, s[12:15], s59 offen offset:1024 sc1
  s_cmp_eq_u32 s26, 2
  s_cbranch_scc1 sequential_preLN__ssm_conv_h3__mixer_s_mlp__prompt_kernel_noe2
  v_pk_fma_f32 v[64:65], v[136:137], v[16:17], v[64:65] op_sel:[0,0,0] op_sel_hi:[1,0,1] neg_lo:[1,0,0] neg_hi:[1,0,0]
  v_pk_fma_f32 v[68:69], v[140:141], v[16:17], v[68:69] op_sel:[0,0,0] op_sel_hi:[1,0,1] neg_lo:[1,0,0] neg_hi:[1,0,0]
  v_pk_fma_f32 v[72:73], v[136:137], v[18:19], v[72:73] op_sel:[0,0,0] op_sel_hi:[1,0,1] neg_lo:[1,0,0] neg_hi:[1,0,0]
  v_pk_fma_f32 v[76:77], v[140:141], v[18:19], v[76:77] op_sel:[0,0,0] op_sel_hi:[1,0,1] neg_lo:[1,0,0] neg_hi:[1,0,0]
  v_pk_mul_f32 v[24:25], v[64:65], v[64:65]
  v_pk_mul_f32 v[26:27], v[68:69], v[68:69]
  v_pk_mul_f32 v[28:29], v[72:73], v[72:73]
  v_pk_mul_f32 v[30:31], v[76:77], v[76:77]
  v_pk_fma_f32 v[24:25], v[24:25], v[168:169], v[168:169] op_sel:[0,0,1] op_sel_hi:[1,0,1]
  v_pk_fma_f32 v[26:27], v[26:27], v[168:169], v[168:169] op_sel:[0,0,1] op_sel_hi:[1,0,1]
  v_pk_fma_f32 v[28:29], v[28:29], v[170:171], v[170:171] op_sel:[0,0,1] op_sel_hi:[1,0,1]
  v_pk_fma_f32 v[30:31], v[30:31], v[170:171], v[170:171] op_sel:[0,0,1] op_sel_hi:[1,0,1]
  v_pk_mul_f32 v[24:25], v[24:25], v[64:65]
  v_pk_mul_f32 v[26:27], v[26:27], v[68:69]
  v_pk_mul_f32 v[28:29], v[28:29], v[72:73]
  v_pk_mul_f32 v[30:31], v[30:31], v[76:77]
  v_exp_f32 v24, v24
  v_exp_f32 v26, v26
  v_exp_f32 v28, v28
  v_exp_f32 v30, v30
  v_exp_f32 v25, v25
  v_exp_f32 v27, v27
  v_exp_f32 v29, v29
  v_exp_f32 v31, v31
  v_pk_fma_f32 v[24:25], v[24:25], v[172:173], v[172:173] op_sel:[0,0,0] op_sel_hi:[1,0,0]
  v_pk_fma_f32 v[26:27], v[26:27], v[172:173], v[172:173] op_sel:[0,0,0] op_sel_hi:[1,0,0]
  v_pk_fma_f32 v[28:29], v[28:29], v[172:173], v[172:173] op_sel:[0,1,1] op_sel_hi:[1,1,1]
  v_pk_fma_f32 v[30:31], v[30:31], v[172:173], v[172:173] op_sel:[0,1,1] op_sel_hi:[1,1,1]
  v_rcp_f32 v24, v24
  v_rcp_f32 v26, v26
  v_rcp_f32 v28, v28
  v_rcp_f32 v30, v30
  v_rcp_f32 v25, v25
  v_rcp_f32 v27, v27
  v_rcp_f32 v29, v29
  v_rcp_f32 v31, v31
  v_pk_mul_f32 v[24:25], v[24:25], v[64:65]
  v_pk_mul_f32 v[26:27], v[26:27], v[68:69]
  v_pk_mul_f32 v[28:29], v[28:29], v[72:73]
  v_pk_mul_f32 v[30:31], v[30:31], v[76:77]
  v_cvt_pk_bf16_f32 v148, v24, v25
  v_cvt_pk_bf16_f32 v150, v26, v27
  v_cvt_pk_bf16_f32 v152, v28, v29
  v_cvt_pk_bf16_f32 v154, v30, v31
  v_pk_fma_f32 v[66:67], v[138:139], v[16:17], v[66:67] op_sel:[0,0,0] op_sel_hi:[1,0,1] neg_lo:[1,0,0] neg_hi:[1,0,0]
  v_pk_fma_f32 v[70:71], v[142:143], v[16:17], v[70:71] op_sel:[0,0,0] op_sel_hi:[1,0,1] neg_lo:[1,0,0] neg_hi:[1,0,0]
  v_pk_fma_f32 v[74:75], v[138:139], v[18:19], v[74:75] op_sel:[0,0,0] op_sel_hi:[1,0,1] neg_lo:[1,0,0] neg_hi:[1,0,0]
  v_pk_fma_f32 v[78:79], v[142:143], v[18:19], v[78:79] op_sel:[0,0,0] op_sel_hi:[1,0,1] neg_lo:[1,0,0] neg_hi:[1,0,0]
  v_pk_mul_f32 v[24:25], v[66:67], v[66:67]
  v_pk_mul_f32 v[26:27], v[70:71], v[70:71]
  v_pk_mul_f32 v[28:29], v[74:75], v[74:75]
  v_pk_mul_f32 v[30:31], v[78:79], v[78:79]
  v_pk_fma_f32 v[24:25], v[24:25], v[168:169], v[168:169] op_sel:[0,0,1] op_sel_hi:[1,0,1]
  v_pk_fma_f32 v[26:27], v[26:27], v[168:169], v[168:169] op_sel:[0,0,1] op_sel_hi:[1,0,1]
  v_pk_fma_f32 v[28:29], v[28:29], v[170:171], v[170:171] op_sel:[0,0,1] op_sel_hi:[1,0,1]
  v_pk_fma_f32 v[30:31], v[30:31], v[170:171], v[170:171] op_sel:[0,0,1] op_sel_hi:[1,0,1]
  v_pk_mul_f32 v[24:25], v[24:25], v[66:67]
  v_pk_mul_f32 v[26:27], v[26:27], v[70:71]
  v_pk_mul_f32 v[28:29], v[28:29], v[74:75]
  v_pk_mul_f32 v[30:31], v[30:31], v[78:79]
  v_exp_f32 v24, v24
  v_exp_f32 v26, v26
  v_exp_f32 v28, v28
  v_exp_f32 v30, v30
  v_exp_f32 v25, v25
  v_exp_f32 v27, v27
  v_exp_f32 v29, v29
  v_exp_f32 v31, v31
  v_pk_fma_f32 v[24:25], v[24:25], v[172:173], v[172:173] op_sel:[0,0,0] op_sel_hi:[1,0,0]
  v_pk_fma_f32 v[26:27], v[26:27], v[172:173], v[172:173] op_sel:[0,0,0] op_sel_hi:[1,0,0]
  v_pk_fma_f32 v[28:29], v[28:29], v[172:173], v[172:173] op_sel:[0,1,1] op_sel_hi:[1,1,1]
  v_pk_fma_f32 v[30:31], v[30:31], v[172:173], v[172:173] op_sel:[0,1,1] op_sel_hi:[1,1,1]
  v_rcp_f32 v24, v24
  v_rcp_f32 v26, v26
  v_rcp_f32 v28, v28
  v_rcp_f32 v30, v30
  v_rcp_f32 v25, v25
  v_rcp_f32 v27, v27
  v_rcp_f32 v29, v29
  v_rcp_f32 v31, v31
  v_pk_mul_f32 v[24:25], v[24:25], v[66:67]
  v_pk_mul_f32 v[26:27], v[26:27], v[70:71]
  v_pk_mul_f32 v[28:29], v[28:29], v[74:75]
  v_pk_mul_f32 v[30:31], v[30:31], v[78:79]
  v_cvt_pk_bf16_f32 v149, v24, v25
  v_cvt_pk_bf16_f32 v151, v26, v27
  v_cvt_pk_bf16_f32 v153, v28, v29
  v_cvt_pk_bf16_f32 v155, v30, v31
  buffer_store_dwordx4 v[148:151], v4, s[12:15], s58 offen offset:2048 sc1
  buffer_store_dwordx4 v[152:155], v4, s[12:15], s59 offen offset:2048 sc1
sequential_preLN__ssm_conv_h3__mixer_s_mlp__prompt_kernel_noe2:
  v_pk_fma_f32 v[80:81], v[144:145], v[16:17], v[80:81] op_sel:[0,0,0] op_sel_hi:[1,0,1] neg_lo:[1,0,0] neg_hi:[1,0,0]
  v_pk_fma_f32 v[84:85], v[144:145], v[18:19], v[84:85] op_sel:[0,0,0] op_sel_hi:[1,0,1] neg_lo:[1,0,0] neg_hi:[1,0,0]
  v_pk_mul_f32 v[24:25], v[80:81], v[80:81]
  v_pk_mul_f32 v[26:27], v[84:85], v[84:85]
  v_pk_fma_f32 v[24:25], v[24:25], v[168:169], v[168:169] op_sel:[0,0,1] op_sel_hi:[1,0,1]
  v_pk_fma_f32 v[26:27], v[26:27], v[170:171], v[170:171] op_sel:[0,0,1] op_sel_hi:[1,0,1]
  v_pk_mul_f32 v[24:25], v[24:25], v[80:81]
  v_pk_mul_f32 v[26:27], v[26:27], v[84:85]
  v_exp_f32 v24, v24
  v_exp_f32 v26, v26
  v_exp_f32 v25, v25
  v_exp_f32 v27, v27
  v_pk_fma_f32 v[24:25], v[24:25], v[172:173], v[172:173] op_sel:[0,0,0] op_sel_hi:[1,0,0]
  v_pk_fma_f32 v[26:27], v[26:27], v[172:173], v[172:173] op_sel:[0,1,1] op_sel_hi:[1,1,1]
  v_rcp_f32 v24, v24
  v_rcp_f32 v26, v26
  v_rcp_f32 v25, v25
  v_rcp_f32 v27, v27
  v_pk_mul_f32 v[24:25], v[24:25], v[80:81]
  v_pk_mul_f32 v[26:27], v[26:27], v[84:85]
  v_cvt_pk_bf16_f32 v148, v24, v25
  v_cvt_pk_bf16_f32 v150, v26, v27
  v_pk_fma_f32 v[82:83], v[146:147], v[16:17], v[82:83] op_sel:[0,0,0] op_sel_hi:[1,0,1] neg_lo:[1,0,0] neg_hi:[1,0,0]
  v_pk_fma_f32 v[86:87], v[146:147], v[18:19], v[86:87] op_sel:[0,0,0] op_sel_hi:[1,0,1] neg_lo:[1,0,0] neg_hi:[1,0,0]
  s_mov_b32 s79, s73
  buffer_load_dwordx4 a[24:27], v4, s[12:15], s79 offen offset:1024 sc1
  v_pk_mul_f32 v[24:25], v[82:83], v[82:83]
  v_pk_mul_f32 v[26:27], v[86:87], v[86:87]
  v_pk_fma_f32 v[24:25], v[24:25], v[168:169], v[168:169] op_sel:[0,0,1] op_sel_hi:[1,0,1]
  v_pk_fma_f32 v[26:27], v[26:27], v[170:171], v[170:171] op_sel:[0,0,1] op_sel_hi:[1,0,1]
  v_pk_mul_f32 v[24:25], v[24:25], v[82:83]
  v_pk_mul_f32 v[26:27], v[26:27], v[86:87]
  v_exp_f32 v24, v24
  v_exp_f32 v26, v26
  v_exp_f32 v25, v25
  v_exp_f32 v27, v27
  v_pk_fma_f32 v[24:25], v[24:25], v[172:173], v[172:173] op_sel:[0,0,0] op_sel_hi:[1,0,0]
  v_pk_fma_f32 v[26:27], v[26:27], v[172:173], v[172:173] op_sel:[0,1,1] op_sel_hi:[1,1,1]
  v_rcp_f32 v24, v24
  v_rcp_f32 v26, v26
  v_rcp_f32 v25, v25
  v_rcp_f32 v27, v27
  v_pk_mul_f32 v[24:25], v[24:25], v[82:83]
  v_pk_mul_f32 v[26:27], v[26:27], v[86:87]
  v_cvt_pk_bf16_f32 v149, v24, v25
  v_cvt_pk_bf16_f32 v151, v26, v27
  s_add_u32 s58, s30, s27
  s_mul_i32 s58, s58, 55296
  s_lshr_b32 s59, s29, 1
  s_lshl_b32 s59, s59, 10
  s_add_u32 s58, s58, s59
  s_add_u32 s58, s58, 21975040
  buffer_store_dwordx4 v[148:151], v4, s[12:15], s58 offen sc1
  s_mov_b32 s79, s74
  buffer_load_dwordx4 a[28:31], v4, s[12:15], s79 offen offset:1024 sc1
  s_mov_b32 s79, s75
  buffer_load_dwordx4 a[32:35], v4, s[12:15], s79 offen offset:1024 sc1
  s_mov_b32 s79, s76
  buffer_load_dwordx4 a[36:39], v4, s[12:15], s79 offen offset:1024 sc1
  s_mov_b32 s79, s72
  buffer_load_dwordx4 a[40:43], v4, s[12:15], s79 offen offset:2048 sc1
  s_mov_b32 s79, s73
  buffer_load_dwordx4 a[44:47], v4, s[12:15], s79 offen offset:2048 sc1
  s_mov_b32 s79, s74
  buffer_load_dwordx4 a[48:51], v4, s[12:15], s79 offen offset:2048 sc1
  s_mov_b32 s79, s75
  buffer_load_dwordx4 a[52:55], v4, s[12:15], s79 offen offset:2048 sc1
  s_mov_b32 s79, s76
  buffer_load_dwordx4 a[56:59], v4, s[12:15], s79 offen offset:2048 sc1
  s_mov_b32 s79, s72
  buffer_load_dwordx4 a[60:63], v4, s[12:15], s79 offen offset:3072 sc1
  s_mov_b32 s79, s73
  buffer_load_dwordx4 a[64:67], v4, s[12:15], s79 offen offset:3072 sc1
  s_waitcnt vmcnt(10)
  s_barrier
  s_cmp_lg_u32 s10, 0
  s_cbranch_scc1 sequential_preLN__ssm_conv_h3__mixer_s_mlp__prompt_kernel_sig23
  s_lshl_b32 s84, s24, 2
  s_lshr_b32 s85, s25, 2
  s_add_u32 s84, s84, s85
  s_lshl_b32 s84, s84, 7
  s_add_u32 s84, s84, 29069312
  v_mov_b32 v5, 0
  v_mov_b32 v6, 1
  s_mov_b64 exec, 1
  buffer_atomic_add v6, v5, s[12:15], s84 offen sc1
  s_mov_b64 exec, -1
sequential_preLN__ssm_conv_h3__mixer_s_mlp__prompt_kernel_sig23:
sequential_preLN__ssm_conv_h3__mixer_s_mlp__prompt_kernel_ph5:
  s_mov_b32 s79, s74
  buffer_load_dwordx4 a[68:71], v4, s[12:15], s79 offen offset:3072 sc1
  s_mov_b32 s79, s75
  buffer_load_dwordx4 a[72:75], v4, s[12:15], s79 offen offset:3072 sc1
  s_mov_b32 s79, s76
  buffer_load_dwordx4 a[76:79], v4, s[12:15], s79 offen offset:3072 sc1
  s_add_u32 s79, s72, 4096
  buffer_load_dwordx4 a[80:83], v4, s[12:15], s79 offen offset:0 sc1
  s_add_u32 s79, s73, 4096
  buffer_load_dwordx4 a[84:87], v4, s[12:15], s79 offen offset:0 sc1
  s_add_u32 s79, s74, 4096
  buffer_load_dwordx4 a[88:91], v4, s[12:15], s79 offen offset:0 sc1
  s_add_u32 s79, s75, 4096
  buffer_load_dwordx4 a[92:95], v4, s[12:15], s79 offen offset:0 sc1
  s_add_u32 s79, s76, 4096
  buffer_load_dwordx4 a[96:99], v4, s[12:15], s79 offen offset:0 sc1
  s_add_u32 s79, s72, 4096
  buffer_load_dwordx4 a[100:103], v4, s[12:15], s79 offen offset:1024 sc1
  s_add_u32 s79, s73, 4096
  buffer_load_dwordx4 a[104:107], v4, s[12:15], s79 offen offset:1024 sc1
  s_add_u32 s79, s74, 4096
  buffer_load_dwordx4 a[108:111], v4, s[12:15], s79 offen offset:1024 sc1
  s_add_u32 s79, s75, 4096
  buffer_load_dwordx4 a[112:115], v4, s[12:15], s79 offen offset:1024 sc1
  s_add_u32 s79, s76, 4096
  buffer_load_dwordx4 a[116:119], v4, s[12:15], s79 offen offset:1024 sc1
  s_add_u32 s79, s72, 4096
  buffer_load_dwordx4 a[120:123], v4, s[12:15], s79 offen offset:2048 sc1
  s_add_u32 s79, s73, 4096
  buffer_load_dwordx4 a[124:127], v4, s[12:15], s79 offen offset:2048 sc1
  s_add_u32 s79, s74, 4096
  buffer_load_dwordx4 a[128:131], v4, s[12:15], s79 offen offset:2048 sc1
  s_cmp_lg_u32 s10, 0
  s_cbranch_scc1 sequential_preLN__ssm_conv_h3__mixer_s_mlp__prompt_kernel_wt24
  s_lshr_b32 s84, s60, 1
  s_lshl_b32 s84, s84, 9
  s_add_u32 s84, s84, 29069312
  v_and_b32 v5, 3, v1
  v_lshlrev_b32 v5, 7, v5
  v_add_u32 v5, s84, v5
  v_mov_b32 v7, 4
  s_mov_b32 s85, 0
sequential_preLN__ssm_conv_h3__mixer_s_mlp__prompt_kernel_pl25_l:
  buffer_load_dword v6, v5, s[12:15], 0 offen sc1
  s_add_u32 s85, s85, 1
  s_waitcnt vmcnt(0)
  v_cmp_gt_u32 vcc, v7, v6
  s_cmp_gt_u32 s85, 200000
  s_cbranch_scc1 sequential_preLN__ssm_conv_h3__mixer_s_mlp__prompt_kernel_pl25
  s_nop 2
  s_nop 2
  s_cbranch_vccnz sequential_preLN__ssm_conv_h3__mixer_s_mlp__prompt_kernel_pl25_l
sequential_preLN__ssm_conv_h3__mixer_s_mlp__prompt_kernel_pl25:
sequential_preLN__ssm_conv_h3__mixer_s_mlp__prompt_kernel_wt24:
  s_add_u32 s79, s75, 4096
  buffer_load_dwordx4 a[132:135], v4, s[12:15], s79 offen offset:2048 sc1
  s_add_u32 s79, s76, 4096
  buffer_load_dwordx4 a[136:139], v4, s[12:15], s79 offen offset:2048 sc1
  s_add_u32 s79, s72, 4096
  buffer_load_dwordx4 a[140:143], v4, s[12:15], s79 offen offset:3072 sc1
  s_add_u32 s79, s73, 4096
  buffer_load_dwordx4 a[144:147], v4, s[12:15], s79 offen offset:3072 sc1
  s_add_u32 s79, s74, 4096
  buffer_load_dwordx4 a[148:151], v4, s[12:15], s79 offen offset:3072 sc1
  s_add_u32 s79, s75, 4096
  buffer_load_dwordx4 a[152:155], v4, s[12:15], s79 offen offset:3072 sc1
  s_add_u32 s79, s76, 4096
  buffer_load_dwordx4 a[156:159], v4, s[12:15], s79 offen offset:3072 sc1
  s_barrier
  s_mul_i32 s36, s10, 14336
  s_add_u32 s37, s10, 0
  s_and_b32 s37, s37, 3
  s_lshl_b32 s38, s60, 2
  s_add_u32 s37, s37, s38
  s_mul_i32 s46, s37, 55296
  s_add_u32 s46, s46, s36
  s_add_u32 s46, s46, 21975040
  s_add_u32 s37, s10, 1
  s_and_b32 s37, s37, 3
  s_lshl_b32 s38, s60, 2
  s_add_u32 s37, s37, s38
  s_mul_i32 s47, s37, 55296
  s_add_u32 s47, s47, s36
  s_add_u32 s47, s47, 21975040
  s_add_u32 s37, s10, 2
  s_and_b32 s37, s37, 3
  s_lshl_b32 s38, s60, 2
  s_add_u32 s37, s37, s38
  s_mul_i32 s48, s37, 55296
  s_add_u32 s48, s48, s36
  s_add_u32 s48, s48, 21975040
  s_add_u32 s37, s10, 3
  s_and_b32 s37, s37, 3
  s_lshl_b32 s38, s60, 2
  s_add_u32 s37, s37, s38
  s_mul_i32 s49, s37, 55296
  s_add_u32 s49, s49, s36
  s_add_u32 s49, s49, 21975040
  s_cmp_eq_u32 s10, 3
  s_cselect_b32 s45, 0x40000000, 4096
  buffer_load_dwordx4 v[124:127], v4, s[12:15], s46 offen offset:0 sc1
  buffer_load_dwordx4 v[128:131], v4, s[12:15], s47 offen offset:0 sc1
  buffer_load_dwordx4 v[132:135], v4, s[12:15], s48 offen offset:0 sc1
  buffer_load_dwordx4 v[136:139], v4, s[12:15], s49 offen offset:0 sc1
  buffer_load_dwordx4 v[140:143], v4, s[12:15], s46 offen offset:1024 sc1
  buffer_load_dwordx4 v[144:147], v4, s[12:15], s47 offen offset:1024 sc1
  buffer_load_dwordx4 v[148:151], v4, s[12:15], s48 offen offset:1024 sc1
  buffer_load_dwordx4 v[152:155], v4, s[12:15], s49 offen offset:1024 sc1
  buffer_load_dwordx4 v[156:159], v4, s[12:15], s46 offen offset:2048 sc1
  buffer_load_dwordx4 v[160:163], v4, s[12:15], s47 offen offset:2048 sc1
  buffer_load_dwordx4 v[164:167], v4, s[12:15], s48 offen offset:2048 sc1
  buffer_load_dwordx4 v[168:171], v4, s[12:15], s49 offen offset:2048 sc1
  s_waitcnt vmcnt(8)
  v_mfma_f32_16x16x32_bf16 v[16:19], a[0:3], v[124:127], 0
  v_mfma_f32_16x16x32_bf16 v[20:23], a[4:7], v[124:127], 0
  v_mfma_f32_16x16x32_bf16 v[24:27], a[8:11], v[124:127], 0
  buffer_load_dwordx4 v[172:175], v4, s[12:15], s46 offen offset:3072 sc1
  v_mfma_f32_16x16x32_bf16 v[28:31], a[12:15], v[124:127], 0
  v_mfma_f32_16x16x32_bf16 v[32:35], a[16:19], v[124:127], 0
  v_mfma_f32_16x16x32_bf16 v[36:39], a[0:3], v[128:131], 0
  v_mfma_f32_16x16x32_bf16 v[40:43], a[4:7], v[128:131], 0
  v_mfma_f32_16x16x32_bf16 v[44:47], a[8:11], v[128:131], 0
  buffer_load_dwordx4 v[176:179], v4, s[12:15], s47 offen offset:3072 sc1
  v_mfma_f32_16x16x32_bf16 v[48:51], a[12:15], v[128:131], 0
  v_mfma_f32_16x16x32_bf16 v[52:55], a[16:19], v[128:131], 0
  v_mfma_f32_16x16x32_bf16 v[56:59], a[0:3], v[132:135], 0
  v_mfma_f32_16x16x32_bf16 v[60:63], a[4:7], v[132:135], 0
  v_mfma_f32_16x16x32_bf16 v[64:67], a[8:11], v[132:135], 0
  buffer_load_dwordx4 v[180:183], v4, s[12:15], s48 offen offset:3072 sc1
  v_mfma_f32_16x16x32_bf16 v[68:71], a[12:15], v[132:135], 0
  v_mfma_f32_16x16x32_bf16 v[72:75], a[16:19], v[132:135], 0
  v_mfma_f32_16x16x32_bf16 v[76:79], a[0:3], v[136:139], 0
  v_mfma_f32_16x16x32_bf16 v[80:83], a[4:7], v[136:139], 0
  v_mfma_f32_16x16x32_bf16 v[84:87], a[8:11], v[136:139], 0
  buffer_load_dwordx4 v[184:187], v4, s[12:15], s49 offen offset:3072 sc1
  v_mfma_f32_16x16x32_bf16 v[88:91], a[12:15], v[136:139], 0
  v_mfma_f32_16x16x32_bf16 v[92:95], a[16:19], v[136:139], 0
  s_waitcnt vmcnt(8)
  v_mfma_f32_16x16x32_bf16 v[16:19], a[20:23], v[140:143], v[16:19]
  v_mfma_f32_16x16x32_bf16 v[20:23], a[24:27], v[140:143], v[20:23]
  v_mfma_f32_16x16x32_bf16 v[24:27], a[28:31], v[140:143], v[24:27]
  s_add_u32 s46, s46, 4096
  buffer_load_dwordx4 v[124:127], v4, s[12:15], s46 offen offset:0 sc1
  v_mfma_f32_16x16x32_bf16 v[28:31], a[32:35], v[140:143], v[28:31]
  v_mfma_f32_16x16x32_bf16 v[32:35], a[36:39], v[140:143], v[32:35]
  v_mfma_f32_16x16x32_bf16 v[36:39], a[20:23], v[144:147], v[36:39]
  v_mfma_f32_16x16x32_bf16 v[40:43], a[24:27], v[144:147], v[40:43]
  v_mfma_f32_16x16x32_bf16 v[44:47], a[28:31], v[144:147], v[44:47]
  s_add_u32 s47, s47, 4096
  buffer_load_dwordx4 v[128:131], v4, s[12:15], s47 offen offset:0 sc1
  v_mfma_f32_16x16x32_bf16 v[48:51], a[32:35], v[144:147], v[48:51]
  v_mfma_f32_16x16x32_bf16 v[52:55], a[36:39], v[144:147], v[52:55]
  v_mfma_f32_16x16x32_bf16 v[56:59], a[20:23], v[148:151], v[56:59]
  v_mfma_f32_16x16x32_bf16 v[60:63], a[24:27], v[148:151], v[60:63]
  v_mfma_f32_16x16x32_bf16 v[64:67], a[28:31], v[148:151], v[64:67]
  s_add_u32 s48, s48, 4096
  buffer_load_dwordx4 v[132:135], v4, s[12:15], s48 offen offset:0 sc1
  v_mfma_f32_16x16x32_bf16 v[68:71], a[32:35], v[148:151], v[68:71]
  v_mfma_f32_16x16x32_bf16 v[72:75], a[36:39], v[148:151], v[72:75]
  v_mfma_f32_16x16x32_bf16 v[76:79], a[20:23], v[152:155], v[76:79]
  v_mfma_f32_16x16x32_bf16 v[80:83], a[24:27], v[152:155], v[80:83]
  v_mfma_f32_16x16x32_bf16 v[84:87], a[28:31], v[152:155], v[84:87]
  s_add_u32 s49, s49, 4096
  buffer_load_dwordx4 v[136:139], v4, s[12:15], s49 offen offset:0 sc1
  v_mfma_f32_16x16x32_bf16 v[88:91], a[32:35], v[152:155], v[88:91]
  v_mfma_f32_16x16x32_bf16 v[92:95], a[36:39], v[152:155], v[92:95]
  s_waitcnt vmcnt(8)
  v_mfma_f32_16x16x32_bf16 v[16:19], a[40:43], v[156:159], v[16:19]
  v_mfma_f32_16x16x32_bf16 v[20:23], a[44:47], v[156:159], v[20:23]
  v_mfma_f32_16x16x32_bf16 v[24:27], a[48:51], v[156:159], v[24:27]
  buffer_load_dwordx4 v[140:143], v4, s[12:15], s46 offen offset:1024 sc1
  v_mfma_f32_16x16x32_bf16 v[28:31], a[52:55], v[156:159], v[28:31]
  v_mfma_f32_16x16x32_bf16 v[32:35], a[56:59], v[156:159], v[32:35]
  v_mfma_f32_16x16x32_bf16 v[36:39], a[40:43], v[160:163], v[36:39]
  v_mfma_f32_16x16x32_bf16 v[40:43], a[44:47], v[160:163], v[40:43]
  v_mfma_f32_16x16x32_bf16 v[44:47], a[48:51], v[160:163], v[44:47]
  buffer_load_dwordx4 v[144:147], v4, s[12:15], s47 offen offset:1024 sc1
  v_mfma_f32_16x16x32_bf16 v[48:51], a[52:55], v[160:163], v[48:51]
  v_mfma_f32_16x16x32_bf16 v[52:55], a[56:59], v[160:163], v[52:55]
  v_mfma_f32_16x16x32_bf16 v[56:59], a[40:43], v[164:167], v[56:59]
  v_mfma_f32_16x16x32_bf16 v[60:63], a[44:47], v[164:167], v[60:63]
  v_mfma_f32_16x16x32_bf16 v[64:67], a[48:51], v[164:167], v[64:67]
  buffer_load_dwordx4 v[148:151], v4, s[12:15], s48 offen offset:1024 sc1
  v_mfma_f32_16x16x32_bf16 v[68:71], a[52:55], v[164:167], v[68:71]
  v_mfma_f32_16x16x32_bf16 v[72:75], a[56:59], v[164:167], v[72:75]
  v_mfma_f32_16x16x32_bf16 v[76:79], a[40:43], v[168:171], v[76:79]
  v_mfma_f32_16x16x32_bf16 v[80:83], a[44:47], v[168:171], v[80:83]
  v_mfma_f32_16x16x32_bf16 v[84:87], a[48:51], v[168:171], v[84:87]
  buffer_load_dwordx4 v[152:155], v4, s[12:15], s49 offen offset:1024 sc1
  v_mfma_f32_16x16x32_bf16 v[88:91], a[52:55], v[168:171], v[88:91]
  v_mfma_f32_16x16x32_bf16 v[92:95], a[56:59], v[168:171], v[92:95]
  s_waitcnt vmcnt(8)
  s_bitcmp1_b32 s10, 0
  s_nop 1
  s_cbranch_scc1 sequential_preLN__ssm_conv_h3__mixer_s_mlp__prompt_kernel_sw3o
  v_swap_b32 v174, v176
  v_swap_b32 v175, v177
  v_swap_b32 v182, v184
  v_swap_b32 v183, v185
  s_branch sequential_preLN__ssm_conv_h3__mixer_s_mlp__prompt_kernel_sw3d
sequential_preLN__ssm_conv_h3__mixer_s_mlp__prompt_kernel_sw3o:
  v_swap_b32 v178, v180
  v_swap_b32 v179, v181
  v_swap_b32 v186, v172
  v_swap_b32 v187, v173
sequential_preLN__ssm_conv_h3__mixer_s_mlp__prompt_kernel_sw3d:
  s_nop 1
  v_mfma_f32_16x16x32_bf16 v[16:19], a[60:63], v[172:175], v[16:19]
  v_mfma_f32_16x16x32_bf16 v[20:23], a[64:67], v[172:175], v[20:23]
  v_mfma_f32_16x16x32_bf16 v[24:27], a[68:71], v[172:175], v[24:27]
  buffer_load_dwordx4 v[156:159], v4, s[12:15], s46 offen offset:2048 sc1
  v_mfma_f32_16x16x32_bf16 v[28:31], a[72:75], v[172:175], v[28:31]
  v_mfma_f32_16x16x32_bf16 v[32:35], a[76:79], v[172:175], v[32:35]
  v_mfma_f32_16x16x32_bf16 v[36:39], a[60:63], v[176:179], v[36:39]
  v_mfma_f32_16x16x32_bf16 v[40:43], a[64:67], v[176:179], v[40:43]
  v_mfma_f32_16x16x32_bf16 v[44:47], a[68:71], v[176:179], v[44:47]
  buffer_load_dwordx4 v[160:163], v4, s[12:15], s47 offen offset:2048 sc1
  v_mfma_f32_16x16x32_bf16 v[48:51], a[72:75], v[176:179], v[48:51]
  v_mfma_f32_16x16x32_bf16 v[52:55], a[76:79], v[176:179], v[52:55]
  v_mfma_f32_16x16x32_bf16 v[56:59], a[60:63], v[180:183], v[56:59]
  v_mfma_f32_16x16x32_bf16 v[60:63], a[64:67], v[180:183], v[60:63]
  v_mfma_f32_16x16x32_bf16 v[64:67], a[68:71], v[180:183], v[64:67]
  buffer_load_dwordx4 v[164:167], v4, s[12:15], s48 offen offset:2048 sc1
  v_mfma_f32_16x16x32_bf16 v[68:71], a[72:75], v[180:183], v[68:71]
  v_mfma_f32_16x16x32_bf16 v[72:75], a[76:79], v[180:183], v[72:75]
  v_mfma_f32_16x16x32_bf16 v[76:79], a[60:63], v[184:187], v[76:79]
  v_mfma_f32_16x16x32_bf16 v[80:83], a[64:67], v[184:187], v[80:83]
  v_mfma_f32_16x16x32_bf16 v[84:87], a[68:71], v[184:187], v[84:87]
  buffer_load_dwordx4 v[168:171], v4, s[12:15], s49 offen offset:2048 sc1
  v_mfma_f32_16x16x32_bf16 v[88:91], a[72:75], v[184:187], v[88:91]
  v_mfma_f32_16x16x32_bf16 v[92:95], a[76:79], v[184:187], v[92:95]
  s_waitcnt vmcnt(8)
  v_mfma_f32_16x16x32_bf16 v[16:19], a[80:83], v[124:127], v[16:19]
  v_mfma_f32_16x16x32_bf16 v[20:23], a[84:87], v[124:127], v[20:23]
  v_mfma_f32_16x16x32_bf16 v[24:27], a[88:91], v[124:127], v[24:27]
  buffer_load_dwordx4 v[172:175], v4, s[12:15], s46 offen offset:3072 sc1
  v_mfma_f32_16x16x32_bf16 v[28:31], a[92:95], v[124:127], v[28:31]
  v_mfma_f32_16x16x32_bf16 v[32:35], a[96:99], v[124:127], v[32:35]
  v_mfma_f32_16x16x32_bf16 v[36:39], a[80:83], v[128:131], v[36:39]
  v_mfma_f32_16x16x32_bf16 v[40:43], a[84:87], v[128:131], v[40:43]
  v_mfma_f32_16x16x32_bf16 v[44:47], a[88:91], v[128:131], v[44:47]
  buffer_load_dwordx4 v[176:179], v4, s[12:15], s47 offen offset:3072 sc1
  v_mfma_f32_16x16x32_bf16 v[48:51], a[92:95], v[128:131], v[48:51]
  v_mfma_f32_16x16x32_bf16 v[52:55], a[96:99], v[128:131], v[52:55]
  v_mfma_f32_16x16x32_bf16 v[56:59], a[80:83], v[132:135], v[56:59]
  v_mfma_f32_16x16x32_bf16 v[60:63], a[84:87], v[132:135], v[60:63]
  v_mfma_f32_16x16x32_bf16 v[64:67], a[88:91], v[132:135], v[64:67]
  buffer_load_dwordx4 v[180:183], v4, s[12:15], s48 offen offset:3072 sc1
  v_mfma_f32_16x16x32_bf16 v[68:71], a[92:95], v[132:135], v[68:71]
  v_mfma_f32_16x16x32_bf16 v[72:75], a[96:99], v[132:135], v[72:75]
  v_mfma_f32_16x16x32_bf16 v[76:79], a[80:83], v[136:139], v[76:79]
  v_mfma_f32_16x16x32_bf16 v[80:83], a[84:87], v[136:139], v[80:83]
  v_mfma_f32_16x16x32_bf16 v[84:87], a[88:91], v[136:139], v[84:87]
  buffer_load_dwordx4 v[184:187], v4, s[12:15], s49 offen offset:3072 sc1
  v_mfma_f32_16x16x32_bf16 v[88:91], a[92:95], v[136:139], v[88:91]
  v_mfma_f32_16x16x32_bf16 v[92:95], a[96:99], v[136:139], v[92:95]
  s_waitcnt vmcnt(8)
  v_mfma_f32_16x16x32_bf16 v[16:19], a[100:103], v[140:143], v[16:19]
  v_mfma_f32_16x16x32_bf16 v[20:23], a[104:107], v[140:143], v[20:23]
  v_mfma_f32_16x16x32_bf16 v[24:27], a[108:111], v[140:143], v[24:27]
  s_add_u32 s46, s46, 4096
  buffer_load_dwordx4 v[124:127], v4, s[12:15], s46 offen offset:0 sc1
  v_mfma_f32_16x16x32_bf16 v[28:31], a[112:115], v[140:143], v[28:31]
  v_mfma_f32_16x16x32_bf16 v[32:35], a[116:119], v[140:143], v[32:35]
  v_mfma_f32_16x16x32_bf16 v[36:39], a[100:103], v[144:147], v[36:39]
  v_mfma_f32_16x16x32_bf16 v[40:43], a[104:107], v[144:147], v[40:43]
  v_mfma_f32_16x16x32_bf16 v[44:47], a[108:111], v[144:147], v[44:47]
  s_add_u32 s47, s47, 4096
  buffer_load_dwordx4 v[128:131], v4, s[12:15], s47 offen offset:0 sc1
  v_mfma_f32_16x16x32_bf16 v[48:51], a[112:115], v[144:147], v[48:51]
  v_mfma_f32_16x16x32_bf16 v[52:55], a[116:119], v[144:147], v[52:55]
  v_mfma_f32_16x16x32_bf16 v[56:59], a[100:103], v[148:151], v[56:59]
  v_mfma_f32_16x16x32_bf16 v[60:63], a[104:107], v[148:151], v[60:63]
  v_mfma_f32_16x16x32_bf16 v[64:67], a[108:111], v[148:151], v[64:67]
  s_add_u32 s48, s48, 4096
  buffer_load_dwordx4 v[132:135], v4, s[12:15], s48 offen offset:0 sc1
  v_mfma_f32_16x16x32_bf16 v[68:71], a[112:115], v[148:151], v[68:71]
  v_mfma_f32_16x16x32_bf16 v[72:75], a[116:119], v[148:151], v[72:75]
  v_mfma_f32_16x16x32_bf16 v[76:79], a[100:103], v[152:155], v[76:79]
  v_mfma_f32_16x16x32_bf16 v[80:83], a[104:107], v[152:155], v[80:83]
  v_mfma_f32_16x16x32_bf16 v[84:87], a[108:111], v[152:155], v[84:87]
  s_add_u32 s49, s49, 4096
  buffer_load_dwordx4 v[136:139], v4, s[12:15], s49 offen offset:0 sc1
  v_mfma_f32_16x16x32_bf16 v[88:91], a[112:115], v[152:155], v[88:91]
  v_mfma_f32_16x16x32_bf16 v[92:95], a[116:119], v[152:155], v[92:95]
  s_waitcnt vmcnt(8)
  v_mfma_f32_16x16x32_bf16 v[16:19], a[120:123], v[156:159], v[16:19]
  v_mfma_f32_16x16x32_bf16 v[20:23], a[124:127], v[156:159], v[20:23]
  v_mfma_f32_16x16x32_bf16 v[24:27], a[128:131], v[156:159], v[24:27]
  buffer_load_dwordx4 v[140:143], v4, s[12:15], s46 offen offset:1024 sc1
  v_mfma_f32_16x16x32_bf16 v[28:31], a[132:135], v[156:159], v[28:31]
  v_mfma_f32_16x16x32_bf16 v[32:35], a[136:139], v[156:159], v[32:35]
  v_mfma_f32_16x16x32_bf16 v[36:39], a[120:123], v[160:163], v[36:39]
  v_mfma_f32_16x16x32_bf16 v[40:43], a[124:127], v[160:163], v[40:43]
  v_mfma_f32_16x16x32_bf16 v[44:47], a[128:131], v[160:163], v[44:47]
  buffer_load_dwordx4 v[144:147], v4, s[12:15], s47 offen offset:1024 sc1
  v_mfma_f32_16x16x32_bf16 v[48:51], a[132:135], v[160:163], v[48:51]
  v_mfma_f32_16x16x32_bf16 v[52:55], a[136:139], v[160:163], v[52:55]
  v_mfma_f32_16x16x32_bf16 v[56:59], a[120:123], v[164:167], v[56:59]
  v_mfma_f32_16x16x32_bf16 v[60:63], a[124:127], v[164:167], v[60:63]
  v_mfma_f32_16x16x32_bf16 v[64:67], a[128:131], v[164:167], v[64:67]
  buffer_load_dwordx4 v[148:151], v4, s[12:15], s48 offen offset:1024 sc1
  v_mfma_f32_16x16x32_bf16 v[68:71], a[132:135], v[164:167], v[68:71]
  v_mfma_f32_16x16x32_bf16 v[72:75], a[136:139], v[164:167], v[72:75]
  v_mfma_f32_16x16x32_bf16 v[76:79], a[120:123], v[168:171], v[76:79]
  v_mfma_f32_16x16x32_bf16 v[80:83], a[124:127], v[168:171], v[80:83]
  v_mfma_f32_16x16x32_bf16 v[84:87], a[128:131], v[168:171], v[84:87]
  buffer_load_dwordx4 v[152:155], v4, s[12:15], s49 offen offset:1024 sc1
  v_mfma_f32_16x16x32_bf16 v[88:91], a[132:135], v[168:171], v[88:91]
  v_mfma_f32_16x16x32_bf16 v[92:95], a[136:139], v[168:171], v[92:95]
  s_waitcnt vmcnt(8)
  v_mfma_f32_16x16x32_bf16 v[16:19], a[140:143], v[172:175], v[16:19]
  v_mfma_f32_16x16x32_bf16 v[20:23], a[144:147], v[172:175], v[20:23]
  v_mfma_f32_16x16x32_bf16 v[24:27], a[148:151], v[172:175], v[24:27]
  buffer_load_dwordx4 v[156:159], v4, s[12:15], s46 offen offset:2048 sc1
  v_mfma_f32_16x16x32_bf16 v[28:31], a[152:155], v[172:175], v[28:31]
  v_mfma_f32_16x16x32_bf16 v[32:35], a[156:159], v[172:175], v[32:35]
  v_mfma_f32_16x16x32_bf16 v[36:39], a[140:143], v[176:179], v[36:39]
  v_mfma_f32_16x16x32_bf16 v[40:43], a[144:147], v[176:179], v[40:43]
  v_mfma_f32_16x16x32_bf16 v[44:47], a[148:151], v[176:179], v[44:47]
  buffer_load_dwordx4 v[160:163], v4, s[12:15], s47 offen offset:2048 sc1
  v_mfma_f32_16x16x32_bf16 v[48:51], a[152:155], v[176:179], v[48:51]
  v_mfma_f32_16x16x32_bf16 v[52:55], a[156:159], v[176:179], v[52:55]
  v_mfma_f32_16x16x32_bf16 v[56:59], a[140:143], v[180:183], v[56:59]
  v_mfma_f32_16x16x32_bf16 v[60:63], a[144:147], v[180:183], v[60:63]
  v_mfma_f32_16x16x32_bf16 v[64:67], a[148:151], v[180:183], v[64:67]
  buffer_load_dwordx4 v[164:167], v4, s[12:15], s48 offen offset:2048 sc1
  v_mfma_f32_16x16x32_bf16 v[68:71], a[152:155], v[180:183], v[68:71]
  v_mfma_f32_16x16x32_bf16 v[72:75], a[156:159], v[180:183], v[72:75]
  v_mfma_f32_16x16x32_bf16 v[76:79], a[140:143], v[184:187], v[76:79]
  v_mfma_f32_16x16x32_bf16 v[80:83], a[144:147], v[184:187], v[80:83]
  v_mfma_f32_16x16x32_bf16 v[84:87], a[148:151], v[184:187], v[84:87]
  buffer_load_dwordx4 v[168:171], v4, s[12:15], s49 offen offset:2048 sc1
  v_mfma_f32_16x16x32_bf16 v[88:91], a[152:155], v[184:187], v[88:91]
  v_mfma_f32_16x16x32_bf16 v[92:95], a[156:159], v[184:187], v[92:95]
  s_waitcnt vmcnt(8)
  v_mfma_f32_16x16x32_bf16 v[16:19], a[160:163], v[124:127], v[16:19]
  v_mfma_f32_16x16x32_bf16 v[20:23], a[164:167], v[124:127], v[20:23]
  v_mfma_f32_16x16x32_bf16 v[24:27], a[168:171], v[124:127], v[24:27]
  buffer_load_dwordx4 v[172:175], v4, s[12:15], s46 offen offset:3072 sc1
  v_mfma_f32_16x16x32_bf16 v[28:31], a[172:175], v[124:127], v[28:31]
  v_mfma_f32_16x16x32_bf16 v[32:35], a[176:179], v[124:127], v[32:35]
  v_mfma_f32_16x16x32_bf16 v[36:39], a[160:163], v[128:131], v[36:39]
  v_mfma_f32_16x16x32_bf16 v[40:43], a[164:167], v[128:131], v[40:43]
  v_mfma_f32_16x16x32_bf16 v[44:47], a[168:171], v[128:131], v[44:47]
  buffer_load_dwordx4 v[176:179], v4, s[12:15], s47 offen offset:3072 sc1
  v_mfma_f32_16x16x32_bf16 v[48:51], a[172:175], v[128:131], v[48:51]
  v_mfma_f32_16x16x32_bf16 v[52:55], a[176:179], v[128:131], v[52:55]
  v_mfma_f32_16x16x32_bf16 v[56:59], a[160:163], v[132:135], v[56:59]
  v_mfma_f32_16x16x32_bf16 v[60:63], a[164:167], v[132:135], v[60:63]
  v_mfma_f32_16x16x32_bf16 v[64:67], a[168:171], v[132:135], v[64:67]
  buffer_load_dwordx4 v[180:183], v4, s[12:15], s48 offen offset:3072 sc1
  v_mfma_f32_16x16x32_bf16 v[68:71], a[172:175], v[132:135], v[68:71]
  v_mfma_f32_16x16x32_bf16 v[72:75], a[176:179], v[132:135], v[72:75]
  v_mfma_f32_16x16x32_bf16 v[76:79], a[160:163], v[136:139], v[76:79]
  v_mfma_f32_16x16x32_bf16 v[80:83], a[164:167], v[136:139], v[80:83]
  v_mfma_f32_16x16x32_bf16 v[84:87], a[168:171], v[136:139], v[84:87]
  buffer_load_dwordx4 v[184:187], v4, s[12:15], s49 offen offset:3072 sc1
  v_mfma_f32_16x16x32_bf16 v[88:91], a[172:175], v[136:139], v[88:91]
  v_mfma_f32_16x16x32_bf16 v[92:95], a[176:179], v[136:139], v[92:95]
  s_waitcnt vmcnt(8)
  s_cmp_lg_u32 s10, 3
  s_cbranch_scc1 sequential_preLN__ssm_conv_h3__mixer_s_mlp__prompt_kernel_sw9d
  v_swap_b32 v146, v148
  v_swap_b32 v147, v149
  v_swap_b32 v154, v140
  v_swap_b32 v155, v141
sequential_preLN__ssm_conv_h3__mixer_s_mlp__prompt_kernel_sw9d:
  s_nop 1
  v_mfma_f32_16x16x32_bf16 v[16:19], a[180:183], v[140:143], v[16:19]
  v_mfma_f32_16x16x32_bf16 v[20:23], a[184:187], v[140:143], v[20:23]
  v_mfma_f32_16x16x32_bf16 v[24:27], a[188:191], v[140:143], v[24:27]
  s_add_u32 s46, s46, s45
  buffer_load_dwordx4 v[124:127], v4, s[12:15], s46 offen offset:0 sc1
  v_mfma_f32_16x16x32_bf16 v[28:31], a[192:195], v[140:143], v[28:31]
  v_mfma_f32_16x16x32_bf16 v[32:35], a[196:199], v[140:143], v[32:35]
  v_mfma_f32_16x16x32_bf16 v[36:39], a[180:183], v[144:147], v[36:39]
  v_mfma_f32_16x16x32_bf16 v[40:43], a[184:187], v[144:147], v[40:43]
  v_mfma_f32_16x16x32_bf16 v[44:47], a[188:191], v[144:147], v[44:47]
  s_add_u32 s47, s47, s45
  buffer_load_dwordx4 v[128:131], v4, s[12:15], s47 offen offset:0 sc1
  v_mfma_f32_16x16x32_bf16 v[48:51], a[192:195], v[144:147], v[48:51]
  v_mfma_f32_16x16x32_bf16 v[52:55], a[196:199], v[144:147], v[52:55]
  v_mfma_f32_16x16x32_bf16 v[56:59], a[180:183], v[148:151], v[56:59]
  v_mfma_f32_16x16x32_bf16 v[60:63], a[184:187], v[148:151], v[60:63]
  v_mfma_f32_16x16x32_bf16 v[64:67], a[188:191], v[148:151], v[64:67]
  s_add_u32 s48, s48, s45
  buffer_load_dwordx4 v[132:135], v4, s[12:15], s48 offen offset:0 sc1
  v_mfma_f32_16x16x32_bf16 v[68:71], a[192:195], v[148:151], v[68:71]
  v_mfma_f32_16x16x32_bf16 v[72:75], a[196:199], v[148:151], v[72:75]
  v_mfma_f32_16x16x32_bf16 v[76:79], a[180:183], v[152:155], v[76:79]
  v_mfma_f32_16x16x32_bf16 v[80:83], a[184:187], v[152:155], v[80:83]
  v_mfma_f32_16x16x32_bf16 v[84:87], a[188:191], v[152:155], v[84:87]
  s_add_u32 s49, s49, s45
  buffer_load_dwordx4 v[136:139], v4, s[12:15], s49 offen offset:0 sc1
  v_mfma_f32_16x16x32_bf16 v[88:91], a[192:195], v[152:155], v[88:91]
  v_mfma_f32_16x16x32_bf16 v[92:95], a[196:199], v[152:155], v[92:95]
  s_waitcnt vmcnt(8)
  s_cmp_eq_u32 s10, 3
  s_cbranch_scc1 sequential_preLN__ssm_conv_h3__mixer_s_mlp__prompt_kernel_sw10d
  s_bitcmp1_b32 s10, 0
  s_nop 1
  s_cbranch_scc1 sequential_preLN__ssm_conv_h3__mixer_s_mlp__prompt_kernel_sw10o
  v_swap_b32 v158, v160
  v_swap_b32 v159, v161
  v_swap_b32 v166, v168
  v_swap_b32 v167, v169
  s_branch sequential_preLN__ssm_conv_h3__mixer_s_mlp__prompt_kernel_sw10d
sequential_preLN__ssm_conv_h3__mixer_s_mlp__prompt_kernel_sw10o:
  v_swap_b32 v162, v164
  v_swap_b32 v163, v165
  v_swap_b32 v170, v156
  v_swap_b32 v171, v157
sequential_preLN__ssm_conv_h3__mixer_s_mlp__prompt_kernel_sw10d:
  s_nop 1
  v_mfma_f32_16x16x32_bf16 v[16:19], a[200:203], v[156:159], v[16:19]
  v_mfma_f32_16x16x32_bf16 v[20:23], a[204:207], v[156:159], v[20:23]
  v_mfma_f32_16x16x32_bf16 v[24:27], a[208:211], v[156:159], v[24:27]
  buffer_load_dwordx4 v[140:143], v4, s[12:15], s46 offen offset:1024 sc1
  v_mfma_f32_16x16x32_bf16 v[28:31], a[212:215], v[156:159], v[28:31]
  v_mfma_f32_16x16x32_bf16 v[32:35], a[216:219], v[156:159], v[32:35]
  v_mfma_f32_16x16x32_bf16 v[36:39], a[200:203], v[160:163], v[36:39]
  v_mfma_f32_16x16x32_bf16 v[40:43], a[204:207], v[160:163], v[40:43]
  v_mfma_f32_16x16x32_bf16 v[44:47], a[208:211], v[160:163], v[44:47]
  buffer_load_dwordx4 v[144:147], v4, s[12:15], s47 offen offset:1024 sc1
  v_mfma_f32_16x16x32_bf16 v[48:51], a[212:215], v[160:163], v[48:51]
  v_mfma_f32_16x16x32_bf16 v[52:55], a[216:219], v[160:163], v[52:55]
  v_mfma_f32_16x16x32_bf16 v[56:59], a[200:203], v[164:167], v[56:59]
  v_mfma_f32_16x16x32_bf16 v[60:63], a[204:207], v[164:167], v[60:63]
  v_mfma_f32_16x16x32_bf16 v[64:67], a[208:211], v[164:167], v[64:67]
  buffer_load_dwordx4 v[148:151], v4, s[12:15], s48 offen offset:1024 sc1
  v_mfma_f32_16x16x32_bf16 v[68:71], a[212:215], v[164:167], v[68:71]
  v_mfma_f32_16x16x32_bf16 v[72:75], a[216:219], v[164:167], v[72:75]
  v_mfma_f32_16x16x32_bf16 v[76:79], a[200:203], v[168:171], v[76:79]
  v_mfma_f32_16x16x32_bf16 v[80:83], a[204:207], v[168:171], v[80:83]
  v_mfma_f32_16x16x32_bf16 v[84:87], a[208:211], v[168:171], v[84:87]
  buffer_load_dwordx4 v[152:155], v4, s[12:15], s49 offen offset:1024 sc1
  s_add_u32 s36, s70, 11358208
  buffer_load_dwordx4 v[100:103], v4, s[12:15], s36 offen sc1
  v_mfma_f32_16x16x32_bf16 v[88:91], a[212:215], v[168:171], v[88:91]
  v_mfma_f32_16x16x32_bf16 v[92:95], a[216:219], v[168:171], v[92:95]
  s_waitcnt vmcnt(9)
  v_mfma_f32_16x16x32_bf16 v[16:19], a[220:223], v[172:175], v[16:19]
  v_mfma_f32_16x16x32_bf16 v[20:23], a[224:227], v[172:175], v[20:23]
  v_mfma_f32_16x16x32_bf16 v[24:27], a[228:231], v[172:175], v[24:27]
  buffer_load_dwordx4 v[104:107], v4, s[12:15], s36 offen offset:1024 sc1
  v_mfma_f32_16x16x32_bf16 v[28:31], a[232:235], v[172:175], v[28:31]
  v_mfma_f32_16x16x32_bf16 v[32:35], a[236:239], v[172:175], v[32:35]
  v_mfma_f32_16x16x32_bf16 v[36:39], a[220:223], v[176:179], v[36:39]
  v_mfma_f32_16x16x32_bf16 v[40:43], a[224:227], v[176:179], v[40:43]
  v_mfma_f32_16x16x32_bf16 v[44:47], a[228:231], v[176:179], v[44:47]
  s_add_u32 s37, s71, 11358208
  buffer_load_dwordx2 v[108:109], v4, s[12:15], s37 offen sc1
  v_mfma_f32_16x16x32_bf16 v[48:51], a[232:235], v[176:179], v[48:51]
  v_mfma_f32_16x16x32_bf16 v[52:55], a[236:239], v[176:179], v[52:55]
  v_mfma_f32_16x16x32_bf16 v[56:59], a[220:223], v[180:183], v[56:59]
  v_mfma_f32_16x16x32_bf16 v[60:63], a[224:227], v[180:183], v[60:63]
  v_mfma_f32_16x16x32_bf16 v[64:67], a[228:231], v[180:183], v[64:67]
  s_add_u32 s36, s70, 19222528
  buffer_load_dwordx4 v[110:113], v4, s[12:15], s36 offen sc1
  v_mfma_f32_16x16x32_bf16 v[68:71], a[232:235], v[180:183], v[68:71]
  v_mfma_f32_16x16x32_bf16 v[72:75], a[236:239], v[180:183], v[72:75]
  v_mfma_f32_16x16x32_bf16 v[76:79], a[220:223], v[184:187], v[76:79]
  v_mfma_f32_16x16x32_bf16 v[80:83], a[224:227], v[184:187], v[80:83]
  v_mfma_f32_16x16x32_bf16 v[84:87], a[228:231], v[184:187], v[84:87]
  buffer_load_dwordx4 v[114:117], v4, s[12:15], s36 offen offset:1024 sc1
  v_mfma_f32_16x16x32_bf16 v[88:91], a[232:235], v[184:187], v[88:91]
  v_mfma_f32_16x16x32_bf16 v[92:95], a[236:239], v[184:187], v[92:95]
  s_waitcnt vmcnt(9)
  v_mfma_f32_16x16x32_bf16 v[16:19], a[240:243], v[124:127], v[16:19]
  v_mfma_f32_16x16x32_bf16 v[20:23], a[244:247], v[124:127], v[20:23]
  v_mfma_f32_16x16x32_bf16 v[24:27], a[248:251], v[124:127], v[24:27]
  s_and_b32 s37, s63, 0xfffffffe
  s_add_u32 s37, s37, s62
  s_mul_i32 s37, s37, 20480
  s_lshr_b32 s38, s68, 1
  s_lshl_b32 s38, s38, 10
  s_add_u32 s37, s37, s38
  s_and_b32 s38, s63, 1
  s_lshl_b32 s38, s38, 3
  s_add_u32 s37, s37, s38
  s_add_u32 s37, s37, 19222528
  buffer_load_dwordx2 v[118:119], v4, s[12:15], s37 offen sc1
  v_mfma_f32_16x16x32_bf16 v[28:31], a[252:255], v[124:127], v[28:31]
  v_mfma_f32_16x16x32_bf16 v[32:35], v[232:235], v[124:127], v[32:35]
  v_mfma_f32_16x16x32_bf16 v[36:39], a[240:243], v[128:131], v[36:39]
  v_mfma_f32_16x16x32_bf16 v[40:43], a[244:247], v[128:131], v[40:43]
  v_mfma_f32_16x16x32_bf16 v[44:47], a[248:251], v[128:131], v[44:47]
  v_mfma_f32_16x16x32_bf16 v[48:51], a[252:255], v[128:131], v[48:51]
  v_mfma_f32_16x16x32_bf16 v[52:55], v[232:235], v[128:131], v[52:55]
  v_mfma_f32_16x16x32_bf16 v[56:59], a[240:243], v[132:135], v[56:59]
  v_mfma_f32_16x16x32_bf16 v[60:63], a[244:247], v[132:135], v[60:63]
  v_mfma_f32_16x16x32_bf16 v[64:67], a[248:251], v[132:135], v[64:67]
  v_mfma_f32_16x16x32_bf16 v[68:71], a[252:255], v[132:135], v[68:71]
  v_mfma_f32_16x16x32_bf16 v[72:75], v[232:235], v[132:135], v[72:75]
  v_mfma_f32_16x16x32_bf16 v[76:79], a[240:243], v[136:139], v[76:79]
  v_mfma_f32_16x16x32_bf16 v[80:83], a[244:247], v[136:139], v[80:83]
  v_mfma_f32_16x16x32_bf16 v[84:87], a[248:251], v[136:139], v[84:87]
  v_mfma_f32_16x16x32_bf16 v[88:91], a[252:255], v[136:139], v[88:91]
  v_mfma_f32_16x16x32_bf16 v[92:95], v[232:235], v[136:139], v[92:95]
  s_waitcnt vmcnt(6)
  v_mfma_f32_16x16x32_bf16 v[16:19], v[236:239], v[140:143], v[16:19]
  v_mfma_f32_16x16x32_bf16 v[20:23], v[240:243], v[140:143], v[20:23]
  v_mfma_f32_16x16x32_bf16 v[24:27], v[244:247], v[140:143], v[24:27]
  v_mfma_f32_16x16x32_bf16 v[28:31], v[248:251], v[140:143], v[28:31]
  v_mfma_f32_16x16x32_bf16 v[32:35], v[252:255], v[140:143], v[32:35]
  v_mfma_f32_16x16x32_bf16 v[36:39], v[236:239], v[144:147], v[36:39]
  v_mfma_f32_16x16x32_bf16 v[40:43], v[240:243], v[144:147], v[40:43]
  v_mfma_f32_16x16x32_bf16 v[44:47], v[244:247], v[144:147], v[44:47]
  v_mfma_f32_16x16x32_bf16 v[48:51], v[248:251], v[144:147], v[48:51]
  v_mfma_f32_16x16x32_bf16 v[52:55], v[252:255], v[144:147], v[52:55]
  v_mfma_f32_16x16x32_bf16 v[56:59], v[236:239], v[148:151], v[56:59]
  v_mfma_f32_16x16x32_bf16 v[60:63], v[240:243], v[148:151], v[60:63]
  v_mfma_f32_16x16x32_bf16 v[64:67], v[244:247], v[148:151], v[64:67]
  v_mfma_f32_16x16x32_bf16 v[68:71], v[248:251], v[148:151], v[68:71]
  v_mfma_f32_16x16x32_bf16 v[72:75], v[252:255], v[148:151], v[72:75]
  v_mfma_f32_16x16x32_bf16 v[76:79], v[236:239], v[152:155], v[76:79]
  v_mfma_f32_16x16x32_bf16 v[80:83], v[240:243], v[152:155], v[80:83]
  v_mfma_f32_16x16x32_bf16 v[84:87], v[244:247], v[152:155], v[84:87]
  v_mfma_f32_16x16x32_bf16 v[88:91], v[248:251], v[152:155], v[88:91]
  v_mfma_f32_16x16x32_bf16 v[92:95], v[252:255], v[152:155], v[92:95]
  s_add_u32 s37, s10, 1
  s_and_b32 s37, s37, 3
  s_mul_i32 s37, s37, 15360
  s_add_u32 s37, s37, 0
  v_add_u32 v6, s37, v4
  s_add_u32 s37, s10, 2
  s_and_b32 s37, s37, 3
  s_mul_i32 s37, s37, 15360
  s_add_u32 s37, s37, 5120
  v_add_u32 v7, s37, v4
  s_add_u32 s37, s10, 3
  s_and_b32 s37, s37, 3
  s_mul_i32 s37, s37, 15360
  s_add_u32 s37, s37, 10240
  v_add_u32 v8, s37, v4
  ds_write_b128 v6, v[36:39] offset:0
  ds_write_b128 v6, v[40:43] offset:1024
  ds_write_b128 v6, v[44:47] offset:2048
  ds_write_b128 v6, v[48:51] offset:3072
  ds_write_b128 v6, v[52:55] offset:4096
  ds_write_b128 v7, v[56:59] offset:0
  ds_write_b128 v7, v[60:63] offset:1024
  ds_write_b128 v7, v[64:67] offset:2048
  ds_write_b128 v7, v[68:71] offset:3072
  ds_write_b128 v7, v[72:75] offset:4096
  ds_write_b128 v8, v[76:79] offset:0
  ds_write_b128 v8, v[80:83] offset:1024
  ds_write_b128 v8, v[84:87] offset:2048
  ds_write_b128 v8, v[88:91] offset:3072
  ds_write_b128 v8, v[92:95] offset:4096
  s_mul_i32 s37, s10, 15360
  v_add_u32 v9, s37, v4
  s_waitcnt vmcnt(0)
  s_mov_b32 s36, 0xffff0000
  v_lshlrev_b32 v188, 16, v100
  v_and_b32 v189, s36, v100
  v_lshlrev_b32 v10, 16, v110
  v_and_b32 v11, s36, v110
  v_add_f32 v188, v188, v10
  v_add_f32 v189, v189, v11
  v_lshlrev_b32 v190, 16, v101
  v_and_b32 v191, s36, v101
  v_lshlrev_b32 v10, 16, v111
  v_and_b32 v11, s36, v111
  v_add_f32 v190, v190, v10
  v_add_f32 v191, v191, v11
  v_lshlrev_b32 v192, 16, v102
  v_and_b32 v193, s36, v102
  v_lshlrev_b32 v10, 16, v112
  v_and_b32 v11, s36, v112
  v_add_f32 v192, v192, v10
  v_add_f32 v193, v193, v11
  v_lshlrev_b32 v194, 16, v103
  v_and_b32 v195, s36, v103
  v_lshlrev_b32 v10, 16, v113
  v_and_b32 v11, s36, v113
  v_add_f32 v194, v194, v10
  v_add_f32 v195, v195, v11
  v_lshlrev_b32 v196, 16, v104
  v_and_b32 v197, s36, v104
  v_lshlrev_b32 v10, 16, v114
  v_and_b32 v11, s36, v114
  v_add_f32 v196, v196, v10
  v_add_f32 v197, v197, v11
  v_lshlrev_b32 v198, 16, v105
  v_and_b32 v199, s36, v105
  v_lshlrev_b32 v10, 16, v115
  v_and_b32 v11, s36, v115
  v_add_f32 v198, v198, v10
  v_add_f32 v199, v199, v11
  v_lshlrev_b32 v200, 16, v106
  v_and_b32 v201, s36, v106
  v_lshlrev_b32 v10, 16, v116
  v_and_b32 v11, s36, v116
  v_add_f32 v200, v200, v10
  v_add_f32 v201, v201, v11
  v_lshlrev_b32 v202, 16, v107
  v_and_b32 v203, s36, v107
  v_lshlrev_b32 v10, 16, v117
  v_and_b32 v11, s36, v117
  v_add_f32 v202, v202, v10
  v_add_f32 v203, v203, v11
  v_lshlrev_b32 v204, 16, v108
  v_and_b32 v205, s36, v108
  v_lshlrev_b32 v10, 16, v118
  v_and_b32 v11, s36, v118
  v_add_f32 v204, v204, v10
  v_add_f32 v205, v205, v11
  v_lshlrev_b32 v206, 16, v109
  v_and_b32 v207, s36, v109
  v_lshlrev_b32 v10, 16, v119
  v_and_b32 v11, s36, v119
  v_add_f32 v206, v206, v10
  v_add_f32 v207, v207, v11
  v_pk_add_f32 v[16:17], v[16:17], v[188:189]
  v_pk_add_f32 v[18:19], v[18:19], v[190:191]
  v_pk_add_f32 v[20:21], v[20:21], v[192:193]
  v_pk_add_f32 v[22:23], v[22:23], v[194:195]
  v_pk_add_f32 v[24:25], v[24:25], v[196:197]
  v_pk_add_f32 v[26:27], v[26:27], v[198:199]
  v_pk_add_f32 v[28:29], v[28:29], v[200:201]
  v_pk_add_f32 v[30:31], v[30:31], v[202:203]
  v_pk_add_f32 v[32:33], v[32:33], v[204:205]
  v_pk_add_f32 v[34:35], v[34:35], v[206:207]
  s_lshl_b32 s37, s63, 4
  v_add_u32 v6, s37, v2
  v_mul_u32_u24 v6, 1280, v6
  v_lshl_add_u32 v6, v3, 4, v6
  s_lshr_b32 s37, s64, 1
  s_lshl_b32 s37, s37, 6
  s_lshr_b32 s38, s68, 1
  s_lshl_b32 s38, s38, 6
  s_lshl_b32 s39, s62, 3
  s_add_u32 s38, s38, s39
  s_waitcnt lgkmcnt(0)
  s_barrier
  ds_read_b128 v[36:39], v9 offset:0
  ds_read_b128 v[40:43], v9 offset:1024
  ds_read_b128 v[44:47], v9 offset:2048
  ds_read_b128 v[48:51], v9 offset:3072
  ds_read_b128 v[52:55], v9 offset:4096
  ds_read_b128 v[56:59], v9 offset:5120
  ds_read_b128 v[60:63], v9 offset:6144
  ds_read_b128 v[64:67], v9 offset:7168
  ds_read_b128 v[68:71], v9 offset:8192
  ds_read_b128 v[72:75], v9 offset:9216
  ds_read_b128 v[76:79], v9 offset:10240
  ds_read_b128 v[80:83], v9 offset:11264
  ds_read_b128 v[84:87], v9 offset:12288
  ds_read_b128 v[88:91], v9 offset:13312
  ds_read_b128 v[92:95], v9 offset:14336
  s_waitcnt lgkmcnt(10)
  v_pk_add_f32 v[16:17], v[16:17], v[36:37]
  v_pk_add_f32 v[18:19], v[18:19], v[38:39]
  v_pk_add_f32 v[20:21], v[20:21], v[40:41]
  v_pk_add_f32 v[22:23], v[22:23], v[42:43]
  v_pk_add_f32 v[24:25], v[24:25], v[44:45]
  v_pk_add_f32 v[26:27], v[26:27], v[46:47]
  v_pk_add_f32 v[28:29], v[28:29], v[48:49]
  v_pk_add_f32 v[30:31], v[30:31], v[50:51]
  v_pk_add_f32 v[32:33], v[32:33], v[52:53]
  v_pk_add_f32 v[34:35], v[34:35], v[54:55]
  s_waitcnt lgkmcnt(5)
  v_pk_add_f32 v[16:17], v[16:17], v[56:57]
  v_pk_add_f32 v[18:19], v[18:19], v[58:59]
  v_pk_add_f32 v[20:21], v[20:21], v[60:61]
  v_pk_add_f32 v[22:23], v[22:23], v[62:63]
  v_pk_add_f32 v[24:25], v[24:25], v[64:65]
  v_pk_add_f32 v[26:27], v[26:27], v[66:67]
  v_pk_add_f32 v[28:29], v[28:29], v[68:69]
  v_pk_add_f32 v[30:31], v[30:31], v[70:71]
  v_pk_add_f32 v[32:33], v[32:33], v[72:73]
  v_pk_add_f32 v[34:35], v[34:35], v[74:75]
  s_waitcnt lgkmcnt(0)
  v_pk_add_f32 v[16:17], v[16:17], v[76:77]
  v_pk_add_f32 v[18:19], v[18:19], v[78:79]
  v_pk_add_f32 v[20:21], v[20:21], v[80:81]
  v_pk_add_f32 v[22:23], v[22:23], v[82:83]
  v_pk_add_f32 v[24:25], v[24:25], v[84:85]
  v_pk_add_f32 v[26:27], v[26:27], v[86:87]
  v_pk_add_f32 v[28:29], v[28:29], v[88:89]
  v_pk_add_f32 v[30:31], v[30:31], v[90:91]
  v_pk_add_f32 v[32:33], v[32:33], v[92:93]
  v_pk_add_f32 v[34:35], v[34:35], v[94:95]
  v_cvt_pk_bf16_f32 v100, v16, v17
  v_cvt_pk_bf16_f32 v101, v18, v19
  v_cvt_pk_bf16_f32 v102, v20, v21
  v_cvt_pk_bf16_f32 v103, v22, v23
  v_cvt_pk_bf16_f32 v104, v24, v25
  v_cvt_pk_bf16_f32 v105, v26, v27
  v_cvt_pk_bf16_f32 v106, v28, v29
  v_cvt_pk_bf16_f32 v107, v30, v31
  v_cvt_pk_bf16_f32 v108, v32, v33
  v_cvt_pk_bf16_f32 v109, v34, v35
  buffer_store_dwordx2 v[108:109], v6, s[20:23], s38 offen sc1
  s_mul_i32 s39, s10, 2304
  s_add_u32 s39, s39, 61440
  v_mul_u32_u24 v7, 144, v2
  v_lshl_add_u32 v7, v3, 4, v7
  v_add_u32 v7, s39, v7
  ds_write_b128 v7, v[100:103]
  ds_write_b128 v7, v[104:107] offset:64
  v_lshrrev_b32 v8, 3, v1
  v_and_b32 v9, 7, v1
  v_lshlrev_b32 v9, 4, v9
  v_mul_u32_u24 v10, 144, v8
  v_add3_u32 v10, v10, v9, s39
  s_lshl_b32 s39, s63, 4
  v_add_u32 v8, s39, v8
  v_mul_u32_u24 v8, 1280, v8
  v_add_u32 v8, v8, v9
  s_waitcnt lgkmcnt(0)
  ds_read_b128 v[100:103], v10
  ds_read_b128 v[104:107], v10 offset:1152
  s_add_u32 s39, s37, 10240
  s_waitcnt lgkmcnt(1)
  buffer_store_dwordx4 v[100:103], v8, s[20:23], s37 offen sc1
  s_waitcnt lgkmcnt(0)
  buffer_store_dwordx4 v[104:107], v8, s[20:23], s39 offen sc1
sequential_preLN__ssm_conv_h3__mixer_s_mlp__prompt_kernel_end:
  s_endpgm
text_end:
.section .rodata,"a"
.p2align 6
.amdhsa_kernel sequential_preLN__ssm_conv_h3__mixer_s_mlp__prompt_kernel
  .amdhsa_next_free_vgpr 512
  .amdhsa_next_free_sgpr 96
  .amdhsa_accum_offset 256
  .amdhsa_group_segment_fixed_size 0
  .amdhsa_kernarg_size 112
  .amdhsa_user_sgpr_count 2
  .amdhsa_user_sgpr_kernarg_segment_ptr 1
  .amdhsa_system_sgpr_workgroup_id_x 1
  .amdhsa_float_denorm_mode_32 3
.end_amdhsa_kernel
```
